```python
import torch

def _softmax(x, axis=-1):
    return torch.softmax(x, dim=axis)
def _gelu(x):
    return torch.nn.functional.gelu(x, approximate="tanh")
def _silu(x):
    return torch.nn.functional.silu(x)
def _sigmoid(x):
    return torch.sigmoid(x)
def _layernorm(x, axis=-1, eps=1e-5):
    m = x.mean(dim=axis, keepdim=True)
    v = x.var(dim=axis, keepdim=True, unbiased=False)
    return (x - m) / torch.sqrt(v + eps)
def _scatter_add(tgt, idx, src, axis=0):
    return tgt.clone().index_add_(axis, idx, src)
def _segment_sum(src, seg, n):
    out = torch.zeros((n,) + src.shape[1:], dtype=src.dtype)
    return out.index_add_(0, seg, src)
def _pad(x, pw):
    flat = tuple(v for pair in reversed(pw) for v in pair)
    return torch.nn.functional.pad(x, flat)

kernel_name = 'sequential_preLN__grouped_kv_mqa__moe_arch_mod__prompt'

def setup_inputs():

    _w = (lambda a: (lambda t: t.to(torch.bfloat16) if t.is_floating_point() else t)(torch.as_tensor(a)))
    def _A_setup():
        B, S, D, H = 1, 2048, 1024, 32
        Dh = D // H
        return {
            "x": _w((lambda *s: torch.randn(*s, dtype=torch.bfloat16) * 0.05)(B, S, D)),
            "wq": _w((lambda *s: torch.randn(*s, dtype=torch.bfloat16) * 0.05)(D, H * Dh)),
            "wk": _w((lambda *s: torch.randn(*s, dtype=torch.bfloat16) * 0.05)(D, Dh)),
            "wv": _w((lambda *s: torch.randn(*s, dtype=torch.bfloat16) * 0.05)(D, Dh)),
            "wo": _w((lambda *s: torch.randn(*s, dtype=torch.bfloat16) * 0.05)(H * Dh, D)),
        }
    _A_in = _A_setup()

    def _B_setup():
        B, S, D, F, C = 1, 2048, 1024, 3584, 1
        return {
            "x": _w((lambda *s: torch.randn(*s, dtype=torch.bfloat16) * 0.05)(B, S, D)),
            "w_r": _w((lambda *s: torch.randn(*s, dtype=torch.bfloat16) * 0.05)(D)),
            "w_gate": _w((lambda *s: torch.randn(*s, dtype=torch.bfloat16) * 0.05)(D, F)),
            "w_up": _w((lambda *s: torch.randn(*s, dtype=torch.bfloat16) * 0.05)(D, F)),
            "w_down": _w((lambda *s: torch.randn(*s, dtype=torch.bfloat16) * 0.05)(F, D)),
        }
    _B_in = _B_setup()

    return {
        "A_x": _A_in["x"],
        "A_wq": _A_in["wq"],
        "A_wk": _A_in["wk"],
        "A_wv": _A_in["wv"],
        "A_wo": _A_in["wo"],
        "B_x": _B_in["x"],
        "B_w_r": _B_in["w_r"],
        "B_w_gate": _B_in["w_gate"],
        "B_w_up": _B_in["w_up"],
        "B_w_down": _B_in["w_down"],
    }

def reference(A_x, A_wq, A_wk, A_wv, A_wo, B_x, B_w_r, B_w_gate, B_w_up, B_w_down):
    def _A_ref(x, wq, wk, wv, wo):
        B, S, D = x.shape
        H = 32
        Dh = D // H
        q = (lambda x, *d: x.permute(*d))((x @ wq).reshape(B, S, H, Dh), 0, 2, 1, 3)
        k = x @ wk
        v = x @ wv
        scores = torch.einsum("bhqd,bkd->bhqk", q, k) * (Dh ** -0.5)
        p = _softmax(scores, axis=-1)
        o = torch.einsum("bhqk,bkd->bhqd", p, v)
        return (lambda x, *d: x.permute(*d))(o, 0, 2, 1, 3).reshape(B, S, H * Dh) @ wo

    def _B_ref(x, w_r, w_gate, w_up, w_down):
        B, S, D = x.shape
        C = 1
        r = x @ w_r
        idx = torch.argsort(-r, axis=-1)[:, :C]
        idx_e = (lambda x, n, axis: torch.repeat_interleave(x, n, dim=axis))(idx.reshape(B, C, 1), D, axis=2)
        x_sel = (lambda x, i, axis: torch.take_along_dim(x, i, dim=axis))(x, idx_e, axis=1)
        g = _silu(x_sel @ w_gate)
        u = x_sel @ w_up
        y = (g * u) @ w_down
        r_sel = _sigmoid((lambda x, i, axis: torch.take_along_dim(x, i, dim=axis))(r, idx, axis=1))
        y = y * r_sel.reshape(B, C, 1)
        b_off = (torch.arange(B) * S).reshape(B, 1)
        flat_idx = (idx + b_off).reshape(B * C)
        zero = (x * 0.0).reshape(B * S, D)
        upd = _scatter_add(zero, flat_idx, y.reshape(B * C, D), axis=0)
        return x + upd.reshape(B, S, D)

    x = A_x
    h = x + _A_ref(_layernorm(x, axis=-1), A_wq, A_wk, A_wv, A_wo)
    h2 = h + _B_ref(_layernorm(h, axis=-1), B_w_r, B_w_gate, B_w_up, B_w_down)
    return h2
```

```asm
; @launch grid=(256,1,1) block=(256,1,1) lds=163840
.amdgcn_target "amdgcn-amd-amdhsa--gfx950"
.text
.globl sequential_preLN__grouped_kv_mqa__moe_arch_mod__prompt_kernel
.p2align 8
.type sequential_preLN__grouped_kv_mqa__moe_arch_mod__prompt_kernel,@function
sequential_preLN__grouped_kv_mqa__moe_arch_mod__prompt_kernel:
    s_cmp_ge_u32 s2, 256
    s_cbranch_scc1 L_end
    s_load_dwordx8 s[64:71], s[0:1], 0
    s_getpc_b64 s[96:97]
L_pc:
    s_and_b32 s62, s2, 0xf8
    v_lshl_add_u32 v4, s62, 5, v0
    v_min_u32 v4, (L_end-L_pc)/8, v4
    v_mov_b32 v5, 0
    v_lshl_add_u64 v[82:83], v[4:5], 3, s[96:97]
    global_load_dword v159, v[82:83], off
    v_lshrrev_b32 v2, 6, v0
    v_and_b32 v1, 63, v0
    v_readfirstlane_b32 s3, v2
    s_and_b32 s55, s2, 7
    s_bfe_u32 s62, s2, 0x20003
    s_lshl2_add_u32 s52, s55, s62
    s_lshr_b32 s53, s2, 5
    s_lshl3_add_u32 s54, s52, s53
    s_and_b32 s61, s53, 1
    v_lshrrev_b32 v2, 5, v1
    v_and_b32 v3, 31, v1
    v_lshlrev_b32 v4, 7, v3
    s_lshl_b32 s63, s61, 3
    v_xor_b32 v3, v3, v2
    v_xor_b32 v3, s63, v3
    v_lshlrev_b32 v3, 4, v3
    v_lshl_add_u32 v72, v2, 11, v3
    v_xor_b32 v73, 32, v72
    v_xor_b32 v74, 64, v72
    v_xor_b32 v75, 96, v72
    s_lshl_b32 s90, s54, 5
    s_add_u32 s90, s90, s3
    s_lshl_b32 s90, s90, 9
    s_mul_i32 s94, s3, 24576
    s_lshl_b32 s93, s61, 12
    s_add_u32 s93, s93, s94
    s_mov_b32 m0, s93
    s_lshr_b32 s91, s53, 1
    s_lshl2_add_u32 s91, s91, s62
    s_lshr_b32 s63, s3, 1
    s_lshl1_add_u32 s95, s2, s63
    s_mov_b32 s6, 0x400000
    s_mov_b32 s7, 0x20000
    s_mov_b32 s50, 0x200000
    s_mov_b32 s51, 0x20000
    s_cmp_eq_u32 s3, 0
    s_cmov_b32 s50, 0x10000
    s_cmov_b32 s95, s91
    s_lshl_b32 s95, s95, 12
    s_add_u32 s91, s90, 3072
    s_add_u32 s92, s90, 6144
    s_add_u32 s63, s90, 9216
    s_cmp_eq_u32 s61, 1
    s_waitcnt lgkmcnt(0)
    s_cselect_b64 s[12:13], s[70:71], s[68:69]
    s_cmp_eq_u32 s3, 0
    s_cselect_b64 s[48:49], s[12:13], s[66:67]
    s_mov_b64 s[4:5], s[64:65]
    buffer_load_dword v159, v4, s[48:51], s95 offen
    buffer_load_dwordx4 v72, s[4:7], s90 offen offset:0 nt lds
    buffer_load_dwordx4 v73, s[4:7], s91 offen offset:1024 nt lds
    buffer_load_dwordx4 v74, s[4:7], s92 offen offset:2048 nt lds
    buffer_load_dwordx4 v75, s[4:7], s63 offen offset:3072 nt lds
    s_load_dwordx8 s[72:79], s[0:1], 32
    s_load_dwordx8 s[80:87], s[0:1], 64
    s_load_dwordx2 s[88:89], s[0:1], 96
    s_xor_b32 m0, s93, 0x1000
    v_xor_b32 v72, 128, v72
    s_xor_b32 s90, s90, 0x4000
    v_xor_b32 v73, 128, v73
    s_xor_b32 s91, s91, 0x4000
    v_xor_b32 v74, 128, v74
    s_xor_b32 s92, s92, 0x4000
    v_xor_b32 v75, 128, v75
    s_xor_b32 s63, s63, 0x4000
    buffer_load_dwordx4 v72, s[4:7], s90 offen offset:0 nt lds
    buffer_load_dwordx4 v73, s[4:7], s91 offen offset:1024 nt lds
    buffer_load_dwordx4 v74, s[4:7], s92 offen offset:2048 nt lds
    buffer_load_dwordx4 v75, s[4:7], s63 offen offset:3072 nt lds
    s_and_b32 s58, s53, 3
    v_lshlrev_b32 v6, 4, v1
    v_mov_b64 v[84:85], -1
    v_mov_b64 v[86:87], -1
    s_mov_b32 s14, 0x10000
    s_mov_b32 s15, 0x20000
    s_waitcnt lgkmcnt(0)
    s_mov_b64 s[44:45], s[88:89]
    s_mov_b32 s46, 9437184
    s_mov_b32 s47, 0x20000
    s_cmp_eq_u32 s3, 3
    s_cselect_b32 s59, s2, 255
    s_cmp_lt_u32 s59, 8
    s_cbranch_scc0 L_noclr
    s_mul_i32 s62, s2, 3072
    s_add_u32 s62, s62, 262144
    buffer_store_dwordx4 v[84:87], v6, s[44:47], s62 offen offset:0 sc1
    buffer_store_dwordx4 v[84:87], v6, s[44:47], s62 offen offset:1024 sc1
    buffer_store_dwordx4 v[84:87], v6, s[44:47], s62 offen offset:2048 sc1
L_noclr:
    s_mov_b64 s[16:17], s[72:73]
    s_mov_b32 s18, 2097152
    s_mov_b32 s19, 0x20000
    s_mov_b64 s[20:21], s[76:77]
    s_mov_b32 s22, 2048
    s_mov_b32 s23, 0x20000
    s_mov_b64 s[36:37], s[84:85]
    s_mov_b32 s38, 4194304
    s_mov_b32 s39, 0x20000
    s_mov_b64 s[40:41], s[86:87]
    s_mov_b32 s42, 256
    s_mov_b32 s43, 0x20000
    s_getreg_b32 s60, hwreg(HW_REG_XCC_ID)
    s_and_b32 s60, s60, 0xff
    s_or_b32 s60, s60, 0x100
    s_and_b32 s62, s52, 3
    s_lshr_b32 s63, s53, 2
    s_lshl1_add_u32 s62, s62, s63
    s_mul_i32 s56, s55, 7
    s_add_u32 s56, s56, s62
    s_lshl2_add_u32 s63, s55, s58
    s_cmp_eq_u32 s62, 7
    s_cselect_b32 s57, 1, 0
    s_cselect_b32 s56, s63, s56
    s_cselect_b32 s62, 0, 0x700000
    s_mov_b64 s[24:25], s[78:79]
    s_mov_b32 s26, s62
    s_mov_b32 s27, 0x20000
    s_mov_b64 s[28:29], s[80:81]
    s_mov_b32 s30, s62
    s_mov_b32 s31, 0x20000
    s_mov_b64 s[32:33], s[82:83]
    s_mov_b32 s34, s62
    s_mov_b32 s35, 0x20000
    s_lshl_b32 s88, s52, 17
    s_mov_b64 s[48:49], s[66:67]
    s_mov_b32 s50, 0x200000
    s_lshl_b32 s80, s3, 11
    s_lshl1_add_u32 s81, s80, 8192
    s_lshl4_add_u32 s62, s80, s88
    s_lshl_b32 s63, s53, 8
    s_lshl4_add_u32 s63, s80, s63
    v_lshlrev_b32 v2, 5, v2
    v_xor_b32 v80, v6, v2
    v_lshrrev_b32 v2, 4, v1
    v_and_b32 v3, 7, v1
    v_lshlrev_b32 v192, 5, v3
    v_and_b32 v194, 511, v6
    v_xor_b32 v3, v3, v2
    v_lshlrev_b32 v3, 4, v3
    v_lshrrev_b32 v4, 3, v1
    v_lshl_add_u32 v3, v4, 11, v3
    v_add_u32 v234, s62, v3
    v_xor_b32 v235, 64, v234
    v_add_u32 v235, 15360, v235
    v_and_b32 v4, 15, v1
    v_lshlrev_b32 v5, 2, v2
    v_xor_b32 v4, v4, v5
    v_lshlrev_b32 v4, 4, v4
    v_lshl_add_u32 v4, v2, 11, v4
    v_add_u32 v248, s63, v4
    v_add_u32 v249, 7168, v248
    v_add_u32 v250, 14336, v248
    v_add_u32 v251, 21504, v248
    s_mul_i32 s62, s53, 2
    s_mul_i32 s63, s52, 4
    s_cmp_eq_u32 s58, 1
    s_cselect_b32 s63, s63, 0
    s_add_u32 s62, s62, s63
    s_and_b32 s62, s62, 15
    s_lshl_b32 s11, s62, 7
    s_lshl_b32 s82, s3, 13
    s_lshl_b32 s0, s3, 14
    s_add_u32 s89, s0, 98304
    s_xor_b32 s62, s0, 0x4000
    s_add_u32 s62, s62, 98304
    v_add_u32 v252, s89, v6
    v_add_u32 v253, s62, v6
    v_and_b32 v2, 15, v1
    v_lshrrev_b32 v3, 4, v1
    v_xor_b32 v4, v2, v3
    v_lshlrev_b32 v4, 4, v4
    v_lshl_add_u32 v4, v2, 9, v4
    v_add_u32 v88, s94, v4
    v_xor_b32 v89, 64, v88
    v_xor_b32 v90, 128, v88
    v_xor_b32 v91, 192, v88
    v_bfe_u32 v4, v1, 2, 2
    v_lshl_add_u32 v4, v3, 3, v4
    v_lshlrev_b32 v4, 6, v4
    v_and_b32 v5, 3, v1
    v_lshl_add_u32 v4, v5, 3, v4
    v_and_b32 v5, 1, v3
    v_lshl_add_u32 v4, v5, 5, v4
    s_add_u32 s62, s94, 8192
    v_add_u32 v92, s62, v4
    v_xor_b32 v93, 32, v92
    s_lshl_b32 s62, s3, 11
    s_add_u32 s62, s62, 147456
    v_add_u32 v96, s62, v6
    s_lshl_b32 s62, s3, 7
    s_add_u32 s63, s62, 155648
    v_lshl_add_u32 v97, v2, 2, s63
    s_add_u32 s63, s62, 156160
    v_lshl_add_u32 v98, v2, 3, s63
    v_lshlrev_b32 v4, 3, v2
    v_lshl_add_u32 v193, v5, 7, v4
    v_lshlrev_b32 v195, 4, v0
    v_mov_b32 v99, 0x3f803f80
    v_mov_b64 v[94:95], 0
    v_cmp_gt_u32 vcc, 2, v2
    v_and_b32 v4, 14, v1
    v_cmp_eq_u32 s[96:97], 4, v4
    v_cndmask_b32 v100, 0, v99, vcc
    v_cndmask_b32 v101, 0, v99, vcc
    v_cndmask_b32 v102, 0, v99, vcc
    v_cndmask_b32 v103, 0, v99, vcc
    v_mov_b64 v[220:221], v[100:101]
    v_cndmask_b32 v222, 0, v99, s[96:97]
    v_cndmask_b32 v223, 0, v99, s[96:97]
    v_cmp_eq_u32 vcc, 0, v2
    v_cmp_eq_u32 s[96:97], 4, v2
    v_and_b32 v4, 1, v1
    v_cndmask_b32 v152, 0, v99, vcc
    v_cndmask_b32 v153, 0, v99, vcc
    v_cndmask_b32 v154, 0, v99, s[96:97]
    v_cndmask_b32 v155, 0, v99, s[96:97]
    v_mul_u32_u24 v4, 0xaaaa, v4
    v_add_u32 v219, 0x4444, v4
    v_mov_b32 v7, 0xdddddddd
    v_mov_b64 v[16:17], 0
    v_mov_b64 v[18:19], 0
    v_mov_b64 v[20:21], 0
    v_mov_b64 v[22:23], 0
    v_mov_b64 v[224:225], 0
    v_mov_b64 v[226:227], 0
    v_mov_b64 v[238:239], 0
    v_mov_b64 v[242:243], 0
    v_mov_b64 v[246:247], 0
    v_lshlrev_b32 v196, 2, v1
    v_lshrrev_b32 v2, 2, v1
    v_and_b32 v3, 3, v1
    s_lshr_b32 s62, s3, 1
    s_and_b32 s63, s3, 1
    s_lshl_b32 s8, s52, 1
    s_lshr_b32 s9, s53, 2
    s_add_u32 s8, s8, s9
    s_lshl_b32 s8, s8, 12
    s_bfe_u32 s9, s53, 0x10001
    v_lshlrev_b32 v4, 2, v2
    v_lshl_add_u32 v197, v2, 1, v3
    v_lshlrev_b32 v197, 2, v197
    s_bitcmp1_b32 s53, 0
    s_cbranch_scc1 L_setv
    s_lshl1_add_u32 s9, s3, s9
    s_lshl_b32 s9, s9, 8
    v_and_b32 v4, 2, v1
    v_add_u32 v4, s63, v4
    v_lshl_add_u32 v4, s62, 2, v4
    v_and_b32 v3, 1, v1
    v_lshlrev_b32 v3, 3, v3
    v_lshl_add_u32 v186, v4, 4, v3
    v_lshl_add_u32 v3, v2, 4, v3
    v_lshl_add_u32 v184, v4, 8, v3
    v_lshlrev_b32 v188, 3, v2
    v_add_u32 v185, 147460, v184
    v_add_u32 v187, 155652, v186
    v_add_u32 v189, 156160, v188
    s_branch L_setk
L_setv:
    s_lshl2_add_u32 s9, s9, s3
    s_add_u32 s9, s9, 8
    s_lshl_b32 s9, s9, 8
    v_lshl_add_u32 v186, s63, 6, v4
    v_lshl_add_u32 v3, s62, 2, v3
    v_lshlrev_b32 v188, 4, v3
    v_and_b32 v4, 12, v4
    v_lshl_add_u32 v4, v3, 5, v4
    v_lshrrev_b32 v2, 2, v2
    v_lshl_add_u32 v4, v2, 8, v4
    v_lshl_add_u32 v184, s63, 10, v4
    v_add_u32 v185, 147472, v184
    v_add_u32 v187, 155648, v186
    v_add_u32 v189, 156168, v188
L_setk:
    s_add_u32 s8, s8, s9
    v_add_u32 v184, 147456, v184
    v_add_u32 v186, 155648, v186
    v_add_u32 v188, 156160, v188
    s_mul_i32 s62, s54, 48
    s_sub_u32 s62, 0x4000, s62
    v_writelane_b32 v197, s62, 2
    v_lshrrev_b32 v3, 5, v1
    v_bfe_u32 v2, v1, 2, 2
    v_lshl_add_u32 v4, v3, 3, v2
    v_lshlrev_b32 v216, 8, v4
    v_lshl_add_u32 v4, v3, 4, v2
    v_lshlrev_b32 v158, 6, v4
    v_xor_b32 v2, s3, v2
    v_lshl_add_u32 v216, v2, 6, v216
    v_lshl_add_u32 v158, v5, 8, v158
    v_and_b32 v4, 3, v1
    v_lshlrev_b32 v4, 3, v4
    v_lshl_add_u32 v4, v5, 5, v4
    v_add_u32 v4, v216, v4
    v_add_u32 v216, 8192, v4
    v_add_u32 v217, 57344, v4
    v_add_u32 v218, 106496, v4
    v_and_b32 v4, 3, v1
    v_lshl_add_u32 v158, v4, 4, v158
    v_add_u32 v158, s89, v158
    s_mov_b32 s93, 278528
    s_lshl_b32 s9, s54, 6
    s_add_u32 s9, s9, 262144
    s_lshl_b32 s92, s52, 9
    s_add_u32 s92, s92, 262144
    s_lshl_b32 s62, s55, 9
    v_add_u32 v194, s62, v194
    v_and_b32 v2, 31, v1
    v_bfe_u32 v4, v1, 1, 3
    v_xor_b32 v4, v4, v3
    v_lshlrev_b32 v4, 4, v4
    v_lshl_add_u32 v204, v2, 7, v4
    v_xor_b32 v205, 32, v204
    v_xor_b32 v206, 64, v204
    v_xor_b32 v207, 96, v204
    v_add_u32 v208, 49152, v204
    v_add_u32 v209, 49152, v205
    v_add_u32 v210, 49152, v206
    v_add_u32 v211, 49152, v207
    v_add_u32 v212, 98304, v204
    v_add_u32 v213, 98304, v205
    v_add_u32 v214, 98304, v206
    v_add_u32 v215, 98304, v207
    s_add_u32 m0, s94, 8192
    s_add_u32 s95, s0, 0
    buffer_load_dwordx4 v80, s[12:15], s95 offen offset:0 lds
    buffer_load_dwordx4 v80, s[12:15], s95 offen offset:1024 lds
    v_lshlrev_b32 v5, 1, v3
    v_xor_b32 v4, v2, v5
    v_lshlrev_b32 v4, 4, v4
    v_lshl_add_u32 v168, v3, 11, v4
    v_xor_b32 v4, 64, v168
    v_add_u32 v169, 3072, v4
    v_add_u32 v170, 6144, v168
    v_add_u32 v171, 9216, v4
    s_lshl_b32 s62, s53, 8
    s_lshl_b32 s63, s3, 6
    s_add_u32 s62, s62, s63
    v_lshrrev_b32 v2, 2, v1
    v_and_b32 v3, 3, v1
    v_lshlrev_b32 v4, 4, v3
    v_lshl_add_u32 v4, v2, 11, v4
    v_add_u32 v160, s62, v4
    v_add_u32 v161, 31744, v160
    v_add_u32 v162, 63488, v160
    v_add_u32 v163, 95232, v160
    v_lshrrev_b32 v2, 3, v1
    v_mul_u32_u24 v2, 7168, v2
    v_bfe_u32 v4, v1, 4, 1
    v_lshlrev_b32 v4, 1, v4
    v_and_b32 v5, 7, v1
    v_xor_b32 v4, v4, v5
    v_lshl_add_u32 v164, v4, 4, v2
    v_xor_b32 v2, 64, v164
    v_add_u32 v165, 56320, v2
    v_add_u32 v166, 112640, v164
    v_add_u32 v167, 168960, v2
    s_mov_b32 s90, s82
    s_lshl2_add_u32 s62, s58, s3
    s_mul_i32 s62, s62, 458752
    s_lshl_b32 s63, s56, 7
    s_add_u32 s84, s62, s63
    s_add_u32 s85, s84, 229376
    s_lshl2_add_u32 s62, s56, s3
    s_lshl_b32 s62, s62, 15
    s_lshl_b32 s63, s58, 9
    s_add_u32 s86, s62, s63
    s_add_u32 s87, s86, 16384
    s_and_b32 s62, s3, 1
    s_lshl_b32 s62, s62, 17
    v_add_u32 v156, s62, v6
    v_add_u32 v157, 0x10000, v156
    s_mov_b32 s65, 4096
    s_mov_b32 s66, 8192
    s_mov_b32 s67, 12288
    s_mov_b32 s68, 16384
    s_mov_b32 s69, 20480
    s_mov_b32 s70, 24576
    s_mov_b32 s71, 28672
    s_mov_b32 s72, 32768
    s_mov_b32 s73, 36864
    s_mov_b32 s74, 40960
    s_mov_b32 s75, 45056
    s_mov_b32 s76, 49152
    s_mov_b32 s77, 53248
    s_mov_b32 s78, 57344
    s_mov_b32 s79, 61440
    v_mov_b64 v[136:137], 0
    v_mov_b64 v[138:139], 0
    v_mov_b64 v[140:141], 0
    v_mov_b64 v[142:143], 0
    v_mov_b64 v[144:145], 0
    v_mov_b64 v[146:147], 0
    v_mov_b64 v[148:149], 0
    v_mov_b64 v[150:151], 0
    buffer_load_dwordx4 v80, s[12:15], s95 offen offset:2048 lds
    buffer_load_dwordx4 v80, s[12:15], s95 offen offset:3072 lds
    s_waitcnt vmcnt(4)
    ds_read_b128 v[40:43], v88 offset:0
    ds_read_b128 v[44:47], v89 offset:0
    ds_read_b128 v[48:51], v90 offset:0
    ds_read_b128 v[52:55], v91 offset:0
    ds_read_b128 v[56:59], v88 offset:256
    ds_read_b128 v[60:63], v89 offset:256
    ds_read_b128 v[64:67], v90 offset:256
    ds_read_b128 v[68:71], v91 offset:256
    s_cmp_lt_u32 s59, 8
    s_cbranch_scc0 L_nogo
    s_lshl_b32 s62, s2, 5
    s_waitcnt vmcnt(4)
    s_mov_b64 exec, 1
    buffer_store_dword v84, v6, s[40:43], s62 offen sc1
    s_mov_b64 exec, -1
L_nogo:
    s_add_u32 m0, s94, 12288
    s_add_u32 s95, s0, 4096
    buffer_load_dwordx4 v80, s[12:15], s95 offen offset:0 lds
    buffer_load_dwordx4 v80, s[12:15], s95 offen offset:1024 lds
    buffer_load_dwordx4 v80, s[12:15], s95 offen offset:2048 lds
    buffer_load_dwordx4 v80, s[12:15], s95 offen offset:3072 lds
    s_add_u32 m0, s94, 16384
    s_add_u32 s95, s0, 8192
    buffer_load_dwordx4 v80, s[12:15], s95 offen offset:0 lds
    buffer_load_dwordx4 v80, s[12:15], s95 offen offset:1024 lds
    s_waitcnt lgkmcnt(6)
    v_dot2c_f32_bf16 v94, v99, v40
    v_dot2c_f32_bf16 v95, v40, v40
    v_dot2c_f32_bf16 v94, v99, v41
    v_dot2c_f32_bf16 v95, v41, v41
    buffer_load_dwordx4 v80, s[12:15], s95 offen offset:2048 lds
    v_dot2c_f32_bf16 v94, v99, v42
    v_dot2c_f32_bf16 v95, v42, v42
    v_dot2c_f32_bf16 v94, v99, v43
    v_dot2c_f32_bf16 v95, v43, v43
    v_dot2c_f32_bf16 v94, v99, v44
    v_dot2c_f32_bf16 v95, v44, v44
    buffer_load_dwordx4 v80, s[12:15], s95 offen offset:3072 lds
    v_dot2c_f32_bf16 v94, v99, v45
    v_dot2c_f32_bf16 v95, v45, v45
    v_dot2c_f32_bf16 v94, v99, v46
    v_dot2c_f32_bf16 v95, v46, v46
    v_dot2c_f32_bf16 v94, v99, v47
    v_dot2c_f32_bf16 v95, v47, v47
    s_add_u32 m0, s94, 20480
    s_add_u32 s95, s0, 12288
    buffer_load_dwordx4 v80, s[12:15], s95 offen offset:0 lds
    s_waitcnt lgkmcnt(4)
    v_dot2c_f32_bf16 v94, v99, v48
    v_dot2c_f32_bf16 v95, v48, v48
    v_dot2c_f32_bf16 v94, v99, v49
    v_dot2c_f32_bf16 v95, v49, v49
    buffer_load_dwordx4 v80, s[12:15], s95 offen offset:1024 lds
    v_dot2c_f32_bf16 v94, v99, v50
    v_dot2c_f32_bf16 v95, v50, v50
    v_dot2c_f32_bf16 v94, v99, v51
    v_dot2c_f32_bf16 v95, v51, v51
    v_dot2c_f32_bf16 v94, v99, v52
    v_dot2c_f32_bf16 v95, v52, v52
    buffer_load_dwordx4 v80, s[12:15], s95 offen offset:2048 lds
    v_dot2c_f32_bf16 v94, v99, v53
    v_dot2c_f32_bf16 v95, v53, v53
    v_dot2c_f32_bf16 v94, v99, v54
    v_dot2c_f32_bf16 v95, v54, v54
    v_dot2c_f32_bf16 v94, v99, v55
    v_dot2c_f32_bf16 v95, v55, v55
    buffer_load_dwordx4 v80, s[12:15], s95 offen offset:3072 lds
    s_waitcnt lgkmcnt(2)
    v_dot2c_f32_bf16 v94, v99, v56
    v_dot2c_f32_bf16 v95, v56, v56
    v_dot2c_f32_bf16 v94, v99, v57
    v_dot2c_f32_bf16 v95, v57, v57
    s_add_u32 m0, s81, 98304
    s_lshl_b32 s83, s11, 10
    buffer_load_dwordx4 v248, s[48:51], s83 offen offset:0 lds
    v_dot2c_f32_bf16 v94, v99, v58
    v_dot2c_f32_bf16 v95, v58, v58
    v_dot2c_f32_bf16 v94, v99, v59
    v_dot2c_f32_bf16 v95, v59, v59
    buffer_load_dwordx4 v249, s[48:51], s83 offen offset:1024 lds
    v_dot2c_f32_bf16 v94, v99, v60
    v_dot2c_f32_bf16 v95, v60, v60
    v_dot2c_f32_bf16 v94, v99, v61
    v_dot2c_f32_bf16 v95, v61, v61
    buffer_load_dwordx4 v250, s[48:51], s83 offen offset:2048 lds
    v_dot2c_f32_bf16 v94, v99, v62
    v_dot2c_f32_bf16 v95, v62, v62
    v_dot2c_f32_bf16 v94, v99, v63
    v_dot2c_f32_bf16 v95, v63, v63
    s_waitcnt vmcnt(15)
    ds_read_b64_tr_b16 a[96:97], v92 offset:0
    ds_read_b64_tr_b16 a[98:99], v92 offset:256
    ds_read_b64_tr_b16 a[128:129], v93 offset:0
    ds_read_b64_tr_b16 a[130:131], v93 offset:256
    ds_read_b64_tr_b16 a[100:101], v92 offset:2048
    ds_read_b64_tr_b16 a[102:103], v92 offset:2304
    ds_read_b64_tr_b16 a[132:133], v93 offset:2048
    ds_read_b64_tr_b16 a[134:135], v93 offset:2304
    buffer_load_dwordx4 v251, s[48:51], s83 offen offset:3072 lds
    s_add_u32 m0, s80, 98304
    s_add_u32 s83, s83, 0x20000
    s_waitcnt lgkmcnt(8)
    v_dot2c_f32_bf16 v94, v99, v64
    v_dot2c_f32_bf16 v95, v64, v64
    buffer_load_dwordx4 v234, s[4:7], s11 offen offset:0 lds
    s_and_b32 s83, s83, 0x1fffff
    v_dot2c_f32_bf16 v94, v99, v65
    v_dot2c_f32_bf16 v95, v65, v65
    v_dot2c_f32_bf16 v94, v99, v66
    v_dot2c_f32_bf16 v95, v66, v66
    buffer_load_dwordx4 v235, s[4:7], s11 offen offset:1024 lds
    s_add_u32 m0, s81, 122880
    s_lshr_b32 s11, s83, 10
    v_dot2c_f32_bf16 v94, v99, v67
    v_dot2c_f32_bf16 v95, v67, v67
    v_dot2c_f32_bf16 v94, v99, v68
    v_dot2c_f32_bf16 v95, v68, v68
    s_waitcnt vmcnt(14)
    ds_read_b64_tr_b16 a[104:105], v92 offset:4096
    ds_read_b64_tr_b16 a[106:107], v92 offset:4352
    ds_read_b64_tr_b16 a[136:137], v93 offset:4096
    ds_read_b64_tr_b16 a[138:139], v93 offset:4352
    ds_read_b64_tr_b16 a[108:109], v92 offset:6144
    ds_read_b64_tr_b16 a[110:111], v92 offset:6400
    ds_read_b64_tr_b16 a[140:141], v93 offset:6144
    ds_read_b64_tr_b16 a[142:143], v93 offset:6400
    buffer_load_dwordx4 v248, s[48:51], s83 offen offset:0 lds
    v_dot2c_f32_bf16 v94, v99, v69
    v_dot2c_f32_bf16 v95, v69, v69
    v_dot2c_f32_bf16 v94, v99, v70
    v_dot2c_f32_bf16 v95, v70, v70
    buffer_load_dwordx4 v249, s[48:51], s83 offen offset:1024 lds
    v_dot2c_f32_bf16 v94, v99, v71
    v_dot2c_f32_bf16 v95, v71, v71
    buffer_load_dwordx4 v250, s[48:51], s83 offen offset:2048 lds
    s_waitcnt vmcnt(13)
    ds_read_b64_tr_b16 a[112:113], v92 offset:8192
    ds_read_b64_tr_b16 a[114:115], v92 offset:8448
    ds_read_b64_tr_b16 a[144:145], v93 offset:8192
    ds_read_b64_tr_b16 a[146:147], v93 offset:8448
    ds_read_b64_tr_b16 a[116:117], v92 offset:10240
    ds_read_b64_tr_b16 a[118:119], v92 offset:10496
    ds_read_b64_tr_b16 a[148:149], v93 offset:10240
    ds_read_b64_tr_b16 a[150:151], v93 offset:10496
    buffer_load_dwordx4 v251, s[48:51], s83 offen offset:3072 lds
    s_add_u32 m0, s80, 122880
    s_add_u32 s83, s83, 0x20000
    buffer_load_dwordx4 v234, s[4:7], s11 offen offset:0 lds
    s_and_b32 s83, s83, 0x1fffff
    buffer_load_dwordx4 v235, s[4:7], s11 offen offset:1024 lds
    s_add_u32 m0, s81, 0
    s_lshr_b32 s11, s83, 10
    s_waitcnt vmcnt(12)
    ds_read_b64_tr_b16 a[120:121], v92 offset:12288
    ds_read_b64_tr_b16 a[122:123], v92 offset:12544
    ds_read_b64_tr_b16 a[152:153], v93 offset:12288
    ds_read_b64_tr_b16 a[154:155], v93 offset:12544
    ds_read_b64_tr_b16 a[124:125], v92 offset:14336
    ds_read_b64_tr_b16 a[126:127], v92 offset:14592
    ds_read_b64_tr_b16 a[156:157], v93 offset:14336
    ds_read_b64_tr_b16 a[158:159], v93 offset:14592
    v_mov_b32 v2, v94
    v_mov_b32 v3, v95
    s_nop 0
    v_permlane16_swap_b32 v94, v2
    v_permlane16_swap_b32 v95, v3
    v_add_f32 v94, v94, v2
    v_add_f32 v95, v95, v3
    v_mov_b32 v2, v94
    v_mov_b32 v3, v95
    s_nop 0
    v_permlane32_swap_b32 v94, v2
    v_permlane32_swap_b32 v95, v3
    v_add_f32 v94, v94, v2
    v_add_f32 v95, v95, v3
    s_waitcnt lgkmcnt(0)
    s_barrier
    v_mfma_f32_16x16x32_bf16 v[8:11], a[96:99], v[40:43], 0
    v_mfma_f32_16x16x32_bf16 v[8:11], a[100:103], v[44:47], v[8:11]
    v_smfmac_f32_16x16x64_bf16 v[16:19], v[100:103], a[96:103], v219
    buffer_load_dwordx4 v248, s[48:51], s83 offen offset:0 lds
    v_mfma_f32_16x16x32_bf16 v[12:15], a[128:131], v[40:43], 0
    v_mfma_f32_16x16x32_bf16 v[12:15], a[132:135], v[44:47], v[12:15]
    v_smfmac_f32_16x16x64_bf16 v[20:23], v[100:103], a[128:135], v219
    buffer_load_dwordx4 v249, s[48:51], s83 offen offset:1024 lds
    v_mfma_f32_16x16x32_bf16 v[8:11], a[104:107], v[48:51], v[8:11]
    v_mfma_f32_16x16x32_bf16 v[8:11], a[108:111], v[52:55], v[8:11]
    v_smfmac_f32_16x16x64_bf16 v[16:19], v[100:103], a[104:111], v219
    buffer_load_dwordx4 v250, s[48:51], s83 offen offset:2048 lds
    v_mfma_f32_16x16x32_bf16 v[12:15], a[136:139], v[48:51], v[12:15]
    v_mfma_f32_16x16x32_bf16 v[12:15], a[140:143], v[52:55], v[12:15]
    v_smfmac_f32_16x16x64_bf16 v[20:23], v[100:103], a[136:143], v219
    buffer_load_dwordx4 v251, s[48:51], s83 offen offset:3072 lds
    s_add_u32 m0, s80, 0
    s_add_u32 s83, s83, 0x20000
    v_mfma_f32_16x16x32_bf16 v[8:11], a[112:115], v[56:59], v[8:11]
    v_mfma_f32_16x16x32_bf16 v[8:11], a[116:119], v[60:63], v[8:11]
    v_smfmac_f32_16x16x64_bf16 v[16:19], v[100:103], a[112:119], v219
    buffer_load_dwordx4 v234, s[4:7], s11 offen offset:0 lds
    s_and_b32 s83, s83, 0x1fffff
    v_mfma_f32_16x16x32_bf16 v[12:15], a[144:147], v[56:59], v[12:15]
    v_mfma_f32_16x16x32_bf16 v[12:15], a[148:151], v[60:63], v[12:15]
    v_smfmac_f32_16x16x64_bf16 v[20:23], v[100:103], a[144:151], v219
    buffer_load_dwordx4 v235, s[4:7], s11 offen offset:1024 lds
    s_add_u32 m0, s81, 24576
    s_lshr_b32 s11, s83, 10
    v_mfma_f32_16x16x32_bf16 v[8:11], a[120:123], v[64:67], v[8:11]
    v_mfma_f32_16x16x32_bf16 v[8:11], a[124:127], v[68:71], v[8:11]
    v_smfmac_f32_16x16x64_bf16 v[16:19], v[100:103], a[120:127], v219
    buffer_load_dwordx4 v248, s[48:51], s83 offen offset:0 lds
    v_mfma_f32_16x16x32_bf16 v[12:15], a[152:155], v[64:67], v[12:15]
    v_mfma_f32_16x16x32_bf16 v[12:15], a[156:159], v[68:71], v[12:15]
    v_smfmac_f32_16x16x64_bf16 v[20:23], v[100:103], a[152:159], v219
    buffer_load_dwordx4 v249, s[48:51], s83 offen offset:1024 lds
    s_lshl2_add_u32 s62, s2, s3
    s_lshl_b32 s62, s62, 6
    s_add_u32 s62, s62, 327680
    ds_write_b64 v98, v[94:95]
    ds_write_b128 v96, v[8:11]
    s_nop 0
    ds_write_b128 v96, v[12:15] offset:1024
    v_add_f32 v16, v16, v17
    v_add_f32 v20, v20, v21
    s_mov_b64 exec, 0xffff
    ds_write2_b32 v97, v16, v20 offset1:16
    s_mov_b64 exec, -1
    s_waitcnt lgkmcnt(0)
    s_barrier
    ds_read_b64 v[104:105], v188 offset:0
    ds_read_b64 v[106:107], v188 offset:128
    ds_read_b64 v[108:109], v188 offset:256
    ds_read_b64 v[110:111], v188 offset:384
    ds_read_b64 v[112:113], v189 offset:0
    ds_read_b64 v[114:115], v189 offset:128
    ds_read_b64 v[116:117], v189 offset:256
    ds_read_b64 v[118:119], v189 offset:384
    ds_read_b32 v24, v184 offset:0
    ds_read_b32 v32, v186 offset:0
    ds_read_b32 v25, v185 offset:0
    ds_read_b32 v33, v187 offset:0
    ds_read_b32 v26, v184 offset:2048
    ds_read_b32 v34, v186 offset:128
    ds_read_b32 v27, v185 offset:2048
    ds_read_b32 v35, v187 offset:128
    ds_read_b32 v28, v184 offset:4096
    ds_read_b32 v36, v186 offset:256
    ds_read_b32 v29, v185 offset:4096
    ds_read_b32 v37, v187 offset:256
    ds_read_b32 v30, v184 offset:6144
    ds_read_b32 v38, v186 offset:384
    ds_read_b32 v31, v185 offset:6144
    ds_read_b32 v39, v187 offset:384
    buffer_load_dword v191, v192, s[40:43], 0 offen sc1
    s_mov_b64 exec, 15
    buffer_store_dwordx4 v[84:87], v6, s[44:47], s62 offen sc1
    s_mov_b64 exec, -1
    s_waitcnt lgkmcnt(14)
    v_pk_add_f32 v[104:105], v[104:105], v[106:107]
    v_pk_add_f32 v[108:109], v[108:109], v[110:111]
    v_pk_add_f32 v[104:105], v[104:105], v[108:109]
    v_pk_add_f32 v[112:113], v[112:113], v[114:115]
    v_pk_add_f32 v[116:117], v[116:117], v[118:119]
    v_pk_add_f32 v[112:113], v[112:113], v[116:117]
    v_mul_f32 v120, 0x3a800000, v104
    v_mul_f32 v121, 0x3a800000, v112
    v_mul_f32 v2, 0x3a800000, v105
    v_mul_f32 v3, 0x3a800000, v113
    v_fma_f32 v2, -v120, v120, v2
    v_fma_f32 v3, -v121, v121, v3
    buffer_load_dwordx4 v250, s[48:51], s83 offen offset:2048 lds
    v_max_f32 v2, 0, v2
    v_max_f32 v3, 0, v3
    v_cvt_pk_bf16_f32 v2, v2, v2
    v_cvt_pk_bf16_f32 v3, v3, v3
    v_and_b32 v2, 0xffff0000, v2
    v_and_b32 v3, 0xffff0000, v3
    buffer_load_dwordx4 v251, s[48:51], s83 offen offset:3072 lds
    s_add_u32 m0, s80, 24576
    s_add_u32 s83, s83, 0x20000
    v_add_f32 v2, 0x3727c5ac, v2
    v_add_f32 v3, 0x3727c5ac, v3
    v_cvt_pk_bf16_f32 v2, v2, v2
    v_cvt_pk_bf16_f32 v3, v3, v3
    v_and_b32 v2, 0xffff0000, v2
    v_and_b32 v3, 0xffff0000, v3
    buffer_load_dwordx4 v234, s[4:7], s11 offen offset:0 lds
    s_and_b32 s83, s83, 0x1fffff
    v_sqrt_f32 v2, v2
    v_sqrt_f32 v3, v3
    v_cvt_pk_bf16_f32 v120, v120, v120
    v_cvt_pk_bf16_f32 v121, v121, v121
    v_and_b32 v120, 0xffff0000, v120
    v_and_b32 v121, 0xffff0000, v121
    buffer_load_dwordx4 v235, s[4:7], s11 offen offset:1024 lds
    s_add_u32 m0, s81, 49152
    s_lshr_b32 s11, s83, 10
    v_cvt_pk_bf16_f32 v2, v2, v2
    v_cvt_pk_bf16_f32 v3, v3, v3
    v_and_b32 v2, 0xffff0000, v2
    v_and_b32 v3, 0xffff0000, v3
    v_rcp_f32 v122, v2
    v_rcp_f32 v123, v3
    buffer_load_dwordx4 v248, s[48:51], s83 offen offset:0 lds
    s_waitcnt lgkmcnt(0)
    v_pk_add_f32 v[32:33], v[32:33], v[34:35]
    v_pk_add_f32 v[36:37], v[36:37], v[38:39]
    v_pk_add_f32 v[32:33], v[32:33], v[36:37]
    v_pk_add_f32 v[24:25], v[24:25], v[26:27]
    v_pk_add_f32 v[28:29], v[28:29], v[30:31]
    v_pk_add_f32 v[24:25], v[24:25], v[28:29]
    v_pk_fma_f32 v[24:25], v[120:121], v[32:33], v[24:25] neg_lo:[1,0,0] neg_hi:[1,0,0]
    v_and_b32 v2, 1, v1
    v_pk_mul_f32 v[24:25], v[24:25], v[122:123]
    v_cmp_eq_u32 vcc, 1, v2
    v_cvt_pk_bf16_f32 v180, v24, v25
    buffer_store_dword v180, v196, s[44:47], s8 offen sc1
    v_cndmask_b32 v190, v120, v122, vcc
    v_min_u32 v190, -2, v190
    s_nop 0
    v_writelane_b32 v190, s60, 2
    s_waitcnt vmcnt(22) lgkmcnt(0)
    s_barrier
    ds_read_b64_tr_b16 a[0:1], v218 offset:0
    ds_read_b64_tr_b16 a[2:3], v218 offset:1024
    buffer_load_dwordx4 v249, s[48:51], s83 offen offset:1024 lds
    ds_read_b128 a[16:19], v212 offset:0
    ds_read_b128 a[20:23], v212 offset:4096
    buffer_load_dwordx4 v250, s[48:51], s83 offen offset:2048 lds
    ds_read_b64_tr_b16 a[4:5], v218 offset:4096
    ds_read_b64_tr_b16 a[6:7], v218 offset:5120
    buffer_load_dwordx4 v251, s[48:51], s83 offen offset:3072 lds
    s_add_u32 m0, s80, 49152
    s_add_u32 s83, s83, 0x20000
    ds_read_b128 a[24:27], v213 offset:0
    ds_read_b128 a[28:31], v213 offset:4096
    buffer_load_dwordx4 v234, s[4:7], s11 offen offset:0 lds
    s_and_b32 s83, s83, 0x1fffff
    ds_read_b64_tr_b16 a[8:9], v218 offset:8192
    ds_read_b64_tr_b16 a[10:11], v218 offset:9216
    buffer_load_dwordx4 v235, s[4:7], s11 offen offset:1024 lds
    s_add_u32 m0, s81, 73728
    s_lshr_b32 s11, s83, 10
    ds_read_b128 a[32:35], v214 offset:0
    ds_read_b128 a[36:39], v214 offset:4096
    buffer_load_dwordx4 v248, s[48:51], s83 offen offset:0 lds
    ds_read_b64_tr_b16 a[12:13], v218 offset:12288
    ds_read_b64_tr_b16 a[14:15], v218 offset:13312
    ds_read_b128 a[40:43], v215 offset:0
    ds_read_b128 a[44:47], v215 offset:4096
    s_waitcnt vmcnt(22) lgkmcnt(0)
    s_barrier
    v_mfma_f32_32x32x16_bf16 v[40:55], a[0:3], a[16:19], 0
    ds_read_b64_tr_b16 a[48:49], v218 offset:24576
    ds_read_b64_tr_b16 a[50:51], v218 offset:25600
    buffer_load_dwordx4 v249, s[48:51], s83 offen offset:1024 lds
    v_mfma_f32_32x32x16_bf16 v[56:71], a[0:3], a[20:23], 0
    ds_read_b128 a[64:67], v212 offset:24576
    ds_read_b128 a[68:71], v212 offset:28672
    v_mfma_f32_32x32x16_bf16 v[40:55], a[4:7], a[24:27], v[40:55]
    ds_read_b64_tr_b16 a[52:53], v218 offset:28672
    ds_read_b64_tr_b16 a[54:55], v218 offset:29696
    buffer_load_dwordx4 v250, s[48:51], s83 offen offset:2048 lds
    v_mfma_f32_32x32x16_bf16 v[56:71], a[4:7], a[28:31], v[56:71]
    ds_read_b128 a[72:75], v213 offset:24576
    ds_read_b128 a[76:79], v213 offset:28672
    v_smfmac_f32_16x16x64_bf16 v[224:227], v[220:223], a[0:7], v219
    ds_read_b64_tr_b16 a[56:57], v218 offset:32768
    ds_read_b64_tr_b16 a[58:59], v218 offset:33792
    v_mfma_f32_32x32x16_bf16 v[40:55], a[8:11], a[32:35], v[40:55]
    ds_read_b128 a[80:83], v214 offset:24576
    ds_read_b128 a[84:87], v214 offset:28672
    buffer_load_dwordx4 v251, s[48:51], s83 offen offset:3072 lds
    s_add_u32 m0, s80, 73728
    s_add_u32 s83, s83, 0x20000
    v_mfma_f32_32x32x16_bf16 v[56:71], a[8:11], a[36:39], v[56:71]
    ds_read_b64_tr_b16 a[60:61], v218 offset:36864
    ds_read_b64_tr_b16 a[62:63], v218 offset:37888
    v_mfma_f32_32x32x16_bf16 v[40:55], a[12:15], a[40:43], v[40:55]
    ds_read_b128 a[88:91], v215 offset:24576
    ds_read_b128 a[92:95], v215 offset:28672
    buffer_load_dwordx4 v234, s[4:7], s11 offen offset:0 lds
    s_and_b32 s83, s83, 0x1fffff
    v_mfma_f32_32x32x16_bf16 v[56:71], a[12:15], a[44:47], v[56:71]
    v_smfmac_f32_16x16x64_bf16 v[224:227], v[220:223], a[8:15], v219
    buffer_load_dwordx4 v235, s[4:7], s11 offen offset:1024 lds
    s_add_u32 m0, s81, 98304
    s_lshr_b32 s11, s83, 10
    s_waitcnt vmcnt(21) lgkmcnt(0)
    s_barrier
    v_mfma_f32_32x32x16_bf16 v[40:55], a[48:51], a[64:67], v[40:55]
    ds_read_b64_tr_b16 a[0:1], v216 offset:0
    ds_read_b64_tr_b16 a[2:3], v216 offset:1024
    buffer_load_dwordx4 v248, s[48:51], s83 offen offset:0 lds
    v_mfma_f32_32x32x16_bf16 v[56:71], a[48:51], a[68:71], v[56:71]
    ds_read_b128 a[16:19], v204 offset:0
    ds_read_b128 a[20:23], v204 offset:4096
    v_mfma_f32_32x32x16_bf16 v[40:55], a[52:55], a[72:75], v[40:55]
    ds_read_b64_tr_b16 a[4:5], v216 offset:4096
    ds_read_b64_tr_b16 a[6:7], v216 offset:5120
    buffer_load_dwordx4 v249, s[48:51], s83 offen offset:1024 lds
    v_mfma_f32_32x32x16_bf16 v[56:71], a[52:55], a[76:79], v[56:71]
    ds_read_b128 a[24:27], v205 offset:0
    ds_read_b128 a[28:31], v205 offset:4096
    v_smfmac_f32_16x16x64_bf16 v[224:227], v[220:223], a[48:55], v219
    ds_read_b64_tr_b16 a[8:9], v216 offset:8192
    ds_read_b64_tr_b16 a[10:11], v216 offset:9216
    v_mfma_f32_32x32x16_bf16 v[40:55], a[56:59], a[80:83], v[40:55]
    ds_read_b128 a[32:35], v206 offset:0
    ds_read_b128 a[36:39], v206 offset:4096
    buffer_load_dwordx4 v250, s[48:51], s83 offen offset:2048 lds
    v_mfma_f32_32x32x16_bf16 v[56:71], a[56:59], a[84:87], v[56:71]
    ds_read_b64_tr_b16 a[12:13], v216 offset:12288
    ds_read_b64_tr_b16 a[14:15], v216 offset:13312
    v_mfma_f32_32x32x16_bf16 v[40:55], a[60:63], a[88:91], v[40:55]
    ds_read_b128 a[40:43], v207 offset:0
    ds_read_b128 a[44:47], v207 offset:4096
    buffer_load_dwordx4 v251, s[48:51], s83 offen offset:3072 lds
    s_add_u32 m0, s80, 98304
    s_add_u32 s83, s83, 0x20000
    v_mfma_f32_32x32x16_bf16 v[56:71], a[60:63], a[92:95], v[56:71]
    v_smfmac_f32_16x16x64_bf16 v[224:227], v[220:223], a[56:63], v219
    buffer_load_dwordx4 v234, s[4:7], s11 offen offset:0 lds
    s_and_b32 s83, s83, 0x1fffff
    s_waitcnt vmcnt(18) lgkmcnt(0)
    s_barrier
    v_mfma_f32_32x32x16_bf16 v[40:55], a[0:3], a[16:19], v[40:55]
    ds_read_b64_tr_b16 a[48:49], v216 offset:24576
    ds_read_b64_tr_b16 a[50:51], v216 offset:25600
    buffer_load_dwordx4 v235, s[4:7], s11 offen offset:1024 lds
    s_add_u32 m0, s81, 122880
    s_lshr_b32 s11, s83, 10
    v_mfma_f32_32x32x16_bf16 v[56:71], a[0:3], a[20:23], v[56:71]
    ds_read_b128 a[64:67], v204 offset:24576
    ds_read_b128 a[68:71], v204 offset:28672
    v_mfma_f32_32x32x16_bf16 v[40:55], a[4:7], a[24:27], v[40:55]
    ds_read_b64_tr_b16 a[52:53], v216 offset:28672
    ds_read_b64_tr_b16 a[54:55], v216 offset:29696
    buffer_load_dwordx4 v248, s[48:51], s83 offen offset:0 lds
    v_mfma_f32_32x32x16_bf16 v[56:71], a[4:7], a[28:31], v[56:71]
    ds_read_b128 a[72:75], v205 offset:24576
    ds_read_b128 a[76:79], v205 offset:28672
    v_smfmac_f32_16x16x64_bf16 v[224:227], v[220:223], a[0:7], v219
    ds_read_b64_tr_b16 a[56:57], v216 offset:32768
    ds_read_b64_tr_b16 a[58:59], v216 offset:33792
    v_mfma_f32_32x32x16_bf16 v[40:55], a[8:11], a[32:35], v[40:55]
    ds_read_b128 a[80:83], v206 offset:24576
    ds_read_b128 a[84:87], v206 offset:28672
    buffer_load_dwordx4 v249, s[48:51], s83 offen offset:1024 lds
    v_mfma_f32_32x32x16_bf16 v[56:71], a[8:11], a[36:39], v[56:71]
    ds_read_b64_tr_b16 a[60:61], v216 offset:36864
    ds_read_b64_tr_b16 a[62:63], v216 offset:37888
    v_mfma_f32_32x32x16_bf16 v[40:55], a[12:15], a[40:43], v[40:55]
    ds_read_b128 a[88:91], v207 offset:24576
    ds_read_b128 a[92:95], v207 offset:28672
    buffer_load_dwordx4 v250, s[48:51], s83 offen offset:2048 lds
    v_mfma_f32_32x32x16_bf16 v[56:71], a[12:15], a[44:47], v[56:71]
    v_smfmac_f32_16x16x64_bf16 v[224:227], v[220:223], a[8:15], v219
    buffer_load_dwordx4 v251, s[48:51], s83 offen offset:3072 lds
    s_add_u32 m0, s80, 122880
    s_add_u32 s83, s83, 0x20000
    s_waitcnt vmcnt(16) lgkmcnt(0)
    s_barrier
    v_mfma_f32_32x32x16_bf16 v[40:55], a[48:51], a[64:67], v[40:55]
    ds_read_b64_tr_b16 a[0:1], v217 offset:0
    ds_read_b64_tr_b16 a[2:3], v217 offset:1024
    buffer_load_dwordx4 v234, s[4:7], s11 offen offset:0 lds
    s_and_b32 s83, s83, 0x1fffff
    v_mfma_f32_32x32x16_bf16 v[56:71], a[48:51], a[68:71], v[56:71]
    ds_read_b128 a[16:19], v208 offset:0
    ds_read_b128 a[20:23], v208 offset:4096
    s_cmp_eq_u32 s3, 3
    s_cbranch_scc0 L_flagd
    v_cmp_eq_u32 vcc, 0, v191
    s_nop 0
    s_cbranch_vccnz L_spin_1
L_spin_1_ok:
    s_bitcmp0_b32 s53, 0
    s_cselect_b32 exec_hi, 0x33333333, 0
    s_or_b32 exec_lo, exec_hi, 4
    buffer_store_dword v190, v197, s[44:47], s9 offen sc1
    s_mov_b64 exec, -1
L_flagd:
    v_mfma_f32_32x32x16_bf16 v[40:55], a[52:55], a[72:75], v[40:55]
    ds_read_b64_tr_b16 a[4:5], v217 offset:4096
    ds_read_b64_tr_b16 a[6:7], v217 offset:5120
    buffer_load_dwordx4 v235, s[4:7], s11 offen offset:1024 lds
    s_add_u32 m0, s81, 0
    s_lshr_b32 s11, s83, 10
    v_mfma_f32_32x32x16_bf16 v[56:71], a[52:55], a[76:79], v[56:71]
    ds_read_b128 a[24:27], v209 offset:0
    ds_read_b128 a[28:31], v209 offset:4096
    v_smfmac_f32_16x16x64_bf16 v[224:227], v[220:223], a[48:55], v219
    ds_read_b64_tr_b16 a[8:9], v217 offset:8192
    ds_read_b64_tr_b16 a[10:11], v217 offset:9216
    v_mfma_f32_32x32x16_bf16 v[40:55], a[56:59], a[80:83], v[40:55]
    ds_read_b128 a[32:35], v210 offset:0
    ds_read_b128 a[36:39], v210 offset:4096
    buffer_load_dwordx4 v248, s[48:51], s83 offen offset:0 lds
    v_mfma_f32_32x32x16_bf16 v[56:71], a[56:59], a[84:87], v[56:71]
    ds_read_b64_tr_b16 a[12:13], v217 offset:12288
    ds_read_b64_tr_b16 a[14:15], v217 offset:13312
    v_mfma_f32_32x32x16_bf16 v[40:55], a[60:63], a[88:91], v[40:55]
    ds_read_b128 a[40:43], v211 offset:0
    ds_read_b128 a[44:47], v211 offset:4096
    buffer_load_dwordx4 v249, s[48:51], s83 offen offset:1024 lds
    v_mfma_f32_32x32x16_bf16 v[56:71], a[60:63], a[92:95], v[56:71]
    v_smfmac_f32_16x16x64_bf16 v[224:227], v[220:223], a[56:63], v219
    buffer_load_dwordx4 v250, s[48:51], s83 offen offset:2048 lds
    s_waitcnt vmcnt(15) lgkmcnt(0)
    s_barrier
    v_mfma_f32_32x32x16_bf16 v[40:55], a[0:3], a[16:19], v[40:55]
    ds_read_b64_tr_b16 a[48:49], v217 offset:24576
    ds_read_b64_tr_b16 a[50:51], v217 offset:25600
    buffer_load_dwordx4 v251, s[48:51], s83 offen offset:3072 lds
    s_add_u32 m0, s80, 0
    s_add_u32 s83, s83, 0x20000
    s_lshl2_add_u32 s63, s54, s3
    v_mfma_f32_32x32x16_bf16 v[56:71], a[0:3], a[20:23], v[56:71]
    ds_read_b128 a[64:67], v208 offset:24576
    ds_read_b128 a[68:71], v208 offset:28672
    s_lshl_b32 s12, s63, 12
    v_mfma_f32_32x32x16_bf16 v[40:55], a[4:7], a[24:27], v[40:55]
    ds_read_b64_tr_b16 a[52:53], v217 offset:28672
    ds_read_b64_tr_b16 a[54:55], v217 offset:29696
    buffer_load_dwordx4 v234, s[4:7], s11 offen offset:0 lds
    s_and_b32 s83, s83, 0x1fffff
    s_add_u32 s12, s12, 2097152
    v_mfma_f32_32x32x16_bf16 v[56:71], a[4:7], a[28:31], v[56:71]
    ds_read_b128 a[72:75], v209 offset:24576
    ds_read_b128 a[76:79], v209 offset:28672
    s_lshl_b32 s14, s52, 10
    v_smfmac_f32_16x16x64_bf16 v[224:227], v[220:223], a[0:7], v219
    ds_read_b64_tr_b16 a[56:57], v217 offset:32768
    ds_read_b64_tr_b16 a[58:59], v217 offset:33792
    s_add_u32 s14, s14, 327680
    v_mfma_f32_32x32x16_bf16 v[40:55], a[8:11], a[32:35], v[40:55]
    ds_read_b128 a[80:83], v210 offset:24576
    ds_read_b128 a[84:87], v210 offset:28672
    buffer_load_dwordx4 v235, s[4:7], s11 offen offset:1024 lds
    s_add_u32 m0, s81, 24576
    s_lshr_b32 s11, s83, 10
    s_lshl2_add_u32 s82, s53, s3
    v_mfma_f32_32x32x16_bf16 v[56:71], a[8:11], a[36:39], v[56:71]
    ds_read_b64_tr_b16 a[60:61], v217 offset:36864
    ds_read_b64_tr_b16 a[62:63], v217 offset:37888
    s_lshl4_add_u32 s13, s82, s14
    v_mov_b64 v[72:73], 0
    v_mfma_f32_32x32x16_bf16 v[40:55], a[12:15], a[40:43], v[40:55]
    ds_read_b128 a[88:91], v211 offset:24576
    ds_read_b128 a[92:95], v211 offset:28672
    buffer_load_dwordx4 v248, s[48:51], s83 offen offset:0 lds
    s_lshl_b32 s82, s82, 6
    v_mov_b64 v[74:75], 0
    v_mfma_f32_32x32x16_bf16 v[56:71], a[12:15], a[44:47], v[56:71]
    v_mov_b64 v[76:77], 0
    v_smfmac_f32_16x16x64_bf16 v[224:227], v[220:223], a[8:15], v219
    buffer_load_dwordx4 v249, s[48:51], s83 offen offset:1024 lds
    v_mov_b64 v[78:79], 0
    s_waitcnt vmcnt(14) lgkmcnt(0)
    s_barrier
    v_mfma_f32_32x32x16_bf16 v[40:55], a[48:51], a[64:67], v[40:55]
    ds_read_b64_tr_b16 a[0:1], v218 offset:0
    ds_read_b64_tr_b16 a[2:3], v218 offset:1024
    buffer_load_dwordx4 v250, s[48:51], s83 offen offset:2048 lds
    s_lshl_b32 s15, s3, 12
    v_mfma_f32_32x32x16_bf16 v[56:71], a[48:51], a[68:71], v[56:71]
    ds_read_b128 a[16:19], v212 offset:0
    ds_read_b128 a[20:23], v212 offset:4096
    s_add_u32 s15, s15, s88
    v_mfma_f32_32x32x16_bf16 v[40:55], a[52:55], a[72:75], v[40:55]
    ds_read_b64_tr_b16 a[4:5], v218 offset:4096
    ds_read_b64_tr_b16 a[6:7], v218 offset:5120
    buffer_load_dwordx4 v251, s[48:51], s83 offen offset:3072 lds
    s_add_u32 m0, s80, 24576
    s_add_u32 s83, s83, 0x20000
    s_add_u32 s15, s15, 2097152
    v_mfma_f32_32x32x16_bf16 v[56:71], a[52:55], a[76:79], v[56:71]
    ds_read_b128 a[24:27], v213 offset:0
    ds_read_b128 a[28:31], v213 offset:4096
    s_lshl_b32 s62, s53, 14
    v_smfmac_f32_16x16x64_bf16 v[224:227], v[220:223], a[48:55], v219
    ds_read_b64_tr_b16 a[8:9], v218 offset:8192
    ds_read_b64_tr_b16 a[10:11], v218 offset:9216
    s_lshl_b32 s8, s63, 8
    v_mfma_f32_32x32x16_bf16 v[40:55], a[56:59], a[80:83], v[40:55]
    ds_read_b128 a[32:35], v214 offset:0
    ds_read_b128 a[36:39], v214 offset:4096
    buffer_load_dwordx4 v234, s[4:7], s11 offen offset:0 lds
    s_and_b32 s83, s83, 0x1fffff
    s_add_u32 s8, s8, 524288
    v_mfma_f32_32x32x16_bf16 v[56:71], a[56:59], a[84:87], v[56:71]
    ds_read_b64_tr_b16 a[12:13], v218 offset:12288
    ds_read_b64_tr_b16 a[14:15], v218 offset:13312
    s_lshl_b32 s9, s63, 7
    v_mov_b64 v[80:81], 0
    v_mfma_f32_32x32x16_bf16 v[40:55], a[60:63], a[88:91], v[40:55]
    ds_read_b128 a[40:43], v215 offset:0
    ds_read_b128 a[44:47], v215 offset:4096
    buffer_load_dwordx4 v235, s[4:7], s11 offen offset:1024 lds
    s_add_u32 m0, s81, 49152
    s_lshr_b32 s11, s83, 10
    s_add_u32 s9, s9, 1048576
    v_mov_b64 v[82:83], 0
    v_mfma_f32_32x32x16_bf16 v[56:71], a[60:63], a[92:95], v[56:71]
    v_mov_b64 v[84:85], 0
    v_smfmac_f32_16x16x64_bf16 v[224:227], v[220:223], a[56:63], v219
    buffer_load_dwordx4 v248, s[48:51], s83 offen offset:0 lds
    v_mov_b64 v[86:87], 0
    s_waitcnt vmcnt(13) lgkmcnt(0)
    s_barrier
    v_mfma_f32_32x32x16_bf16 v[40:55], a[0:3], a[16:19], v[40:55]
    ds_read_b64_tr_b16 a[48:49], v218 offset:24576
    ds_read_b64_tr_b16 a[50:51], v218 offset:25600
    buffer_load_dwordx4 v249, s[48:51], s83 offen offset:1024 lds
    s_add_u32 s10, s13, 512
    v_mfma_f32_32x32x16_bf16 v[56:71], a[0:3], a[20:23], v[56:71]
    ds_read_b128 a[64:67], v212 offset:24576
    ds_read_b128 a[68:71], v212 offset:28672
    s_mov_b32 s1, 0
    v_mfma_f32_32x32x16_bf16 v[40:55], a[4:7], a[24:27], v[40:55]
    ds_read_b64_tr_b16 a[52:53], v218 offset:28672
    ds_read_b64_tr_b16 a[54:55], v218 offset:29696
    buffer_load_dwordx4 v250, s[48:51], s83 offen offset:2048 lds
    s_lshl_b32 s91, s52, 16
    v_mfma_f32_32x32x16_bf16 v[56:71], a[4:7], a[28:31], v[56:71]
    ds_read_b128 a[72:75], v213 offset:24576
    ds_read_b128 a[76:79], v213 offset:28672
    s_lshl_b32 s94, s82, 3
    v_smfmac_f32_16x16x64_bf16 v[224:227], v[220:223], a[0:7], v219
    ds_read_b64_tr_b16 a[56:57], v218 offset:32768
    ds_read_b64_tr_b16 a[58:59], v218 offset:33792
    s_add_u32 s94, s94, 360448
    v_mfma_f32_32x32x16_bf16 v[40:55], a[8:11], a[32:35], v[40:55]
    ds_read_b128 a[80:83], v214 offset:24576
    ds_read_b128 a[84:87], v214 offset:28672
    buffer_load_dwordx4 v251, s[48:51], s83 offen offset:3072 lds
    s_add_u32 m0, s80, 49152
    s_add_u32 s83, s83, 0x20000
    s_lshl_b32 s0, s82, 10
    v_mfma_f32_32x32x16_bf16 v[56:71], a[8:11], a[36:39], v[56:71]
    ds_read_b64_tr_b16 a[60:61], v218 offset:36864
    ds_read_b64_tr_b16 a[62:63], v218 offset:37888
    s_add_u32 s0, s0, 6291456
    v_mov_b64 v[88:89], 0
    v_mfma_f32_32x32x16_bf16 v[40:55], a[12:15], a[40:43], v[40:55]
    ds_read_b128 a[88:91], v215 offset:24576
    ds_read_b128 a[92:95], v215 offset:28672
    buffer_load_dwordx4 v234, s[4:7], s11 offen offset:0 lds
    s_and_b32 s83, s83, 0x1fffff
    v_add_u32 v254, s0, v6
    v_mov_b64 v[90:91], 0
    v_mfma_f32_32x32x16_bf16 v[56:71], a[12:15], a[44:47], v[56:71]
    v_mov_b64 v[92:93], 0
    v_smfmac_f32_16x16x64_bf16 v[224:227], v[220:223], a[8:15], v219
    buffer_load_dwordx4 v235, s[4:7], s11 offen offset:1024 lds
    s_add_u32 m0, s81, 73728
    s_lshr_b32 s11, s83, 10
    v_mov_b64 v[94:95], 0
    s_waitcnt vmcnt(12) lgkmcnt(0)
    s_barrier
    v_mfma_f32_32x32x16_bf16 v[40:55], a[48:51], a[64:67], v[40:55]
    ds_read_b64_tr_b16 a[0:1], v216 offset:0
    ds_read_b64_tr_b16 a[2:3], v216 offset:1024
    buffer_load_dwordx4 v248, s[48:51], s83 offen offset:0 lds
    s_mul_i32 s95, s63, 816
    v_mfma_f32_32x32x16_bf16 v[56:71], a[48:51], a[68:71], v[56:71]
    ds_read_b128 a[16:19], v204 offset:0
    ds_read_b128 a[20:23], v204 offset:4096
    s_add_u32 s95, s95, 524288
    v_mfma_f32_32x32x16_bf16 v[40:55], a[52:55], a[72:75], v[40:55]
    ds_read_b64_tr_b16 a[4:5], v216 offset:4096
    ds_read_b64_tr_b16 a[6:7], v216 offset:5120
    buffer_load_dwordx4 v249, s[48:51], s83 offen offset:1024 lds
    v_accvgpr_write_b32 a160, -1
    v_mfma_f32_32x32x16_bf16 v[56:71], a[52:55], a[76:79], v[56:71]
    ds_read_b128 a[24:27], v205 offset:0
    ds_read_b128 a[28:31], v205 offset:4096
    v_accvgpr_write_b32 a161, -1
    v_smfmac_f32_16x16x64_bf16 v[224:227], v[220:223], a[48:55], v219
    ds_read_b64_tr_b16 a[8:9], v216 offset:8192
    ds_read_b64_tr_b16 a[10:11], v216 offset:9216
    v_accvgpr_write_b32 a162, -1
    v_mfma_f32_32x32x16_bf16 v[40:55], a[56:59], a[80:83], v[40:55]
    ds_read_b128 a[32:35], v206 offset:0
    ds_read_b128 a[36:39], v206 offset:4096
    buffer_load_dwordx4 v250, s[48:51], s83 offen offset:2048 lds
    v_accvgpr_write_b32 a163, -1
    v_mfma_f32_32x32x16_bf16 v[56:71], a[56:59], a[84:87], v[56:71]
    ds_read_b64_tr_b16 a[12:13], v216 offset:12288
    ds_read_b64_tr_b16 a[14:15], v216 offset:13312
    s_add_u32 s62, s62, 0x4000
    v_mov_b64 v[96:97], 0
    v_mfma_f32_32x32x16_bf16 v[40:55], a[60:63], a[88:91], v[40:55]
    ds_read_b128 a[40:43], v207 offset:0
    ds_read_b128 a[44:47], v207 offset:4096
    buffer_load_dwordx4 v251, s[48:51], s83 offen offset:3072 lds
    s_add_u32 m0, s80, 73728
    s_add_u32 s83, s83, 0x20000
    s_and_b32 s62, s62, 0x1ffff
    v_mov_b64 v[98:99], 0
    v_mfma_f32_32x32x16_bf16 v[56:71], a[60:63], a[92:95], v[56:71]
    v_mov_b64 v[100:101], 0
    v_smfmac_f32_16x16x64_bf16 v[224:227], v[220:223], a[56:63], v219
    buffer_load_dwordx4 v234, s[4:7], s11 offen offset:0 lds
    s_and_b32 s83, s83, 0x1fffff
    v_mov_b64 v[102:103], 0
    s_waitcnt vmcnt(11) lgkmcnt(0)
    s_barrier
    v_mfma_f32_32x32x16_bf16 v[40:55], a[0:3], a[16:19], v[40:55]
    ds_read_b64_tr_b16 a[48:49], v216 offset:24576
    ds_read_b64_tr_b16 a[50:51], v216 offset:25600
    buffer_load_dwordx4 v235, s[4:7], s11 offen offset:1024 lds
    s_add_u32 m0, s81, 98304
    s_lshr_b32 s11, s83, 10
    s_add_u32 s40, s15, s62
    v_mfma_f32_32x32x16_bf16 v[56:71], a[0:3], a[20:23], v[56:71]
    ds_read_b128 a[64:67], v204 offset:24576
    ds_read_b128 a[68:71], v204 offset:28672
    s_add_u32 s62, s62, 0x4000
    v_mfma_f32_32x32x16_bf16 v[40:55], a[4:7], a[24:27], v[40:55]
    ds_read_b64_tr_b16 a[52:53], v216 offset:28672
    ds_read_b64_tr_b16 a[54:55], v216 offset:29696
    buffer_load_dwordx4 v248, s[48:51], s83 offen offset:0 lds
    s_and_b32 s62, s62, 0x1ffff
    v_mfma_f32_32x32x16_bf16 v[56:71], a[4:7], a[28:31], v[56:71]
    ds_read_b128 a[72:75], v205 offset:24576
    ds_read_b128 a[76:79], v205 offset:28672
    s_add_u32 s41, s15, s62
    v_smfmac_f32_16x16x64_bf16 v[224:227], v[220:223], a[0:7], v219
    ds_read_b64_tr_b16 a[56:57], v216 offset:32768
    ds_read_b64_tr_b16 a[58:59], v216 offset:33792
    s_add_u32 s62, s62, 0x4000
    v_mfma_f32_32x32x16_bf16 v[40:55], a[8:11], a[32:35], v[40:55]
    ds_read_b128 a[80:83], v206 offset:24576
    ds_read_b128 a[84:87], v206 offset:28672
    buffer_load_dwordx4 v249, s[48:51], s83 offen offset:1024 lds
    s_and_b32 s62, s62, 0x1ffff
    v_mfma_f32_32x32x16_bf16 v[56:71], a[8:11], a[36:39], v[56:71]
    ds_read_b64_tr_b16 a[60:61], v216 offset:36864
    ds_read_b64_tr_b16 a[62:63], v216 offset:37888
    s_add_u32 s42, s15, s62
    v_mov_b64 v[104:105], 0
    v_mfma_f32_32x32x16_bf16 v[40:55], a[12:15], a[40:43], v[40:55]
    ds_read_b128 a[88:91], v207 offset:24576
    ds_read_b128 a[92:95], v207 offset:28672
    buffer_load_dwordx4 v250, s[48:51], s83 offen offset:2048 lds
    s_add_u32 s62, s62, 0x4000
    v_mov_b64 v[106:107], 0
    v_mfma_f32_32x32x16_bf16 v[56:71], a[12:15], a[44:47], v[56:71]
    v_mov_b64 v[108:109], 0
    v_smfmac_f32_16x16x64_bf16 v[224:227], v[220:223], a[8:15], v219
    buffer_load_dwordx4 v251, s[48:51], s83 offen offset:3072 lds
    s_add_u32 m0, s80, 98304
    s_add_u32 s83, s83, 0x20000
    v_mov_b64 v[110:111], 0
    s_waitcnt vmcnt(10) lgkmcnt(0)
    s_barrier
    v_mfma_f32_32x32x16_bf16 v[40:55], a[48:51], a[64:67], v[40:55]
    ds_read_b64_tr_b16 a[0:1], v217 offset:0
    ds_read_b64_tr_b16 a[2:3], v217 offset:1024
    buffer_load_dwordx4 v234, s[4:7], s11 offen offset:0 lds
    s_and_b32 s83, s83, 0x1fffff
    s_and_b32 s62, s62, 0x1ffff
    v_mfma_f32_32x32x16_bf16 v[56:71], a[48:51], a[68:71], v[56:71]
    ds_read_b128 a[16:19], v208 offset:0
    ds_read_b128 a[20:23], v208 offset:4096
    s_add_u32 s43, s15, s62
    v_mfma_f32_32x32x16_bf16 v[40:55], a[52:55], a[72:75], v[40:55]
    ds_read_b64_tr_b16 a[4:5], v217 offset:4096
    ds_read_b64_tr_b16 a[6:7], v217 offset:5120
    buffer_load_dwordx4 v235, s[4:7], s11 offen offset:1024 lds
    s_add_u32 m0, s81, 122880
    s_lshr_b32 s11, s83, 10
    s_getpc_b64 s[96:97]
L_pc2:
    v_mfma_f32_32x32x16_bf16 v[56:71], a[52:55], a[76:79], v[56:71]
    ds_read_b128 a[24:27], v209 offset:0
    ds_read_b128 a[28:31], v209 offset:4096
    s_lshr_b32 s63, s2, 3
    v_smfmac_f32_16x16x64_bf16 v[224:227], v[220:223], a[48:55], v219
    ds_read_b64_tr_b16 a[8:9], v217 offset:8192
    ds_read_b64_tr_b16 a[10:11], v217 offset:9216
    s_lshl2_add_u32 s63, s63, s3
    v_mfma_f32_32x32x16_bf16 v[40:55], a[56:59], a[80:83], v[40:55]
    ds_read_b128 a[32:35], v210 offset:0
    ds_read_b128 a[36:39], v210 offset:4096
    buffer_load_dwordx4 v248, s[48:51], s83 offen offset:0 lds
    s_lshl_b32 s63, s63, 1
    v_mfma_f32_32x32x16_bf16 v[56:71], a[56:59], a[84:87], v[56:71]
    ds_read_b64_tr_b16 a[12:13], v217 offset:12288
    ds_read_b64_tr_b16 a[14:15], v217 offset:13312
    v_and_b32 v3, 1, v1
    v_mov_b64 v[112:113], 0
    v_mfma_f32_32x32x16_bf16 v[40:55], a[60:63], a[88:91], v[40:55]
    ds_read_b128 a[40:43], v211 offset:0
    ds_read_b128 a[44:47], v211 offset:4096
    buffer_load_dwordx4 v249, s[48:51], s83 offen offset:1024 lds
    v_add_lshl_u32 v3, v3, s63, 7
    v_mov_b64 v[114:115], 0
    v_mfma_f32_32x32x16_bf16 v[56:71], a[60:63], a[92:95], v[56:71]
    v_mov_b64 v[116:117], 0
    v_smfmac_f32_16x16x64_bf16 v[224:227], v[220:223], a[56:63], v219
    buffer_load_dwordx4 v250, s[48:51], s83 offen offset:2048 lds
    v_mov_b64 v[118:119], 0
    s_waitcnt vmcnt(9) lgkmcnt(0)
    s_barrier
    v_mfma_f32_32x32x16_bf16 v[40:55], a[0:3], a[16:19], v[40:55]
    ds_read_b64_tr_b16 a[48:49], v217 offset:24576
    ds_read_b64_tr_b16 a[50:51], v217 offset:25600
    buffer_load_dwordx4 v251, s[48:51], s83 offen offset:3072 lds
    s_add_u32 m0, s80, 122880
    s_add_u32 s83, s83, 0x20000
    v_add_u32 v3, L_att-L_pc2, v3
    v_mfma_f32_32x32x16_bf16 v[56:71], a[0:3], a[20:23], v[56:71]
    ds_read_b128 a[64:67], v208 offset:24576
    ds_read_b128 a[68:71], v208 offset:28672
    buffer_load_dwordx2 v[228:229], v193, s[44:47], s92 offen offset:0 sc1
    v_min_u32 v3, L_exact0-L_pc2, v3
    v_mfma_f32_32x32x16_bf16 v[40:55], a[4:7], a[24:27], v[40:55]
    ds_read_b64_tr_b16 a[52:53], v217 offset:28672
    ds_read_b64_tr_b16 a[54:55], v217 offset:29696
    buffer_load_dwordx4 v234, s[4:7], s11 offen offset:0 lds
    s_and_b32 s83, s83, 0x1fffff
    v_mov_b32 v5, s97
    v_mfma_f32_32x32x16_bf16 v[56:71], a[4:7], a[28:31], v[56:71]
    ds_read_b128 a[72:75], v209 offset:24576
    ds_read_b128 a[76:79], v209 offset:28672
    buffer_load_dwordx2 v[230:231], v193, s[44:47], s92 offen offset:256 sc1
    v_add_co_u32 v4, vcc, s96, v3
    v_smfmac_f32_16x16x64_bf16 v[224:227], v[220:223], a[0:7], v219
    ds_read_b64_tr_b16 a[56:57], v217 offset:32768
    ds_read_b64_tr_b16 a[58:59], v217 offset:33792
    v_addc_co_u32 v5, vcc, 0, v5, vcc
    v_mfma_f32_32x32x16_bf16 v[40:55], a[8:11], a[32:35], v[40:55]
    ds_read_b128 a[80:83], v210 offset:24576
    ds_read_b128 a[84:87], v210 offset:28672
    buffer_load_dwordx4 v235, s[4:7], s11 offen offset:1024 lds
    s_add_u32 m0, s81, 0
    s_lshr_b32 s11, s83, 10
    v_mfma_f32_32x32x16_bf16 v[56:71], a[8:11], a[36:39], v[56:71]
    ds_read_b64_tr_b16 a[60:61], v217 offset:36864
    ds_read_b64_tr_b16 a[62:63], v217 offset:37888
    buffer_load_dword v232, v194, s[44:47], s93 offen sc1
    v_mov_b64 v[120:121], 0
    v_mfma_f32_32x32x16_bf16 v[40:55], a[12:15], a[40:43], v[40:55]
    ds_read_b128 a[88:91], v211 offset:24576
    ds_read_b128 a[92:95], v211 offset:28672
    buffer_load_dwordx4 v248, s[48:51], s83 offen offset:0 lds
    v_mov_b64 v[122:123], 0
    v_mfma_f32_32x32x16_bf16 v[56:71], a[12:15], a[44:47], v[56:71]
    buffer_load_dword v233, v195, s[44:47], s93 offen sc1
    v_mov_b64 v[124:125], 0
    v_smfmac_f32_16x16x64_bf16 v[224:227], v[220:223], a[8:15], v219
    buffer_load_dwordx4 v249, s[48:51], s83 offen offset:1024 lds
    v_mov_b64 v[126:127], 0
    s_waitcnt vmcnt(12) lgkmcnt(0)
    s_barrier
    v_mfma_f32_32x32x16_bf16 v[40:55], a[48:51], a[64:67], v[40:55]
    ds_read_b64_tr_b16 a[0:1], v218 offset:0
    ds_read_b64_tr_b16 a[2:3], v218 offset:1024
    buffer_load_dwordx4 v250, s[48:51], s83 offen offset:2048 lds
    v_mfma_f32_32x32x16_bf16 v[56:71], a[48:51], a[68:71], v[56:71]
    ds_read_b128 a[16:19], v212 offset:0
    ds_read_b128 a[20:23], v212 offset:4096
    v_mfma_f32_32x32x16_bf16 v[40:55], a[52:55], a[72:75], v[40:55]
    ds_read_b64_tr_b16 a[4:5], v218 offset:4096
    ds_read_b64_tr_b16 a[6:7], v218 offset:5120
    buffer_load_dwordx4 v251, s[48:51], s83 offen offset:3072 lds
    s_add_u32 m0, s80, 0
    s_add_u32 s83, s83, 0x20000
    v_mfma_f32_32x32x16_bf16 v[56:71], a[52:55], a[76:79], v[56:71]
    ds_read_b128 a[24:27], v213 offset:0
    ds_read_b128 a[28:31], v213 offset:4096
    v_smfmac_f32_16x16x64_bf16 v[224:227], v[220:223], a[48:55], v219
    ds_read_b64_tr_b16 a[8:9], v218 offset:8192
    ds_read_b64_tr_b16 a[10:11], v218 offset:9216
    v_mfma_f32_32x32x16_bf16 v[40:55], a[56:59], a[80:83], v[40:55]
    ds_read_b128 a[32:35], v214 offset:0
    ds_read_b128 a[36:39], v214 offset:4096
    buffer_load_dwordx4 v234, s[4:7], s11 offen offset:0 lds
    s_and_b32 s83, s83, 0x1fffff
    v_mfma_f32_32x32x16_bf16 v[56:71], a[56:59], a[84:87], v[56:71]
    ds_read_b64_tr_b16 a[12:13], v218 offset:12288
    ds_read_b64_tr_b16 a[14:15], v218 offset:13312
    v_mov_b64 v[128:129], 0
    v_mfma_f32_32x32x16_bf16 v[40:55], a[60:63], a[88:91], v[40:55]
    ds_read_b128 a[40:43], v215 offset:0
    ds_read_b128 a[44:47], v215 offset:4096
    buffer_load_dwordx4 v235, s[4:7], s11 offen offset:1024 lds
    s_add_u32 m0, s81, 24576
    s_lshr_b32 s11, s83, 10
    v_mov_b64 v[130:131], 0
    v_mfma_f32_32x32x16_bf16 v[56:71], a[60:63], a[92:95], v[56:71]
    v_mov_b64 v[132:133], 0
    v_smfmac_f32_16x16x64_bf16 v[224:227], v[220:223], a[56:63], v219
    buffer_load_dwordx4 v248, s[48:51], s83 offen offset:0 lds
    v_mov_b64 v[134:135], 0
    s_waitcnt vmcnt(9) lgkmcnt(0)
    s_barrier
    v_mfma_f32_32x32x16_bf16 v[40:55], a[0:3], a[16:19], v[40:55]
    ds_read_b64_tr_b16 a[48:49], v218 offset:24576
    ds_read_b64_tr_b16 a[50:51], v218 offset:25600
    buffer_load_dwordx4 v249, s[48:51], s83 offen offset:1024 lds
    v_mfma_f32_32x32x16_bf16 v[56:71], a[0:3], a[20:23], v[56:71]
    ds_read_b128 a[64:67], v212 offset:24576
    ds_read_b128 a[68:71], v212 offset:28672
    v_mfma_f32_32x32x16_bf16 v[40:55], a[4:7], a[24:27], v[40:55]
    ds_read_b64_tr_b16 a[52:53], v218 offset:28672
    ds_read_b64_tr_b16 a[54:55], v218 offset:29696
    buffer_load_dwordx4 v250, s[48:51], s83 offen offset:2048 lds
    v_mfma_f32_32x32x16_bf16 v[56:71], a[4:7], a[28:31], v[56:71]
    ds_read_b128 a[72:75], v213 offset:24576
    ds_read_b128 a[76:79], v213 offset:28672
    v_smfmac_f32_16x16x64_bf16 v[224:227], v[220:223], a[0:7], v219
    ds_read_b64_tr_b16 a[56:57], v218 offset:32768
    ds_read_b64_tr_b16 a[58:59], v218 offset:33792
    v_mfma_f32_32x32x16_bf16 v[40:55], a[8:11], a[32:35], v[40:55]
    ds_read_b128 a[80:83], v214 offset:24576
    ds_read_b128 a[84:87], v214 offset:28672
    buffer_load_dwordx4 v251, s[48:51], s83 offen offset:3072 lds
    s_add_u32 m0, s80, 24576
    v_mfma_f32_32x32x16_bf16 v[56:71], a[8:11], a[36:39], v[56:71]
    ds_read_b64_tr_b16 a[60:61], v218 offset:36864
    ds_read_b64_tr_b16 a[62:63], v218 offset:37888
    v_mfma_f32_32x32x16_bf16 v[40:55], a[12:15], a[40:43], v[40:55]
    ds_read_b128 a[88:91], v215 offset:24576
    ds_read_b128 a[92:95], v215 offset:28672
    buffer_load_dwordx4 v234, s[4:7], s11 offen offset:0 lds
    v_mfma_f32_32x32x16_bf16 v[56:71], a[12:15], a[44:47], v[56:71]
    v_smfmac_f32_16x16x64_bf16 v[224:227], v[220:223], a[8:15], v219
    buffer_load_dwordx4 v235, s[4:7], s11 offen offset:1024 lds
    s_waitcnt vmcnt(11)
    v_max3_u32 v2, v228, v229, v230
    v_max3_u32 v2, v2, v231, v232
    v_max_u32 v2, v2, v233
    v_cmp_eq_u32 vcc, -1, v2
    s_nop 0
    s_cbranch_vccnz L_spin_2
L_spin_2_ok:
    s_waitcnt vmcnt(6) lgkmcnt(0)
    s_barrier
    v_mfma_f32_32x32x16_bf16 v[40:55], a[48:51], a[64:67], v[40:55]
    ds_read_b64_tr_b16 a[0:1], v216 offset:0
    ds_read_b64_tr_b16 a[2:3], v216 offset:1024
    s_lshl_b32 s92, s53, 2
    v_mfma_f32_32x32x16_bf16 v[56:71], a[48:51], a[68:71], v[56:71]
    ds_read_b128 a[16:19], v204 offset:0
    ds_read_b128 a[20:23], v204 offset:4096
    buffer_load_dwordx4 v[172:175], v156, s[44:47], 0 offen offset:0
    s_sub_u32 s92, s52, s92
    v_mfma_f32_32x32x16_bf16 v[40:55], a[52:55], a[72:75], v[40:55]
    ds_read_b64_tr_b16 a[4:5], v216 offset:4096
    ds_read_b64_tr_b16 a[6:7], v216 offset:5120
    s_and_b32 s92, s92, 31
    v_mfma_f32_32x32x16_bf16 v[56:71], a[52:55], a[76:79], v[56:71]
    ds_read_b128 a[24:27], v205 offset:0
    ds_read_b128 a[28:31], v205 offset:4096
    buffer_load_dwordx4 v[176:179], v156, s[44:47], 0 offen offset:1024
    s_lshl_b32 s92, s92, 11
    v_smfmac_f32_16x16x64_bf16 v[224:227], v[220:223], a[48:55], v219
    ds_read_b64_tr_b16 a[8:9], v216 offset:8192
    ds_read_b64_tr_b16 a[10:11], v216 offset:9216
    s_lshl4_add_u32 s93, s52, s94
    v_mfma_f32_32x32x16_bf16 v[40:55], a[56:59], a[80:83], v[40:55]
    ds_read_b128 a[32:35], v206 offset:0
    ds_read_b128 a[36:39], v206 offset:4096
    buffer_load_dwordx4 v[180:183], v156, s[44:47], 0 offen offset:2048
    s_add_u32 s62, s62, 0x4000
    v_mfma_f32_32x32x16_bf16 v[56:71], a[56:59], a[84:87], v[56:71]
    ds_read_b64_tr_b16 a[12:13], v216 offset:12288
    ds_read_b64_tr_b16 a[14:15], v216 offset:13312
    s_and_b32 s62, s62, 0x1ffff
    v_mfma_f32_32x32x16_bf16 v[40:55], a[60:63], a[88:91], v[40:55]
    ds_read_b128 a[40:43], v207 offset:0
    ds_read_b128 a[44:47], v207 offset:4096
    buffer_load_dwordx4 v[184:187], v156, s[44:47], 0 offen offset:3072
    s_add_u32 s81, s15, s62
    v_mfma_f32_32x32x16_bf16 v[56:71], a[60:63], a[92:95], v[56:71]
    s_add_u32 s62, s62, 0x4000
    v_smfmac_f32_16x16x64_bf16 v[224:227], v[220:223], a[56:63], v219
    buffer_load_dwordx4 v[188:191], v156, s[44:47], s65 offen offset:0
    s_and_b32 s62, s62, 0x1ffff
    s_waitcnt vmcnt(5) lgkmcnt(0)
    s_barrier
    v_mfma_f32_32x32x16_bf16 v[40:55], a[0:3], a[16:19], v[40:55]
    ds_read_b64_tr_b16 a[48:49], v216 offset:24576
    ds_read_b64_tr_b16 a[50:51], v216 offset:25600
    s_add_u32 s83, s15, s62
    v_mfma_f32_32x32x16_bf16 v[56:71], a[0:3], a[20:23], v[56:71]
    ds_read_b128 a[64:67], v204 offset:24576
    ds_read_b128 a[68:71], v204 offset:28672
    buffer_load_dwordx4 v[192:195], v156, s[44:47], s65 offen offset:1024
    s_add_u32 s62, s62, 0x4000
    v_mfma_f32_32x32x16_bf16 v[40:55], a[4:7], a[24:27], v[40:55]
    ds_read_b64_tr_b16 a[52:53], v216 offset:28672
    ds_read_b64_tr_b16 a[54:55], v216 offset:29696
    s_and_b32 s62, s62, 0x1ffff
    v_mfma_f32_32x32x16_bf16 v[56:71], a[4:7], a[28:31], v[56:71]
    ds_read_b128 a[72:75], v205 offset:24576
    ds_read_b128 a[76:79], v205 offset:28672
    buffer_load_dwordx4 v[196:199], v156, s[44:47], s65 offen offset:2048
    s_add_u32 s11, s15, s62
    v_smfmac_f32_16x16x64_bf16 v[224:227], v[220:223], a[0:7], v219
    ds_read_b64_tr_b16 a[56:57], v216 offset:32768
    ds_read_b64_tr_b16 a[58:59], v216 offset:33792
    v_and_b32 v2, 1, v1
    v_lshl_add_u32 v2, v2, 7, s8
    v_mfma_f32_32x32x16_bf16 v[40:55], a[8:11], a[32:35], v[40:55]
    ds_read_b128 a[80:83], v206 offset:24576
    ds_read_b128 a[84:87], v206 offset:28672
    buffer_load_dwordx4 v[200:203], v156, s[44:47], s65 offen offset:3072
    v_and_b32 v3, 15, v1
    v_writelane_b32 v2, s9, 2
    v_mfma_f32_32x32x16_bf16 v[56:71], a[8:11], a[36:39], v[56:71]
    ds_read_b64_tr_b16 a[60:61], v216 offset:36864
    ds_read_b64_tr_b16 a[62:63], v216 offset:37888
    v_lshl_add_u32 v3, v3, 6, s89
    v_writelane_b32 v2, s10, 3
    v_mfma_f32_32x32x16_bf16 v[40:55], a[12:15], a[40:43], v[40:55]
    ds_read_b128 a[88:91], v207 offset:24576
    ds_read_b128 a[92:95], v207 offset:28672
    v_and_b32 v0, 48, v1
    v_writelane_b32 v2, s13, 4
    v_mfma_f32_32x32x16_bf16 v[56:71], a[12:15], a[44:47], v[56:71]
    v_add_u32 v3, v3, v0
    v_smfmac_f32_16x16x64_bf16 v[224:227], v[220:223], a[8:15], v219
    s_waitcnt lgkmcnt(0)
    v_smfmac_f32_16x16x64_bf16 v[224:227], v[220:223], a[48:55], v219
    v_smfmac_f32_16x16x64_bf16 v[224:227], v[220:223], a[56:63], v219
    v_mfma_f32_32x32x16_bf16 v[40:55], a[48:51], a[64:67], v[40:55]
    v_cmp_ne_u32 vcc, s60, v232
    v_cvt_pk_bf16_f32 v240, -v228, -v228
    v_cvt_pk_bf16_f32 v244, -v230, -v230
    s_cmp_eq_u64 vcc, 0
    s_cselect_b32 s59, 1, 0
    v_mfma_f32_32x32x16_bf16 v[40:55], a[52:55], a[72:75], v[40:55]
    v_mov_b32 v241, v240
    v_mov_b32 v245, v244
    v_mul_f32 v229, 0x3e8293ee, v229
    v_mul_f32 v231, 0x3e8293ee, v231
    v_add_f32 v224, v224, v225
    v_mfma_f32_32x32x16_bf16 v[40:55], a[56:59], a[80:83], v[40:55]
    v_cvt_pk_bf16_f32 v236, v224, v224
    v_and_b32 v225, 0xffff0000, v236
    v_sub_f32 v225, v224, v225
    v_cvt_pk_bf16_f32 v236, v224, v225
    v_and_b32 v226, 0xffff0000, v236
    v_mfma_f32_32x32x16_bf16 v[40:55], a[60:63], a[88:91], v[40:55]
    v_sub_f32 v225, v225, v226
    v_cvt_pk_bf16_f32 v237, v225, 0
    s_add_u32 m0, s89, 8192
    v_mfma_f32_32x32x16_bf16 v[56:71], a[48:51], a[68:71], v[56:71]
    v_mfma_f32_32x32x16_bf16 v[40:55], v[236:239], v[240:243], v[40:55]
    buffer_load_dwordx4 v[204:207], v156, s[44:47], s66 offen offset:0
    buffer_load_dwordx4 v[208:211], v156, s[44:47], s66 offen offset:1024
    v_mfma_f32_32x32x16_bf16 v[56:71], a[52:55], a[76:79], v[56:71]
    buffer_load_dwordx4 v[212:215], v156, s[44:47], s66 offen offset:2048
    buffer_load_dwordx4 v[216:219], v156, s[44:47], s66 offen offset:3072
    v_mfma_f32_32x32x16_bf16 v[56:71], a[56:59], a[84:87], v[56:71]
    s_nop 5
    v_mul_f32 v40, v229, v40
    v_mul_f32 v41, v229, v41
    v_cvt_pk_bf16_f32 v8, v40, v41
    v_mul_f32 v42, v229, v42
    v_mul_f32 v43, v229, v43
    v_cvt_pk_bf16_f32 v9, v42, v43
    v_mul_f32 v44, v229, v44
    v_mul_f32 v45, v229, v45
    v_mfma_f32_32x32x16_bf16 v[56:71], a[60:63], a[92:95], v[56:71]
    v_cvt_pk_bf16_f32 v10, v44, v45
    v_mul_f32 v46, v229, v46
    v_mul_f32 v47, v229, v47
    v_cvt_pk_bf16_f32 v11, v46, v47
    v_mul_f32 v48, v229, v48
    v_mul_f32 v49, v229, v49
    v_cvt_pk_bf16_f32 v12, v48, v49
    v_mul_f32 v50, v229, v50
    v_mfma_f32_32x32x16_bf16 v[56:71], v[236:239], v[244:247], v[56:71]
    v_mul_f32 v51, v229, v51
    v_cvt_pk_bf16_f32 v13, v50, v51
    v_mul_f32 v52, v229, v52
    v_mul_f32 v53, v229, v53
    v_cvt_pk_bf16_f32 v14, v52, v53
    v_mul_f32 v54, v229, v54
    v_mul_f32 v55, v229, v55
    v_cvt_pk_bf16_f32 v15, v54, v55
    s_waitcnt vmcnt(8)
L_att:
    v_mfma_f32_32x32x16_bf16 v[40:55], v[172:175], v[8:11], 0
    s_nop 1
    v_mul_f32 v56, v231, v56
    v_mul_f32 v57, v231, v57
    v_cvt_pk_bf16_f32 v16, v56, v57
    v_mul_f32 v58, v231, v58
    v_mul_f32 v59, v231, v59
    v_cvt_pk_bf16_f32 v17, v58, v59
    v_mfma_f32_32x32x16_bf16 v[40:55], v[176:179], v[12:15], v[40:55]
    v_mul_f32 v60, v231, v60
    v_mul_f32 v61, v231, v61
    v_cvt_pk_bf16_f32 v18, v60, v61
    v_mul_f32 v62, v231, v62
    v_mul_f32 v63, v231, v63
    v_cvt_pk_bf16_f32 v19, v62, v63
    v_mul_f32 v64, v231, v64
    v_mul_f32 v65, v231, v65
    v_cvt_pk_bf16_f32 v20, v64, v65
    v_mul_f32 v66, v231, v66
    v_mul_f32 v67, v231, v67
    v_cvt_pk_bf16_f32 v21, v66, v67
    v_mul_f32 v68, v231, v68
    v_mul_f32 v69, v231, v69
    v_cvt_pk_bf16_f32 v22, v68, v69
    v_mul_f32 v70, v231, v70
    v_mul_f32 v71, v231, v71
    v_cvt_pk_bf16_f32 v23, v70, v71
    v_exp_f32 v40, v40
    v_exp_f32 v41, v41
    buffer_load_dwordx4 v[220:223], v156, s[44:47], s67 offen offset:0
    ds_write_b128 v253, v[8:11] offset:12288
    v_exp_f32 v42, v42
    v_exp_f32 v43, v43
    v_exp_f32 v44, v44
    v_exp_f32 v45, v45
    v_mfma_f32_32x32x16_bf16 v[56:71], v[172:175], v[16:19], 0
    ds_write_b128 v253, v[12:15] offset:13312
    v_exp_f32 v46, v46
    v_exp_f32 v47, v47
    v_exp_f32 v48, v48
    v_mfma_f32_32x32x16_bf16 v[56:71], v[176:179], v[20:23], v[56:71]
    buffer_load_dwordx4 v[224:227], v156, s[44:47], s67 offen offset:1024
    ds_write_b128 v253, v[16:19] offset:14336
    v_exp_f32 v49, v49
    v_exp_f32 v50, v50
    v_exp_f32 v51, v51
    v_smfmac_f32_32x32x32_bf16 v[72:87], v[180:183], v[40:47], v7
    ds_write_b128 v253, v[20:23] offset:15360
    v_exp_f32 v52, v52
    v_exp_f32 v53, v53
    v_exp_f32 v54, v54
    v_smfmac_f32_16x16x64_bf16 v[136:139], v[152:155], v[40:47], v7
    v_exp_f32 v55, v55
    s_waitcnt vmcnt(6)
    v_exp_f32 v56, v56
    v_exp_f32 v57, v57
    v_smfmac_f32_32x32x32_bf16 v[72:87], v[184:187], v[48:55], v7
    buffer_load_dwordx4 v[228:231], v156, s[44:47], s67 offen offset:2048
    v_exp_f32 v58, v58
    v_exp_f32 v59, v59
    v_exp_f32 v60, v60
    v_smfmac_f32_16x16x64_bf16 v[136:139], v[152:155], v[48:55], v7
    v_exp_f32 v61, v61
    v_mfma_f32_32x32x16_bf16 v[40:55], v[188:191], v[8:11], 0
    v_exp_f32 v62, v62
    v_exp_f32 v63, v63
    v_exp_f32 v64, v64
    v_mfma_f32_32x32x16_bf16 v[40:55], v[192:195], v[12:15], v[40:55]
    buffer_load_dwordx4 v[232:235], v156, s[44:47], s67 offen offset:3072
    s_waitcnt lgkmcnt(0)
    s_barrier
    ds_read_b128 v[24:27], v252 offset:12288
    ds_read_b128 v[28:31], v252 offset:13312
    ds_read_b128 v[32:35], v252 offset:14336
    ds_read_b128 v[36:39], v252 offset:15360
    v_exp_f32 v65, v65
    v_exp_f32 v66, v66
    v_exp_f32 v67, v67
    v_smfmac_f32_32x32x32_bf16 v[88:103], v[180:183], v[56:63], v7
    buffer_load_dwordx4 v160, s[16:19], s91 offen offset:0 nt lds
    buffer_load_dwordx4 v161, s[16:19], s91 offen offset:1024 nt lds
    s_add_u32 m0, s89, 2048
    v_exp_f32 v68, v68
    v_exp_f32 v69, v69
    v_exp_f32 v70, v70
    v_smfmac_f32_16x16x64_bf16 v[140:143], v[152:155], v[56:63], v7
    v_exp_f32 v71, v71
    v_exp_f32 v40, v40
    v_exp_f32 v41, v41
    v_smfmac_f32_32x32x32_bf16 v[88:103], v[184:187], v[64:71], v7
    buffer_load_dwordx4 v[236:239], v156, s[44:47], s68 offen offset:0
    v_exp_f32 v42, v42
    v_exp_f32 v43, v43
    v_exp_f32 v44, v44
    v_smfmac_f32_16x16x64_bf16 v[140:143], v[152:155], v[64:71], v7
    v_exp_f32 v45, v45
    v_mfma_f32_32x32x16_bf16 v[56:71], v[188:191], v[16:19], 0
    buffer_load_dwordx4 v160, s[4:7], s88 offen offset:0 lds
    v_exp_f32 v46, v46
    v_exp_f32 v47, v47
    v_exp_f32 v48, v48
    v_mfma_f32_32x32x16_bf16 v[56:71], v[192:195], v[20:23], v[56:71]
    buffer_load_dwordx4 v[240:243], v156, s[44:47], s68 offen offset:1024
    v_exp_f32 v49, v49
    v_exp_f32 v50, v50
    v_exp_f32 v51, v51
    v_smfmac_f32_32x32x32_bf16 v[72:87], v[196:199], v[40:47], v7
    v_exp_f32 v52, v52
    v_exp_f32 v53, v53
    v_exp_f32 v54, v54
    v_smfmac_f32_16x16x64_bf16 v[136:139], v[152:155], v[40:47], v7
    v_exp_f32 v55, v55
    s_waitcnt lgkmcnt(0)
    v_exp_f32 v56, v56
    v_exp_f32 v57, v57
    v_smfmac_f32_32x32x32_bf16 v[72:87], v[200:203], v[48:55], v7
    buffer_load_dwordx4 v[244:247], v156, s[44:47], s68 offen offset:2048
    v_exp_f32 v58, v58
    v_exp_f32 v59, v59
    v_exp_f32 v60, v60
    v_smfmac_f32_16x16x64_bf16 v[136:139], v[152:155], v[48:55], v7
    v_exp_f32 v61, v61
    v_mfma_f32_32x32x16_bf16 v[40:55], v[172:175], v[24:27], 0
    buffer_load_dwordx4 v161, s[4:7], s88 offen offset:1024 lds
    v_exp_f32 v62, v62
    v_exp_f32 v63, v63
    v_exp_f32 v64, v64
    v_mfma_f32_32x32x16_bf16 v[40:55], v[176:179], v[28:31], v[40:55]
    buffer_load_dwordx4 v[248:251], v156, s[44:47], s68 offen offset:3072
    v_exp_f32 v65, v65
    v_exp_f32 v66, v66
    v_exp_f32 v67, v67
    v_smfmac_f32_32x32x32_bf16 v[88:103], v[196:199], v[56:63], v7
    v_exp_f32 v68, v68
    v_exp_f32 v69, v69
    v_exp_f32 v70, v70
    v_smfmac_f32_16x16x64_bf16 v[140:143], v[152:155], v[56:63], v7
    v_exp_f32 v71, v71
    v_exp_f32 v40, v40
    v_exp_f32 v41, v41
    v_smfmac_f32_32x32x32_bf16 v[88:103], v[200:203], v[64:71], v7
    v_exp_f32 v42, v42
    v_exp_f32 v43, v43
    v_exp_f32 v44, v44
    v_smfmac_f32_16x16x64_bf16 v[140:143], v[152:155], v[64:71], v7
    v_exp_f32 v45, v45
    v_mfma_f32_32x32x16_bf16 v[56:71], v[172:175], v[32:35], 0
    buffer_load_dwordx4 v162, s[4:7], s88 offen offset:2048 lds
    v_exp_f32 v46, v46
    v_exp_f32 v47, v47
    v_exp_f32 v48, v48
    v_mfma_f32_32x32x16_bf16 v[56:71], v[176:179], v[36:39], v[56:71]
    buffer_load_dwordx4 v[172:175], v156, s[44:47], s69 offen offset:0
    v_exp_f32 v49, v49
    v_exp_f32 v50, v50
    v_exp_f32 v51, v51
    v_smfmac_f32_32x32x32_bf16 v[104:119], v[180:183], v[40:47], v7
    v_exp_f32 v52, v52
    v_exp_f32 v53, v53
    v_exp_f32 v54, v54
    v_smfmac_f32_16x16x64_bf16 v[144:147], v[152:155], v[40:47], v7
    v_exp_f32 v55, v55
    v_exp_f32 v56, v56
    v_exp_f32 v57, v57
    v_smfmac_f32_32x32x32_bf16 v[104:119], v[184:187], v[48:55], v7
    buffer_load_dwordx4 v[176:179], v156, s[44:47], s69 offen offset:1024
    v_exp_f32 v58, v58
    v_exp_f32 v59, v59
    v_exp_f32 v60, v60
    v_smfmac_f32_16x16x64_bf16 v[144:147], v[152:155], v[48:55], v7
    v_exp_f32 v61, v61
    v_mfma_f32_32x32x16_bf16 v[40:55], v[188:191], v[24:27], 0
    buffer_load_dwordx4 v163, s[4:7], s88 offen offset:3072 lds
    v_exp_f32 v62, v62
    v_exp_f32 v63, v63
    v_exp_f32 v64, v64
    v_mfma_f32_32x32x16_bf16 v[40:55], v[192:195], v[28:31], v[40:55]
    v_exp_f32 v65, v65
    v_exp_f32 v66, v66
    v_exp_f32 v67, v67
    v_smfmac_f32_32x32x32_bf16 v[120:135], v[180:183], v[56:63], v7
    v_exp_f32 v68, v68
    v_exp_f32 v69, v69
    v_exp_f32 v70, v70
    v_smfmac_f32_16x16x64_bf16 v[148:151], v[152:155], v[56:63], v7
    v_exp_f32 v71, v71
    v_exp_f32 v40, v40
    v_exp_f32 v41, v41
    v_smfmac_f32_32x32x32_bf16 v[120:135], v[184:187], v[64:71], v7
    buffer_load_dwordx4 v[180:183], v156, s[44:47], s69 offen offset:2048
    v_exp_f32 v42, v42
    v_exp_f32 v43, v43
    v_exp_f32 v44, v44
    v_smfmac_f32_16x16x64_bf16 v[148:151], v[152:155], v[64:71], v7
    v_exp_f32 v45, v45
    v_mfma_f32_32x32x16_bf16 v[56:71], v[188:191], v[32:35], 0
    s_add_u32 m0, s90, 0
    v_exp_f32 v46, v46
    v_exp_f32 v47, v47
    v_exp_f32 v48, v48
    v_mfma_f32_32x32x16_bf16 v[56:71], v[192:195], v[36:39], v[56:71]
    buffer_load_dwordx4 v[184:187], v156, s[44:47], s69 offen offset:3072
    v_exp_f32 v49, v49
    v_exp_f32 v50, v50
    v_exp_f32 v51, v51
    v_smfmac_f32_32x32x32_bf16 v[104:119], v[196:199], v[40:47], v7
    v_exp_f32 v52, v52
    v_exp_f32 v53, v53
    v_exp_f32 v54, v54
    v_smfmac_f32_16x16x64_bf16 v[144:147], v[152:155], v[40:47], v7
    v_exp_f32 v55, v55
    s_waitcnt vmcnt(18)
    v_exp_f32 v56, v56
    v_exp_f32 v57, v57
    v_smfmac_f32_32x32x32_bf16 v[104:119], v[200:203], v[48:55], v7
    buffer_load_dwordx4 v[188:191], v156, s[44:47], s70 offen offset:0
    v_exp_f32 v58, v58
    v_exp_f32 v59, v59
    v_exp_f32 v60, v60
    v_smfmac_f32_16x16x64_bf16 v[144:147], v[152:155], v[48:55], v7
    v_exp_f32 v61, v61
    v_mfma_f32_32x32x16_bf16 v[40:55], v[204:207], v[24:27], 0
    buffer_load_dwordx4 v164, s[24:27], s84 offen offset:0 nt lds
    v_exp_f32 v62, v62
    v_exp_f32 v63, v63
    v_exp_f32 v64, v64
    v_mfma_f32_32x32x16_bf16 v[40:55], v[208:211], v[28:31], v[40:55]
    buffer_load_dwordx4 v[192:195], v156, s[44:47], s70 offen offset:1024
    v_exp_f32 v65, v65
    v_exp_f32 v66, v66
    v_exp_f32 v67, v67
    v_smfmac_f32_32x32x32_bf16 v[120:135], v[196:199], v[56:63], v7
    v_exp_f32 v68, v68
    v_exp_f32 v69, v69
    v_exp_f32 v70, v70
    v_smfmac_f32_16x16x64_bf16 v[148:151], v[152:155], v[56:63], v7
    v_exp_f32 v71, v71
    v_exp_f32 v40, v40
    v_exp_f32 v41, v41
    v_smfmac_f32_32x32x32_bf16 v[120:135], v[200:203], v[64:71], v7
    buffer_load_dwordx4 v[196:199], v156, s[44:47], s70 offen offset:2048
    v_exp_f32 v42, v42
    v_exp_f32 v43, v43
    v_exp_f32 v44, v44
    v_smfmac_f32_16x16x64_bf16 v[148:151], v[152:155], v[64:71], v7
    v_exp_f32 v45, v45
    v_mfma_f32_32x32x16_bf16 v[56:71], v[204:207], v[32:35], 0
    v_exp_f32 v46, v46
    v_exp_f32 v47, v47
    v_exp_f32 v48, v48
    v_mfma_f32_32x32x16_bf16 v[56:71], v[208:211], v[36:39], v[56:71]
    buffer_load_dwordx4 v[200:203], v156, s[44:47], s70 offen offset:3072
    v_exp_f32 v49, v49
    v_exp_f32 v50, v50
    v_exp_f32 v51, v51
    v_smfmac_f32_32x32x32_bf16 v[104:119], v[212:215], v[40:47], v7
    s_mov_b32 exec_hi, 0x7ffff
    buffer_store_dwordx4 a[160:163], v6, s[44:47], s95 offen sc1
    s_mov_b32 exec_hi, -1
    v_exp_f32 v52, v52
    v_exp_f32 v53, v53
    v_exp_f32 v54, v54
    v_smfmac_f32_16x16x64_bf16 v[144:147], v[152:155], v[40:47], v7
    v_exp_f32 v55, v55
    v_exp_f32 v56, v56
    v_exp_f32 v57, v57
    v_smfmac_f32_32x32x32_bf16 v[104:119], v[216:219], v[48:55], v7
    v_exp_f32 v58, v58
    v_exp_f32 v59, v59
    v_exp_f32 v60, v60
    v_smfmac_f32_16x16x64_bf16 v[144:147], v[152:155], v[48:55], v7
    v_exp_f32 v61, v61
    v_mfma_f32_32x32x16_bf16 v[40:55], v[204:207], v[8:11], 0
    buffer_load_dwordx4 v165, s[24:27], s84 offen offset:1024 nt lds
    v_exp_f32 v62, v62
    v_exp_f32 v63, v63
    v_exp_f32 v64, v64
    v_mfma_f32_32x32x16_bf16 v[40:55], v[208:211], v[12:15], v[40:55]
    v_exp_f32 v65, v65
    v_exp_f32 v66, v66
    v_exp_f32 v67, v67
    v_smfmac_f32_32x32x32_bf16 v[120:135], v[212:215], v[56:63], v7
    v_exp_f32 v68, v68
    v_exp_f32 v69, v69
    v_exp_f32 v70, v70
    v_smfmac_f32_16x16x64_bf16 v[148:151], v[152:155], v[56:63], v7
    v_exp_f32 v71, v71
    v_exp_f32 v40, v40
    v_exp_f32 v41, v41
    v_smfmac_f32_32x32x32_bf16 v[120:135], v[216:219], v[64:71], v7
    v_exp_f32 v42, v42
    v_exp_f32 v43, v43
    v_exp_f32 v44, v44
    v_smfmac_f32_16x16x64_bf16 v[148:151], v[152:155], v[64:71], v7
    v_exp_f32 v45, v45
    v_mfma_f32_32x32x16_bf16 v[56:71], v[204:207], v[16:19], 0
    v_exp_f32 v46, v46
    v_exp_f32 v47, v47
    v_exp_f32 v48, v48
    v_mfma_f32_32x32x16_bf16 v[56:71], v[208:211], v[20:23], v[56:71]
    buffer_load_dwordx4 v[204:207], v156, s[44:47], s71 offen offset:0
    v_exp_f32 v49, v49
    v_exp_f32 v50, v50
    v_exp_f32 v51, v51
    v_smfmac_f32_32x32x32_bf16 v[72:87], v[212:215], v[40:47], v7
    v_exp_f32 v52, v52
    v_exp_f32 v53, v53
    v_exp_f32 v54, v54
    v_smfmac_f32_16x16x64_bf16 v[136:139], v[152:155], v[40:47], v7
    v_exp_f32 v55, v55
    s_waitcnt vmcnt(22)
    v_exp_f32 v56, v56
    v_exp_f32 v57, v57
    v_smfmac_f32_32x32x32_bf16 v[72:87], v[216:219], v[48:55], v7
    buffer_load_dwordx4 v[208:211], v156, s[44:47], s71 offen offset:1024
    v_exp_f32 v58, v58
    v_exp_f32 v59, v59
    v_exp_f32 v60, v60
    v_smfmac_f32_16x16x64_bf16 v[136:139], v[152:155], v[48:55], v7
    v_exp_f32 v61, v61
    v_mfma_f32_32x32x16_bf16 v[40:55], v[220:223], v[24:27], 0
    buffer_load_dwordx4 v166, s[24:27], s84 offen offset:2048 nt lds
    v_exp_f32 v62, v62
    v_exp_f32 v63, v63
    v_exp_f32 v64, v64
    v_mfma_f32_32x32x16_bf16 v[40:55], v[224:227], v[28:31], v[40:55]
    v_exp_f32 v65, v65
    v_exp_f32 v66, v66
    v_exp_f32 v67, v67
    v_smfmac_f32_32x32x32_bf16 v[88:103], v[212:215], v[56:63], v7
    v_exp_f32 v68, v68
    v_exp_f32 v69, v69
    v_exp_f32 v70, v70
    v_smfmac_f32_16x16x64_bf16 v[140:143], v[152:155], v[56:63], v7
    v_exp_f32 v71, v71
    v_exp_f32 v40, v40
    v_exp_f32 v41, v41
    v_smfmac_f32_32x32x32_bf16 v[88:103], v[216:219], v[64:71], v7
    buffer_load_dwordx4 v[212:215], v156, s[44:47], s71 offen offset:2048
    v_exp_f32 v42, v42
    v_exp_f32 v43, v43
    v_exp_f32 v44, v44
    v_smfmac_f32_16x16x64_bf16 v[140:143], v[152:155], v[64:71], v7
    v_exp_f32 v45, v45
    v_mfma_f32_32x32x16_bf16 v[56:71], v[220:223], v[32:35], 0
    v_exp_f32 v46, v46
    v_exp_f32 v47, v47
    v_exp_f32 v48, v48
    v_mfma_f32_32x32x16_bf16 v[56:71], v[224:227], v[36:39], v[56:71]
    buffer_load_dwordx4 v[216:219], v156, s[44:47], s71 offen offset:3072
    v_exp_f32 v49, v49
    v_exp_f32 v50, v50
    v_exp_f32 v51, v51
    v_smfmac_f32_32x32x32_bf16 v[104:119], v[228:231], v[40:47], v7
    s_waitcnt vmcnt(24)
    ds_read_b64_tr_b16 a[0:1], v158 offset:8192
    ds_read_b64_tr_b16 a[2:3], v158 offset:8704
    ds_read_b64_tr_b16 a[4:5], v158 offset:8200
    ds_read_b64_tr_b16 a[6:7], v158 offset:8712
    v_exp_f32 v52, v52
    v_exp_f32 v53, v53
    v_exp_f32 v54, v54
    v_smfmac_f32_16x16x64_bf16 v[144:147], v[152:155], v[40:47], v7
    v_exp_f32 v55, v55
    v_exp_f32 v56, v56
    v_exp_f32 v57, v57
    v_smfmac_f32_32x32x32_bf16 v[104:119], v[232:235], v[48:55], v7
    v_exp_f32 v58, v58
    v_exp_f32 v59, v59
    v_exp_f32 v60, v60
    v_smfmac_f32_16x16x64_bf16 v[144:147], v[152:155], v[48:55], v7
    v_exp_f32 v61, v61
    v_mfma_f32_32x32x16_bf16 v[40:55], v[220:223], v[8:11], 0
    v_exp_f32 v62, v62
    v_exp_f32 v63, v63
    v_exp_f32 v64, v64
    v_mfma_f32_32x32x16_bf16 v[40:55], v[224:227], v[12:15], v[40:55]
    v_exp_f32 v65, v65
    v_exp_f32 v66, v66
    v_exp_f32 v67, v67
    v_smfmac_f32_32x32x32_bf16 v[120:135], v[228:231], v[56:63], v7
    s_waitcnt lgkmcnt(0)
    buffer_store_dwordx4 a[0:3], v254, s[44:47], s92 offen offset:0 sc1
    buffer_store_dwordx4 a[4:7], v254, s[44:47], s92 offen offset:1024 sc1
    v_exp_f32 v68, v68
    v_exp_f32 v69, v69
    v_exp_f32 v70, v70
    v_smfmac_f32_16x16x64_bf16 v[148:151], v[152:155], v[56:63], v7
    v_exp_f32 v71, v71
    v_exp_f32 v40, v40
    v_exp_f32 v41, v41
    v_smfmac_f32_32x32x32_bf16 v[120:135], v[232:235], v[64:71], v7
    v_exp_f32 v42, v42
    v_exp_f32 v43, v43
    v_exp_f32 v44, v44
    v_smfmac_f32_16x16x64_bf16 v[148:151], v[152:155], v[64:71], v7
    v_exp_f32 v45, v45
    v_mfma_f32_32x32x16_bf16 v[56:71], v[220:223], v[16:19], 0
    buffer_load_dwordx4 v167, s[24:27], s84 offen offset:3072 nt lds
    v_exp_f32 v46, v46
    v_exp_f32 v47, v47
    v_exp_f32 v48, v48
    v_mfma_f32_32x32x16_bf16 v[56:71], v[224:227], v[20:23], v[56:71]
    buffer_load_dwordx4 v[220:223], v156, s[44:47], s72 offen offset:0
    v_exp_f32 v49, v49
    v_exp_f32 v50, v50
    v_exp_f32 v51, v51
    v_smfmac_f32_32x32x32_bf16 v[72:87], v[228:231], v[40:47], v7
    v_exp_f32 v52, v52
    v_exp_f32 v53, v53
    v_exp_f32 v54, v54
    v_smfmac_f32_16x16x64_bf16 v[136:139], v[152:155], v[40:47], v7
    v_exp_f32 v55, v55
    s_waitcnt vmcnt(22)
    v_exp_f32 v56, v56
    v_exp_f32 v57, v57
    v_smfmac_f32_32x32x32_bf16 v[72:87], v[232:235], v[48:55], v7
    buffer_load_dwordx4 v[224:227], v156, s[44:47], s72 offen offset:1024
    v_exp_f32 v58, v58
    v_exp_f32 v59, v59
    v_exp_f32 v60, v60
    v_smfmac_f32_16x16x64_bf16 v[136:139], v[152:155], v[48:55], v7
    v_exp_f32 v61, v61
    v_mfma_f32_32x32x16_bf16 v[40:55], v[236:239], v[24:27], 0
    s_add_u32 m0, s90, 32768
    v_exp_f32 v62, v62
    v_exp_f32 v63, v63
    v_exp_f32 v64, v64
    v_mfma_f32_32x32x16_bf16 v[40:55], v[240:243], v[28:31], v[40:55]
    v_exp_f32 v65, v65
    v_exp_f32 v66, v66
    v_exp_f32 v67, v67
    v_smfmac_f32_32x32x32_bf16 v[88:103], v[228:231], v[56:63], v7
    v_exp_f32 v68, v68
    v_exp_f32 v69, v69
    v_exp_f32 v70, v70
    v_smfmac_f32_16x16x64_bf16 v[140:143], v[152:155], v[56:63], v7
    v_exp_f32 v71, v71
    v_exp_f32 v40, v40
    v_exp_f32 v41, v41
    v_smfmac_f32_32x32x32_bf16 v[88:103], v[232:235], v[64:71], v7
    buffer_load_dwordx4 v[228:231], v156, s[44:47], s72 offen offset:2048
    v_exp_f32 v42, v42
    v_exp_f32 v43, v43
    v_exp_f32 v44, v44
    v_smfmac_f32_16x16x64_bf16 v[140:143], v[152:155], v[64:71], v7
    v_exp_f32 v45, v45
    v_mfma_f32_32x32x16_bf16 v[56:71], v[236:239], v[32:35], 0
    buffer_load_dwordx4 v164, s[28:31], s84 offen offset:0 nt lds
    v_exp_f32 v46, v46
    v_exp_f32 v47, v47
    v_exp_f32 v48, v48
    v_mfma_f32_32x32x16_bf16 v[56:71], v[240:243], v[36:39], v[56:71]
    v_exp_f32 v49, v49
    v_exp_f32 v50, v50
    v_exp_f32 v51, v51
    v_smfmac_f32_32x32x32_bf16 v[104:119], v[244:247], v[40:47], v7
    v_exp_f32 v52, v52
    v_exp_f32 v53, v53
    v_exp_f32 v54, v54
    v_smfmac_f32_16x16x64_bf16 v[144:147], v[152:155], v[40:47], v7
    v_exp_f32 v55, v55
    v_exp_f32 v56, v56
    v_exp_f32 v57, v57
    v_smfmac_f32_32x32x32_bf16 v[104:119], v[248:251], v[48:55], v7
    buffer_load_dwordx4 v[232:235], v156, s[44:47], s72 offen offset:3072
    v_exp_f32 v58, v58
    v_exp_f32 v59, v59
    v_exp_f32 v60, v60
    v_smfmac_f32_16x16x64_bf16 v[144:147], v[152:155], v[48:55], v7
    v_exp_f32 v61, v61
    v_mfma_f32_32x32x16_bf16 v[40:55], v[236:239], v[8:11], 0
    v_exp_f32 v62, v62
    v_exp_f32 v63, v63
    v_exp_f32 v64, v64
    v_mfma_f32_32x32x16_bf16 v[40:55], v[240:243], v[12:15], v[40:55]
    v_exp_f32 v65, v65
    v_exp_f32 v66, v66
    v_exp_f32 v67, v67
    v_smfmac_f32_32x32x32_bf16 v[120:135], v[244:247], v[56:63], v7
    v_exp_f32 v68, v68
    v_exp_f32 v69, v69
    v_exp_f32 v70, v70
    v_smfmac_f32_16x16x64_bf16 v[148:151], v[152:155], v[56:63], v7
    v_exp_f32 v71, v71
    v_exp_f32 v40, v40
    v_exp_f32 v41, v41
    v_smfmac_f32_32x32x32_bf16 v[120:135], v[248:251], v[64:71], v7
    v_exp_f32 v42, v42
    v_exp_f32 v43, v43
    v_exp_f32 v44, v44
    v_smfmac_f32_16x16x64_bf16 v[148:151], v[152:155], v[64:71], v7
    v_exp_f32 v45, v45
    v_mfma_f32_32x32x16_bf16 v[56:71], v[236:239], v[16:19], 0
    v_exp_f32 v46, v46
    v_exp_f32 v47, v47
    v_exp_f32 v48, v48
    v_mfma_f32_32x32x16_bf16 v[56:71], v[240:243], v[20:23], v[56:71]
    v_exp_f32 v49, v49
    v_exp_f32 v50, v50
    v_exp_f32 v51, v51
    v_smfmac_f32_32x32x32_bf16 v[72:87], v[244:247], v[40:47], v7
    v_exp_f32 v52, v52
    v_exp_f32 v53, v53
    v_exp_f32 v54, v54
    v_smfmac_f32_16x16x64_bf16 v[136:139], v[152:155], v[40:47], v7
    v_exp_f32 v55, v55
    s_waitcnt vmcnt(20)
    v_exp_f32 v56, v56
    v_exp_f32 v57, v57
    v_smfmac_f32_32x32x32_bf16 v[72:87], v[248:251], v[48:55], v7
    buffer_load_dwordx4 v[236:239], v156, s[44:47], s73 offen offset:0
    v_exp_f32 v58, v58
    v_exp_f32 v59, v59
    v_exp_f32 v60, v60
    v_smfmac_f32_16x16x64_bf16 v[136:139], v[152:155], v[48:55], v7
    v_exp_f32 v61, v61
    v_mfma_f32_32x32x16_bf16 v[40:55], v[172:175], v[24:27], 0
    buffer_load_dwordx4 v165, s[28:31], s84 offen offset:1024 nt lds
    v_exp_f32 v62, v62
    v_exp_f32 v63, v63
    v_exp_f32 v64, v64
    v_mfma_f32_32x32x16_bf16 v[40:55], v[176:179], v[28:31], v[40:55]
    v_exp_f32 v65, v65
    v_exp_f32 v66, v66
    v_exp_f32 v67, v67
    v_smfmac_f32_32x32x32_bf16 v[88:103], v[244:247], v[56:63], v7
    v_exp_f32 v68, v68
    v_exp_f32 v69, v69
    v_exp_f32 v70, v70
    v_smfmac_f32_16x16x64_bf16 v[140:143], v[152:155], v[56:63], v7
    v_exp_f32 v71, v71
    v_exp_f32 v40, v40
    v_exp_f32 v41, v41
    v_smfmac_f32_32x32x32_bf16 v[88:103], v[248:251], v[64:71], v7
    buffer_load_dwordx4 v[240:243], v156, s[44:47], s73 offen offset:1024
    global_load_dword v159, v[4:5], off
    v_exp_f32 v42, v42
    v_exp_f32 v43, v43
    v_exp_f32 v44, v44
    v_smfmac_f32_16x16x64_bf16 v[140:143], v[152:155], v[64:71], v7
    v_exp_f32 v45, v45
    v_mfma_f32_32x32x16_bf16 v[56:71], v[172:175], v[32:35], 0
    v_exp_f32 v46, v46
    v_exp_f32 v47, v47
    v_exp_f32 v48, v48
    v_mfma_f32_32x32x16_bf16 v[56:71], v[176:179], v[36:39], v[56:71]
    v_exp_f32 v49, v49
    v_exp_f32 v50, v50
    v_exp_f32 v51, v51
    v_smfmac_f32_32x32x32_bf16 v[104:119], v[180:183], v[40:47], v7
    v_exp_f32 v52, v52
    v_exp_f32 v53, v53
    v_exp_f32 v54, v54
    v_smfmac_f32_16x16x64_bf16 v[144:147], v[152:155], v[40:47], v7
    v_exp_f32 v55, v55
    v_exp_f32 v56, v56
    v_exp_f32 v57, v57
    v_smfmac_f32_32x32x32_bf16 v[104:119], v[184:187], v[48:55], v7
    buffer_load_dwordx4 v[244:247], v156, s[44:47], s73 offen offset:2048
    v_exp_f32 v58, v58
    v_exp_f32 v59, v59
    v_exp_f32 v60, v60
    v_smfmac_f32_16x16x64_bf16 v[144:147], v[152:155], v[48:55], v7
    v_exp_f32 v61, v61
    v_mfma_f32_32x32x16_bf16 v[40:55], v[172:175], v[8:11], 0
    buffer_load_dwordx4 v166, s[28:31], s84 offen offset:2048 nt lds
    v_exp_f32 v62, v62
    v_exp_f32 v63, v63
    v_exp_f32 v64, v64
    v_mfma_f32_32x32x16_bf16 v[40:55], v[176:179], v[12:15], v[40:55]
    v_exp_f32 v65, v65
    v_exp_f32 v66, v66
    v_exp_f32 v67, v67
    v_smfmac_f32_32x32x32_bf16 v[120:135], v[180:183], v[56:63], v7
    v_exp_f32 v68, v68
    v_exp_f32 v69, v69
    v_exp_f32 v70, v70
    v_smfmac_f32_16x16x64_bf16 v[148:151], v[152:155], v[56:63], v7
    v_exp_f32 v71, v71
    v_exp_f32 v40, v40
    v_exp_f32 v41, v41
    v_smfmac_f32_32x32x32_bf16 v[120:135], v[184:187], v[64:71], v7
    buffer_load_dwordx4 v[248:251], v156, s[44:47], s73 offen offset:3072
    v_exp_f32 v42, v42
    v_exp_f32 v43, v43
    v_exp_f32 v44, v44
    v_smfmac_f32_16x16x64_bf16 v[148:151], v[152:155], v[64:71], v7
    v_exp_f32 v45, v45
    v_mfma_f32_32x32x16_bf16 v[56:71], v[172:175], v[16:19], 0
    v_exp_f32 v46, v46
    v_exp_f32 v47, v47
    v_exp_f32 v48, v48
    v_mfma_f32_32x32x16_bf16 v[56:71], v[176:179], v[20:23], v[56:71]
    v_exp_f32 v49, v49
    v_exp_f32 v50, v50
    v_exp_f32 v51, v51
    v_smfmac_f32_32x32x32_bf16 v[72:87], v[180:183], v[40:47], v7
    v_exp_f32 v52, v52
    v_exp_f32 v53, v53
    v_exp_f32 v54, v54
    v_smfmac_f32_16x16x64_bf16 v[136:139], v[152:155], v[40:47], v7
    v_exp_f32 v55, v55
    s_waitcnt vmcnt(22)
    v_exp_f32 v56, v56
    v_exp_f32 v57, v57
    v_smfmac_f32_32x32x32_bf16 v[72:87], v[184:187], v[48:55], v7
    buffer_load_dwordx4 v[172:175], v156, s[44:47], s74 offen offset:0
    v_exp_f32 v58, v58
    v_exp_f32 v59, v59
    v_exp_f32 v60, v60
    v_smfmac_f32_16x16x64_bf16 v[136:139], v[152:155], v[48:55], v7
    v_exp_f32 v61, v61
    v_mfma_f32_32x32x16_bf16 v[40:55], v[188:191], v[24:27], 0
    v_exp_f32 v62, v62
    v_exp_f32 v63, v63
    v_exp_f32 v64, v64
    v_mfma_f32_32x32x16_bf16 v[40:55], v[192:195], v[28:31], v[40:55]
    v_exp_f32 v65, v65
    v_exp_f32 v66, v66
    v_exp_f32 v67, v67
    v_smfmac_f32_32x32x32_bf16 v[88:103], v[180:183], v[56:63], v7
    v_exp_f32 v68, v68
    v_exp_f32 v69, v69
    v_exp_f32 v70, v70
    v_smfmac_f32_16x16x64_bf16 v[140:143], v[152:155], v[56:63], v7
    v_exp_f32 v71, v71
    v_exp_f32 v40, v40
    v_exp_f32 v41, v41
    v_smfmac_f32_32x32x32_bf16 v[88:103], v[184:187], v[64:71], v7
    buffer_load_dwordx4 v[176:179], v156, s[44:47], s74 offen offset:1024
    v_exp_f32 v42, v42
    v_exp_f32 v43, v43
    v_exp_f32 v44, v44
    v_smfmac_f32_16x16x64_bf16 v[140:143], v[152:155], v[64:71], v7
    v_exp_f32 v45, v45
    v_mfma_f32_32x32x16_bf16 v[56:71], v[188:191], v[32:35], 0
    buffer_load_dwordx4 v167, s[28:31], s84 offen offset:3072 nt lds
    v_exp_f32 v46, v46
    v_exp_f32 v47, v47
    v_exp_f32 v48, v48
    v_mfma_f32_32x32x16_bf16 v[56:71], v[192:195], v[36:39], v[56:71]
    v_exp_f32 v49, v49
    v_exp_f32 v50, v50
    v_exp_f32 v51, v51
    v_smfmac_f32_32x32x32_bf16 v[104:119], v[196:199], v[40:47], v7
    s_waitcnt vmcnt(16)
    s_mov_b64 exec, 1
    buffer_store_dword v6, v6, s[44:47], s93 offen sc1
    s_mov_b64 exec, -1
    v_exp_f32 v52, v52
    v_exp_f32 v53, v53
    v_exp_f32 v54, v54
    v_smfmac_f32_16x16x64_bf16 v[144:147], v[152:155], v[40:47], v7
    v_exp_f32 v55, v55
    v_exp_f32 v56, v56
    v_exp_f32 v57, v57
    v_smfmac_f32_32x32x32_bf16 v[104:119], v[200:203], v[48:55], v7
    buffer_load_dwordx4 v[180:183], v156, s[44:47], s74 offen offset:2048
    v_exp_f32 v58, v58
    v_exp_f32 v59, v59
    v_exp_f32 v60, v60
    v_smfmac_f32_16x16x64_bf16 v[144:147], v[152:155], v[48:55], v7
    v_exp_f32 v61, v61
    v_mfma_f32_32x32x16_bf16 v[40:55], v[188:191], v[8:11], 0
    s_add_u32 m0, s90, 4096
    v_exp_f32 v62, v62
    v_exp_f32 v63, v63
    v_exp_f32 v64, v64
    v_mfma_f32_32x32x16_bf16 v[40:55], v[192:195], v[12:15], v[40:55]
    v_exp_f32 v65, v65
    v_exp_f32 v66, v66
    v_exp_f32 v67, v67
    v_smfmac_f32_32x32x32_bf16 v[120:135], v[196:199], v[56:63], v7
    v_exp_f32 v68, v68
    v_exp_f32 v69, v69
    v_exp_f32 v70, v70
    v_smfmac_f32_16x16x64_bf16 v[148:151], v[152:155], v[56:63], v7
    v_exp_f32 v71, v71
    v_exp_f32 v40, v40
    v_exp_f32 v41, v41
    v_smfmac_f32_32x32x32_bf16 v[120:135], v[200:203], v[64:71], v7
    buffer_load_dwordx4 v[184:187], v156, s[44:47], s74 offen offset:3072
    v_exp_f32 v42, v42
    v_exp_f32 v43, v43
    v_exp_f32 v44, v44
    v_smfmac_f32_16x16x64_bf16 v[148:151], v[152:155], v[64:71], v7
    v_exp_f32 v45, v45
    v_mfma_f32_32x32x16_bf16 v[56:71], v[188:191], v[16:19], 0
    buffer_load_dwordx4 v164, s[24:27], s85 offen offset:0 nt lds
    v_exp_f32 v46, v46
    v_exp_f32 v47, v47
    v_exp_f32 v48, v48
    v_mfma_f32_32x32x16_bf16 v[56:71], v[192:195], v[20:23], v[56:71]
    v_exp_f32 v49, v49
    v_exp_f32 v50, v50
    v_exp_f32 v51, v51
    v_smfmac_f32_32x32x32_bf16 v[72:87], v[196:199], v[40:47], v7
    v_exp_f32 v52, v52
    v_exp_f32 v53, v53
    v_exp_f32 v54, v54
    v_smfmac_f32_16x16x64_bf16 v[136:139], v[152:155], v[40:47], v7
    v_exp_f32 v55, v55
    s_waitcnt vmcnt(22)
    v_exp_f32 v56, v56
    v_exp_f32 v57, v57
    v_smfmac_f32_32x32x32_bf16 v[72:87], v[200:203], v[48:55], v7
    buffer_load_dwordx4 v[188:191], v156, s[44:47], s75 offen offset:0
    v_exp_f32 v58, v58
    v_exp_f32 v59, v59
    v_exp_f32 v60, v60
    v_smfmac_f32_16x16x64_bf16 v[136:139], v[152:155], v[48:55], v7
    v_exp_f32 v61, v61
    v_mfma_f32_32x32x16_bf16 v[40:55], v[204:207], v[24:27], 0
    v_exp_f32 v62, v62
    v_exp_f32 v63, v63
    v_exp_f32 v64, v64
    v_mfma_f32_32x32x16_bf16 v[40:55], v[208:211], v[28:31], v[40:55]
    v_exp_f32 v65, v65
    v_exp_f32 v66, v66
    v_exp_f32 v67, v67
    v_smfmac_f32_32x32x32_bf16 v[88:103], v[196:199], v[56:63], v7
    v_exp_f32 v68, v68
    v_exp_f32 v69, v69
    v_exp_f32 v70, v70
    v_smfmac_f32_16x16x64_bf16 v[140:143], v[152:155], v[56:63], v7
    v_exp_f32 v71, v71
    v_exp_f32 v40, v40
    v_exp_f32 v41, v41
    v_smfmac_f32_32x32x32_bf16 v[88:103], v[200:203], v[64:71], v7
    buffer_load_dwordx4 v[192:195], v156, s[44:47], s75 offen offset:1024
    v_exp_f32 v42, v42
    v_exp_f32 v43, v43
    v_exp_f32 v44, v44
    v_smfmac_f32_16x16x64_bf16 v[140:143], v[152:155], v[64:71], v7
    v_exp_f32 v45, v45
    v_mfma_f32_32x32x16_bf16 v[56:71], v[204:207], v[32:35], 0
    v_exp_f32 v46, v46
    v_exp_f32 v47, v47
    v_exp_f32 v48, v48
    v_mfma_f32_32x32x16_bf16 v[56:71], v[208:211], v[36:39], v[56:71]
    v_exp_f32 v49, v49
    v_exp_f32 v50, v50
    v_exp_f32 v51, v51
    v_smfmac_f32_32x32x32_bf16 v[104:119], v[212:215], v[40:47], v7
    v_exp_f32 v52, v52
    v_exp_f32 v53, v53
    v_exp_f32 v54, v54
    v_smfmac_f32_16x16x64_bf16 v[144:147], v[152:155], v[40:47], v7
    v_exp_f32 v55, v55
    v_exp_f32 v56, v56
    v_exp_f32 v57, v57
    v_smfmac_f32_32x32x32_bf16 v[104:119], v[216:219], v[48:55], v7
    buffer_load_dwordx4 v[196:199], v156, s[44:47], s75 offen offset:2048
    v_exp_f32 v58, v58
    v_exp_f32 v59, v59
    v_exp_f32 v60, v60
    v_smfmac_f32_16x16x64_bf16 v[144:147], v[152:155], v[48:55], v7
    v_exp_f32 v61, v61
    v_mfma_f32_32x32x16_bf16 v[40:55], v[204:207], v[8:11], 0
    buffer_load_dwordx4 v165, s[24:27], s85 offen offset:1024 nt lds
    v_exp_f32 v62, v62
    v_exp_f32 v63, v63
    v_exp_f32 v64, v64
    v_mfma_f32_32x32x16_bf16 v[40:55], v[208:211], v[12:15], v[40:55]
    v_exp_f32 v65, v65
    v_exp_f32 v66, v66
    v_exp_f32 v67, v67
    v_smfmac_f32_32x32x32_bf16 v[120:135], v[212:215], v[56:63], v7
    v_exp_f32 v68, v68
    v_exp_f32 v69, v69
    v_exp_f32 v70, v70
    v_smfmac_f32_16x16x64_bf16 v[148:151], v[152:155], v[56:63], v7
    v_exp_f32 v71, v71
    v_exp_f32 v40, v40
    v_exp_f32 v41, v41
    v_smfmac_f32_32x32x32_bf16 v[120:135], v[216:219], v[64:71], v7
    buffer_load_dwordx4 v[200:203], v156, s[44:47], s75 offen offset:3072
    v_exp_f32 v42, v42
    v_exp_f32 v43, v43
    v_exp_f32 v44, v44
    v_smfmac_f32_16x16x64_bf16 v[148:151], v[152:155], v[64:71], v7
    v_exp_f32 v45, v45
    v_mfma_f32_32x32x16_bf16 v[56:71], v[204:207], v[16:19], 0
    v_exp_f32 v46, v46
    v_exp_f32 v47, v47
    v_exp_f32 v48, v48
    v_mfma_f32_32x32x16_bf16 v[56:71], v[208:211], v[20:23], v[56:71]
    v_exp_f32 v49, v49
    v_exp_f32 v50, v50
    v_exp_f32 v51, v51
    v_smfmac_f32_32x32x32_bf16 v[72:87], v[212:215], v[40:47], v7
    v_exp_f32 v52, v52
    v_exp_f32 v53, v53
    v_exp_f32 v54, v54
    v_smfmac_f32_16x16x64_bf16 v[136:139], v[152:155], v[40:47], v7
    v_exp_f32 v55, v55
    s_waitcnt vmcnt(19)
    v_exp_f32 v56, v56
    v_exp_f32 v57, v57
    v_smfmac_f32_32x32x32_bf16 v[72:87], v[216:219], v[48:55], v7
    buffer_load_dwordx4 v[204:207], v156, s[44:47], s76 offen offset:0
    v_exp_f32 v58, v58
    v_exp_f32 v59, v59
    v_exp_f32 v60, v60
    v_smfmac_f32_16x16x64_bf16 v[136:139], v[152:155], v[48:55], v7
    v_exp_f32 v61, v61
    v_mfma_f32_32x32x16_bf16 v[40:55], v[220:223], v[24:27], 0
    buffer_load_dwordx4 v166, s[24:27], s85 offen offset:2048 nt lds
    v_exp_f32 v62, v62
    v_exp_f32 v63, v63
    v_exp_f32 v64, v64
    v_mfma_f32_32x32x16_bf16 v[40:55], v[224:227], v[28:31], v[40:55]
    v_exp_f32 v65, v65
    v_exp_f32 v66, v66
    v_exp_f32 v67, v67
    v_smfmac_f32_32x32x32_bf16 v[88:103], v[212:215], v[56:63], v7
    v_exp_f32 v68, v68
    v_exp_f32 v69, v69
    v_exp_f32 v70, v70
    v_smfmac_f32_16x16x64_bf16 v[140:143], v[152:155], v[56:63], v7
    v_exp_f32 v71, v71
    v_exp_f32 v40, v40
    v_exp_f32 v41, v41
    v_smfmac_f32_32x32x32_bf16 v[88:103], v[216:219], v[64:71], v7
    buffer_load_dwordx4 v[208:211], v156, s[44:47], s76 offen offset:1024
    v_exp_f32 v42, v42
    v_exp_f32 v43, v43
    v_exp_f32 v44, v44
    v_smfmac_f32_16x16x64_bf16 v[140:143], v[152:155], v[64:71], v7
    v_exp_f32 v45, v45
    v_mfma_f32_32x32x16_bf16 v[56:71], v[220:223], v[32:35], 0
    v_exp_f32 v46, v46
    v_exp_f32 v47, v47
    v_exp_f32 v48, v48
    v_mfma_f32_32x32x16_bf16 v[56:71], v[224:227], v[36:39], v[56:71]
    v_exp_f32 v49, v49
    v_exp_f32 v50, v50
    v_exp_f32 v51, v51
    v_smfmac_f32_32x32x32_bf16 v[104:119], v[228:231], v[40:47], v7
    v_exp_f32 v52, v52
    v_exp_f32 v53, v53
    v_exp_f32 v54, v54
    v_smfmac_f32_16x16x64_bf16 v[144:147], v[152:155], v[40:47], v7
    v_exp_f32 v55, v55
    v_exp_f32 v56, v56
    v_exp_f32 v57, v57
    v_smfmac_f32_32x32x32_bf16 v[104:119], v[232:235], v[48:55], v7
    buffer_load_dwordx4 v[212:215], v156, s[44:47], s76 offen offset:2048
    v_exp_f32 v58, v58
    v_exp_f32 v59, v59
    v_exp_f32 v60, v60
    v_smfmac_f32_16x16x64_bf16 v[144:147], v[152:155], v[48:55], v7
    v_exp_f32 v61, v61
    v_mfma_f32_32x32x16_bf16 v[40:55], v[220:223], v[8:11], 0
    v_exp_f32 v62, v62
    v_exp_f32 v63, v63
    v_exp_f32 v64, v64
    v_mfma_f32_32x32x16_bf16 v[40:55], v[224:227], v[12:15], v[40:55]
    v_exp_f32 v65, v65
    v_exp_f32 v66, v66
    v_exp_f32 v67, v67
    v_smfmac_f32_32x32x32_bf16 v[120:135], v[228:231], v[56:63], v7
    v_exp_f32 v68, v68
    v_exp_f32 v69, v69
    v_exp_f32 v70, v70
    v_smfmac_f32_16x16x64_bf16 v[148:151], v[152:155], v[56:63], v7
    v_exp_f32 v71, v71
    v_exp_f32 v40, v40
    v_exp_f32 v41, v41
    v_smfmac_f32_32x32x32_bf16 v[120:135], v[232:235], v[64:71], v7
    buffer_load_dwordx4 v[216:219], v156, s[44:47], s76 offen offset:3072
    v_exp_f32 v42, v42
    v_exp_f32 v43, v43
    v_exp_f32 v44, v44
    v_smfmac_f32_16x16x64_bf16 v[148:151], v[152:155], v[64:71], v7
    v_exp_f32 v45, v45
    v_mfma_f32_32x32x16_bf16 v[56:71], v[220:223], v[16:19], 0
    buffer_load_dwordx4 v167, s[24:27], s85 offen offset:3072 nt lds
    v_exp_f32 v46, v46
    v_exp_f32 v47, v47
    v_exp_f32 v48, v48
    v_mfma_f32_32x32x16_bf16 v[56:71], v[224:227], v[20:23], v[56:71]
    v_exp_f32 v49, v49
    v_exp_f32 v50, v50
    v_exp_f32 v51, v51
    v_smfmac_f32_32x32x32_bf16 v[72:87], v[228:231], v[40:47], v7
    v_exp_f32 v52, v52
    v_exp_f32 v53, v53
    v_exp_f32 v54, v54
    v_smfmac_f32_16x16x64_bf16 v[136:139], v[152:155], v[40:47], v7
    v_exp_f32 v55, v55
    s_waitcnt vmcnt(18)
    v_exp_f32 v56, v56
    v_exp_f32 v57, v57
    v_smfmac_f32_32x32x32_bf16 v[72:87], v[232:235], v[48:55], v7
    buffer_load_dwordx4 v[220:223], v156, s[44:47], s77 offen offset:0
    v_exp_f32 v58, v58
    v_exp_f32 v59, v59
    v_exp_f32 v60, v60
    v_smfmac_f32_16x16x64_bf16 v[136:139], v[152:155], v[48:55], v7
    v_exp_f32 v61, v61
    v_mfma_f32_32x32x16_bf16 v[40:55], v[236:239], v[24:27], 0
    s_add_u32 m0, s90, 36864
    v_exp_f32 v62, v62
    v_exp_f32 v63, v63
    v_exp_f32 v64, v64
    v_mfma_f32_32x32x16_bf16 v[40:55], v[240:243], v[28:31], v[40:55]
    v_exp_f32 v65, v65
    v_exp_f32 v66, v66
    v_exp_f32 v67, v67
    v_smfmac_f32_32x32x32_bf16 v[88:103], v[228:231], v[56:63], v7
    v_exp_f32 v68, v68
    v_exp_f32 v69, v69
    v_exp_f32 v70, v70
    v_smfmac_f32_16x16x64_bf16 v[140:143], v[152:155], v[56:63], v7
    v_exp_f32 v71, v71
    v_exp_f32 v40, v40
    v_exp_f32 v41, v41
    v_smfmac_f32_32x32x32_bf16 v[88:103], v[232:235], v[64:71], v7
    buffer_load_dwordx4 v[224:227], v156, s[44:47], s77 offen offset:1024
    v_exp_f32 v42, v42
    v_exp_f32 v43, v43
    v_exp_f32 v44, v44
    v_smfmac_f32_16x16x64_bf16 v[140:143], v[152:155], v[64:71], v7
    v_exp_f32 v45, v45
    v_mfma_f32_32x32x16_bf16 v[56:71], v[236:239], v[32:35], 0
    buffer_load_dwordx4 v164, s[28:31], s85 offen offset:0 nt lds
    v_exp_f32 v46, v46
    v_exp_f32 v47, v47
    v_exp_f32 v48, v48
    v_mfma_f32_32x32x16_bf16 v[56:71], v[240:243], v[36:39], v[56:71]
    v_exp_f32 v49, v49
    v_exp_f32 v50, v50
    v_exp_f32 v51, v51
    v_smfmac_f32_32x32x32_bf16 v[104:119], v[244:247], v[40:47], v7
    v_exp_f32 v52, v52
    v_exp_f32 v53, v53
    v_exp_f32 v54, v54
    v_smfmac_f32_16x16x64_bf16 v[144:147], v[152:155], v[40:47], v7
    v_exp_f32 v55, v55
    v_exp_f32 v56, v56
    v_exp_f32 v57, v57
    v_smfmac_f32_32x32x32_bf16 v[104:119], v[248:251], v[48:55], v7
    buffer_load_dwordx4 v[228:231], v156, s[44:47], s77 offen offset:2048
    v_exp_f32 v58, v58
    v_exp_f32 v59, v59
    v_exp_f32 v60, v60
    v_smfmac_f32_16x16x64_bf16 v[144:147], v[152:155], v[48:55], v7
    v_exp_f32 v61, v61
    v_mfma_f32_32x32x16_bf16 v[40:55], v[236:239], v[8:11], 0
    v_exp_f32 v62, v62
    v_exp_f32 v63, v63
    v_exp_f32 v64, v64
    v_mfma_f32_32x32x16_bf16 v[40:55], v[240:243], v[12:15], v[40:55]
    v_exp_f32 v65, v65
    v_exp_f32 v66, v66
    v_exp_f32 v67, v67
    v_smfmac_f32_32x32x32_bf16 v[120:135], v[244:247], v[56:63], v7
    v_exp_f32 v68, v68
    v_exp_f32 v69, v69
    v_exp_f32 v70, v70
    v_smfmac_f32_16x16x64_bf16 v[148:151], v[152:155], v[56:63], v7
    v_exp_f32 v71, v71
    v_exp_f32 v40, v40
    v_exp_f32 v41, v41
    v_smfmac_f32_32x32x32_bf16 v[120:135], v[248:251], v[64:71], v7
    buffer_load_dwordx4 v[232:235], v156, s[44:47], s77 offen offset:3072
    v_exp_f32 v42, v42
    v_exp_f32 v43, v43
    v_exp_f32 v44, v44
    v_smfmac_f32_16x16x64_bf16 v[148:151], v[152:155], v[64:71], v7
    v_exp_f32 v45, v45
    v_mfma_f32_32x32x16_bf16 v[56:71], v[236:239], v[16:19], 0
    v_exp_f32 v46, v46
    v_exp_f32 v47, v47
    v_exp_f32 v48, v48
    v_mfma_f32_32x32x16_bf16 v[56:71], v[240:243], v[20:23], v[56:71]
    v_exp_f32 v49, v49
    v_exp_f32 v50, v50
    v_exp_f32 v51, v51
    v_smfmac_f32_32x32x32_bf16 v[72:87], v[244:247], v[40:47], v7
    v_exp_f32 v52, v52
    v_exp_f32 v53, v53
    v_exp_f32 v54, v54
    v_smfmac_f32_16x16x64_bf16 v[136:139], v[152:155], v[40:47], v7
    v_exp_f32 v55, v55
    s_waitcnt vmcnt(17)
    v_exp_f32 v56, v56
    v_exp_f32 v57, v57
    v_smfmac_f32_32x32x32_bf16 v[72:87], v[248:251], v[48:55], v7
    buffer_load_dwordx4 v[236:239], v156, s[44:47], s78 offen offset:0
    v_exp_f32 v58, v58
    v_exp_f32 v59, v59
    v_exp_f32 v60, v60
    v_smfmac_f32_16x16x64_bf16 v[136:139], v[152:155], v[48:55], v7
    v_exp_f32 v61, v61
    v_mfma_f32_32x32x16_bf16 v[40:55], v[172:175], v[24:27], 0
    buffer_load_dwordx4 v165, s[28:31], s85 offen offset:1024 nt lds
    v_exp_f32 v62, v62
    v_exp_f32 v63, v63
    v_exp_f32 v64, v64
    v_mfma_f32_32x32x16_bf16 v[40:55], v[176:179], v[28:31], v[40:55]
    v_exp_f32 v65, v65
    v_exp_f32 v66, v66
    v_exp_f32 v67, v67
    v_smfmac_f32_32x32x32_bf16 v[88:103], v[244:247], v[56:63], v7
    v_exp_f32 v68, v68
    v_exp_f32 v69, v69
    v_exp_f32 v70, v70
    v_smfmac_f32_16x16x64_bf16 v[140:143], v[152:155], v[56:63], v7
    v_exp_f32 v71, v71
    v_exp_f32 v40, v40
    v_exp_f32 v41, v41
    v_smfmac_f32_32x32x32_bf16 v[88:103], v[248:251], v[64:71], v7
    buffer_load_dwordx4 v[240:243], v156, s[44:47], s78 offen offset:1024
    v_exp_f32 v42, v42
    v_exp_f32 v43, v43
    v_exp_f32 v44, v44
    v_smfmac_f32_16x16x64_bf16 v[140:143], v[152:155], v[64:71], v7
    v_exp_f32 v45, v45
    v_mfma_f32_32x32x16_bf16 v[56:71], v[172:175], v[32:35], 0
    v_exp_f32 v46, v46
    v_exp_f32 v47, v47
    v_exp_f32 v48, v48
    v_mfma_f32_32x32x16_bf16 v[56:71], v[176:179], v[36:39], v[56:71]
    v_exp_f32 v49, v49
    v_exp_f32 v50, v50
    v_exp_f32 v51, v51
    v_smfmac_f32_32x32x32_bf16 v[104:119], v[180:183], v[40:47], v7
    v_exp_f32 v52, v52
    v_exp_f32 v53, v53
    v_exp_f32 v54, v54
    v_smfmac_f32_16x16x64_bf16 v[144:147], v[152:155], v[40:47], v7
    v_exp_f32 v55, v55
    v_exp_f32 v56, v56
    v_exp_f32 v57, v57
    v_smfmac_f32_32x32x32_bf16 v[104:119], v[184:187], v[48:55], v7
    buffer_load_dwordx4 v[244:247], v156, s[44:47], s78 offen offset:2048
    v_exp_f32 v58, v58
    v_exp_f32 v59, v59
    v_exp_f32 v60, v60
    v_smfmac_f32_16x16x64_bf16 v[144:147], v[152:155], v[48:55], v7
    v_exp_f32 v61, v61
    v_mfma_f32_32x32x16_bf16 v[40:55], v[172:175], v[8:11], 0
    buffer_load_dwordx4 v166, s[28:31], s85 offen offset:2048 nt lds
    v_exp_f32 v62, v62
    v_exp_f32 v63, v63
    v_exp_f32 v64, v64
    v_mfma_f32_32x32x16_bf16 v[40:55], v[176:179], v[12:15], v[40:55]
    v_exp_f32 v65, v65
    v_exp_f32 v66, v66
    v_exp_f32 v67, v67
    v_smfmac_f32_32x32x32_bf16 v[120:135], v[180:183], v[56:63], v7
    v_exp_f32 v68, v68
    v_exp_f32 v69, v69
    v_exp_f32 v70, v70
    v_smfmac_f32_16x16x64_bf16 v[148:151], v[152:155], v[56:63], v7
    v_exp_f32 v71, v71
    v_exp_f32 v40, v40
    v_exp_f32 v41, v41
    v_smfmac_f32_32x32x32_bf16 v[120:135], v[184:187], v[64:71], v7
    buffer_load_dwordx4 v[248:251], v156, s[44:47], s78 offen offset:3072
    v_exp_f32 v42, v42
    v_exp_f32 v43, v43
    v_exp_f32 v44, v44
    v_smfmac_f32_16x16x64_bf16 v[148:151], v[152:155], v[64:71], v7
    v_exp_f32 v45, v45
    v_mfma_f32_32x32x16_bf16 v[56:71], v[172:175], v[16:19], 0
    v_exp_f32 v46, v46
    v_exp_f32 v47, v47
    v_exp_f32 v48, v48
    v_mfma_f32_32x32x16_bf16 v[56:71], v[176:179], v[20:23], v[56:71]
    v_exp_f32 v49, v49
    v_exp_f32 v50, v50
    v_exp_f32 v51, v51
    v_smfmac_f32_32x32x32_bf16 v[72:87], v[180:183], v[40:47], v7
    v_exp_f32 v52, v52
    v_exp_f32 v53, v53
    v_exp_f32 v54, v54
    v_smfmac_f32_16x16x64_bf16 v[136:139], v[152:155], v[40:47], v7
    v_exp_f32 v55, v55
    s_waitcnt vmcnt(17)
    v_exp_f32 v56, v56
    v_exp_f32 v57, v57
    v_smfmac_f32_32x32x32_bf16 v[72:87], v[184:187], v[48:55], v7
    buffer_load_dwordx4 v[172:175], v156, s[44:47], s79 offen offset:0
    v_exp_f32 v58, v58
    v_exp_f32 v59, v59
    v_exp_f32 v60, v60
    v_smfmac_f32_16x16x64_bf16 v[136:139], v[152:155], v[48:55], v7
    v_exp_f32 v61, v61
    v_mfma_f32_32x32x16_bf16 v[40:55], v[188:191], v[24:27], 0
    v_exp_f32 v62, v62
    v_exp_f32 v63, v63
    v_exp_f32 v64, v64
    v_mfma_f32_32x32x16_bf16 v[40:55], v[192:195], v[28:31], v[40:55]
    v_exp_f32 v65, v65
    v_exp_f32 v66, v66
    v_exp_f32 v67, v67
    v_smfmac_f32_32x32x32_bf16 v[88:103], v[180:183], v[56:63], v7
    v_exp_f32 v68, v68
    v_exp_f32 v69, v69
    v_exp_f32 v70, v70
    v_smfmac_f32_16x16x64_bf16 v[140:143], v[152:155], v[56:63], v7
    v_exp_f32 v71, v71
    v_exp_f32 v40, v40
    v_exp_f32 v41, v41
    v_smfmac_f32_32x32x32_bf16 v[88:103], v[184:187], v[64:71], v7
    buffer_load_dwordx4 v[176:179], v156, s[44:47], s79 offen offset:1024
    v_exp_f32 v42, v42
    v_exp_f32 v43, v43
    v_exp_f32 v44, v44
    v_smfmac_f32_16x16x64_bf16 v[140:143], v[152:155], v[64:71], v7
    v_exp_f32 v45, v45
    v_mfma_f32_32x32x16_bf16 v[56:71], v[188:191], v[32:35], 0
    buffer_load_dwordx4 v167, s[28:31], s85 offen offset:3072 nt lds
    v_exp_f32 v46, v46
    v_exp_f32 v47, v47
    v_exp_f32 v48, v48
    v_mfma_f32_32x32x16_bf16 v[56:71], v[192:195], v[36:39], v[56:71]
    v_exp_f32 v49, v49
    v_exp_f32 v50, v50
    v_exp_f32 v51, v51
    v_smfmac_f32_32x32x32_bf16 v[104:119], v[196:199], v[40:47], v7
    v_exp_f32 v52, v52
    v_exp_f32 v53, v53
    v_exp_f32 v54, v54
    v_smfmac_f32_16x16x64_bf16 v[144:147], v[152:155], v[40:47], v7
    v_exp_f32 v55, v55
    v_exp_f32 v56, v56
    v_exp_f32 v57, v57
    v_smfmac_f32_32x32x32_bf16 v[104:119], v[200:203], v[48:55], v7
    buffer_load_dwordx4 v[180:183], v156, s[44:47], s79 offen offset:2048
    v_exp_f32 v58, v58
    v_exp_f32 v59, v59
    v_exp_f32 v60, v60
    v_smfmac_f32_16x16x64_bf16 v[144:147], v[152:155], v[48:55], v7
    v_exp_f32 v61, v61
    v_mfma_f32_32x32x16_bf16 v[40:55], v[188:191], v[8:11], 0
    s_add_u32 m0, s90, 65536
    v_exp_f32 v62, v62
    v_exp_f32 v63, v63
    v_exp_f32 v64, v64
    v_mfma_f32_32x32x16_bf16 v[40:55], v[192:195], v[12:15], v[40:55]
    v_exp_f32 v65, v65
    v_exp_f32 v66, v66
    v_exp_f32 v67, v67
    v_smfmac_f32_32x32x32_bf16 v[120:135], v[196:199], v[56:63], v7
    v_exp_f32 v68, v68
    v_exp_f32 v69, v69
    v_exp_f32 v70, v70
    v_smfmac_f32_16x16x64_bf16 v[148:151], v[152:155], v[56:63], v7
    v_exp_f32 v71, v71
    v_exp_f32 v40, v40
    v_exp_f32 v41, v41
    v_smfmac_f32_32x32x32_bf16 v[120:135], v[200:203], v[64:71], v7
    buffer_load_dwordx4 v[184:187], v156, s[44:47], s79 offen offset:3072
    v_exp_f32 v42, v42
    v_exp_f32 v43, v43
    v_exp_f32 v44, v44
    v_smfmac_f32_16x16x64_bf16 v[148:151], v[152:155], v[64:71], v7
    v_exp_f32 v45, v45
    v_mfma_f32_32x32x16_bf16 v[56:71], v[188:191], v[16:19], 0
    buffer_load_dwordx4 v168, s[32:35], s86 offen offset:0 nt lds
    v_exp_f32 v46, v46
    v_exp_f32 v47, v47
    v_exp_f32 v48, v48
    v_mfma_f32_32x32x16_bf16 v[56:71], v[192:195], v[20:23], v[56:71]
    v_exp_f32 v49, v49
    v_exp_f32 v50, v50
    v_exp_f32 v51, v51
    v_smfmac_f32_32x32x32_bf16 v[72:87], v[196:199], v[40:47], v7
    v_exp_f32 v52, v52
    v_exp_f32 v53, v53
    v_exp_f32 v54, v54
    v_smfmac_f32_16x16x64_bf16 v[136:139], v[152:155], v[40:47], v7
    v_exp_f32 v55, v55
    s_waitcnt vmcnt(18)
    v_exp_f32 v56, v56
    v_exp_f32 v57, v57
    v_smfmac_f32_32x32x32_bf16 v[72:87], v[200:203], v[48:55], v7
    buffer_load_dwordx4 v[188:191], v157, s[44:47], 0 offen offset:0
    v_exp_f32 v58, v58
    v_exp_f32 v59, v59
    v_exp_f32 v60, v60
    v_smfmac_f32_16x16x64_bf16 v[136:139], v[152:155], v[48:55], v7
    v_exp_f32 v61, v61
    v_mfma_f32_32x32x16_bf16 v[40:55], v[204:207], v[24:27], 0
    v_exp_f32 v62, v62
    v_exp_f32 v63, v63
    v_exp_f32 v64, v64
    v_mfma_f32_32x32x16_bf16 v[40:55], v[208:211], v[28:31], v[40:55]
    v_exp_f32 v65, v65
    v_exp_f32 v66, v66
    v_exp_f32 v67, v67
    v_smfmac_f32_32x32x32_bf16 v[88:103], v[196:199], v[56:63], v7
    v_exp_f32 v68, v68
    v_exp_f32 v69, v69
    v_exp_f32 v70, v70
    v_smfmac_f32_16x16x64_bf16 v[140:143], v[152:155], v[56:63], v7
    v_exp_f32 v71, v71
    v_exp_f32 v40, v40
    v_exp_f32 v41, v41
    v_smfmac_f32_32x32x32_bf16 v[88:103], v[200:203], v[64:71], v7
    buffer_load_dwordx4 v[192:195], v157, s[44:47], 0 offen offset:1024
    v_exp_f32 v42, v42
    v_exp_f32 v43, v43
    v_exp_f32 v44, v44
    v_smfmac_f32_16x16x64_bf16 v[140:143], v[152:155], v[64:71], v7
    v_exp_f32 v45, v45
    v_mfma_f32_32x32x16_bf16 v[56:71], v[204:207], v[32:35], 0
    v_exp_f32 v46, v46
    v_exp_f32 v47, v47
    v_exp_f32 v48, v48
    v_mfma_f32_32x32x16_bf16 v[56:71], v[208:211], v[36:39], v[56:71]
    v_exp_f32 v49, v49
    v_exp_f32 v50, v50
    v_exp_f32 v51, v51
    v_smfmac_f32_32x32x32_bf16 v[104:119], v[212:215], v[40:47], v7
    buffer_load_dword v158, v6, s[44:47], s94 offen sc1
    v_exp_f32 v52, v52
    v_exp_f32 v53, v53
    v_exp_f32 v54, v54
    v_smfmac_f32_16x16x64_bf16 v[144:147], v[152:155], v[40:47], v7
    v_exp_f32 v55, v55
    v_exp_f32 v56, v56
    v_exp_f32 v57, v57
    v_smfmac_f32_32x32x32_bf16 v[104:119], v[216:219], v[48:55], v7
    buffer_load_dwordx4 v[196:199], v157, s[44:47], 0 offen offset:2048
    v_exp_f32 v58, v58
    v_exp_f32 v59, v59
    v_exp_f32 v60, v60
    v_smfmac_f32_16x16x64_bf16 v[144:147], v[152:155], v[48:55], v7
    v_exp_f32 v61, v61
    v_mfma_f32_32x32x16_bf16 v[40:55], v[204:207], v[8:11], 0
    buffer_load_dwordx4 v169, s[32:35], s86 offen offset:1024 nt lds
    v_exp_f32 v62, v62
    v_exp_f32 v63, v63
    v_exp_f32 v64, v64
    v_mfma_f32_32x32x16_bf16 v[40:55], v[208:211], v[12:15], v[40:55]
    v_exp_f32 v65, v65
    v_exp_f32 v66, v66
    v_exp_f32 v67, v67
    v_smfmac_f32_32x32x32_bf16 v[120:135], v[212:215], v[56:63], v7
    v_exp_f32 v68, v68
    v_exp_f32 v69, v69
    v_exp_f32 v70, v70
    v_smfmac_f32_16x16x64_bf16 v[148:151], v[152:155], v[56:63], v7
    v_exp_f32 v71, v71
    v_exp_f32 v40, v40
    v_exp_f32 v41, v41
    v_smfmac_f32_32x32x32_bf16 v[120:135], v[216:219], v[64:71], v7
    buffer_load_dwordx4 v[200:203], v157, s[44:47], 0 offen offset:3072
    global_load_dword v159, v[4:5], off
    v_exp_f32 v42, v42
    v_exp_f32 v43, v43
    v_exp_f32 v44, v44
    v_smfmac_f32_16x16x64_bf16 v[148:151], v[152:155], v[64:71], v7
    v_exp_f32 v45, v45
    v_mfma_f32_32x32x16_bf16 v[56:71], v[204:207], v[16:19], 0
    v_exp_f32 v46, v46
    v_exp_f32 v47, v47
    v_exp_f32 v48, v48
    v_mfma_f32_32x32x16_bf16 v[56:71], v[208:211], v[20:23], v[56:71]
    v_exp_f32 v49, v49
    v_exp_f32 v50, v50
    v_exp_f32 v51, v51
    v_smfmac_f32_32x32x32_bf16 v[72:87], v[212:215], v[40:47], v7
    v_exp_f32 v52, v52
    v_exp_f32 v53, v53
    v_exp_f32 v54, v54
    v_smfmac_f32_16x16x64_bf16 v[136:139], v[152:155], v[40:47], v7
    v_exp_f32 v55, v55
    s_waitcnt vmcnt(19)
    v_exp_f32 v56, v56
    v_exp_f32 v57, v57
    v_smfmac_f32_32x32x32_bf16 v[72:87], v[216:219], v[48:55], v7
    buffer_load_dwordx4 v[204:207], v157, s[44:47], s65 offen offset:0
    v_exp_f32 v58, v58
    v_exp_f32 v59, v59
    v_exp_f32 v60, v60
    v_smfmac_f32_16x16x64_bf16 v[136:139], v[152:155], v[48:55], v7
    v_exp_f32 v61, v61
    v_mfma_f32_32x32x16_bf16 v[40:55], v[220:223], v[24:27], 0
    buffer_load_dwordx4 v170, s[32:35], s86 offen offset:2048 nt lds
    v_exp_f32 v62, v62
    v_exp_f32 v63, v63
    v_exp_f32 v64, v64
    v_mfma_f32_32x32x16_bf16 v[40:55], v[224:227], v[28:31], v[40:55]
    v_exp_f32 v65, v65
    v_exp_f32 v66, v66
    v_exp_f32 v67, v67
    v_smfmac_f32_32x32x32_bf16 v[88:103], v[212:215], v[56:63], v7
    v_exp_f32 v68, v68
    v_exp_f32 v69, v69
    v_exp_f32 v70, v70
    v_smfmac_f32_16x16x64_bf16 v[140:143], v[152:155], v[56:63], v7
    v_exp_f32 v71, v71
    v_exp_f32 v40, v40
    v_exp_f32 v41, v41
    v_smfmac_f32_32x32x32_bf16 v[88:103], v[216:219], v[64:71], v7
    buffer_load_dwordx4 v[208:211], v157, s[44:47], s65 offen offset:1024
    v_exp_f32 v42, v42
    v_exp_f32 v43, v43
    v_exp_f32 v44, v44
    v_smfmac_f32_16x16x64_bf16 v[140:143], v[152:155], v[64:71], v7
    v_exp_f32 v45, v45
    v_mfma_f32_32x32x16_bf16 v[56:71], v[220:223], v[32:35], 0
    v_exp_f32 v46, v46
    v_exp_f32 v47, v47
    v_exp_f32 v48, v48
    v_mfma_f32_32x32x16_bf16 v[56:71], v[224:227], v[36:39], v[56:71]
    v_exp_f32 v49, v49
    v_exp_f32 v50, v50
    v_exp_f32 v51, v51
    v_smfmac_f32_32x32x32_bf16 v[104:119], v[228:231], v[40:47], v7
    v_exp_f32 v52, v52
    v_exp_f32 v53, v53
    v_exp_f32 v54, v54
    v_smfmac_f32_16x16x64_bf16 v[144:147], v[152:155], v[40:47], v7
    v_exp_f32 v55, v55
    v_exp_f32 v56, v56
    v_exp_f32 v57, v57
    v_smfmac_f32_32x32x32_bf16 v[104:119], v[232:235], v[48:55], v7
    buffer_load_dwordx4 v[212:215], v157, s[44:47], s65 offen offset:2048
    v_exp_f32 v58, v58
    v_exp_f32 v59, v59
    v_exp_f32 v60, v60
    v_smfmac_f32_16x16x64_bf16 v[144:147], v[152:155], v[48:55], v7
    v_exp_f32 v61, v61
    v_mfma_f32_32x32x16_bf16 v[40:55], v[220:223], v[8:11], 0
    v_exp_f32 v62, v62
    v_exp_f32 v63, v63
    v_exp_f32 v64, v64
    v_mfma_f32_32x32x16_bf16 v[40:55], v[224:227], v[12:15], v[40:55]
    v_exp_f32 v65, v65
    v_exp_f32 v66, v66
    v_exp_f32 v67, v67
    v_smfmac_f32_32x32x32_bf16 v[120:135], v[228:231], v[56:63], v7
    v_exp_f32 v68, v68
    v_exp_f32 v69, v69
    v_exp_f32 v70, v70
    v_smfmac_f32_16x16x64_bf16 v[148:151], v[152:155], v[56:63], v7
    v_exp_f32 v71, v71
    v_exp_f32 v40, v40
    v_exp_f32 v41, v41
    v_smfmac_f32_32x32x32_bf16 v[120:135], v[232:235], v[64:71], v7
    buffer_load_dwordx4 v[216:219], v157, s[44:47], s65 offen offset:3072
    v_exp_f32 v42, v42
    v_exp_f32 v43, v43
    v_exp_f32 v44, v44
    v_smfmac_f32_16x16x64_bf16 v[148:151], v[152:155], v[64:71], v7
    v_exp_f32 v45, v45
    v_mfma_f32_32x32x16_bf16 v[56:71], v[220:223], v[16:19], 0
    buffer_load_dwordx4 v171, s[32:35], s86 offen offset:3072 nt lds
    v_exp_f32 v46, v46
    v_exp_f32 v47, v47
    v_exp_f32 v48, v48
    v_mfma_f32_32x32x16_bf16 v[56:71], v[224:227], v[20:23], v[56:71]
    v_exp_f32 v49, v49
    v_exp_f32 v50, v50
    v_exp_f32 v51, v51
    v_smfmac_f32_32x32x32_bf16 v[72:87], v[228:231], v[40:47], v7
    v_exp_f32 v52, v52
    v_exp_f32 v53, v53
    v_exp_f32 v54, v54
    v_smfmac_f32_16x16x64_bf16 v[136:139], v[152:155], v[40:47], v7
    v_exp_f32 v55, v55
    s_waitcnt vmcnt(19)
    v_exp_f32 v56, v56
    v_exp_f32 v57, v57
    v_smfmac_f32_32x32x32_bf16 v[72:87], v[232:235], v[48:55], v7
    buffer_load_dwordx4 v[220:223], v157, s[44:47], s66 offen offset:0
    v_exp_f32 v58, v58
    v_exp_f32 v59, v59
    v_exp_f32 v60, v60
    v_smfmac_f32_16x16x64_bf16 v[136:139], v[152:155], v[48:55], v7
    v_exp_f32 v61, v61
    v_mfma_f32_32x32x16_bf16 v[40:55], v[236:239], v[24:27], 0
    s_add_u32 m0, s90, 69632
    v_xor_b32 v168, 128, v168
    v_xor_b32 v169, 128, v169
    v_xor_b32 v170, 128, v170
    v_xor_b32 v171, 128, v171
    v_exp_f32 v62, v62
    v_exp_f32 v63, v63
    v_exp_f32 v64, v64
    v_mfma_f32_32x32x16_bf16 v[40:55], v[240:243], v[28:31], v[40:55]
    v_exp_f32 v65, v65
    v_exp_f32 v66, v66
    v_exp_f32 v67, v67
    v_smfmac_f32_32x32x32_bf16 v[88:103], v[228:231], v[56:63], v7
    v_exp_f32 v68, v68
    v_exp_f32 v69, v69
    v_exp_f32 v70, v70
    v_smfmac_f32_16x16x64_bf16 v[140:143], v[152:155], v[56:63], v7
    v_exp_f32 v71, v71
    v_exp_f32 v40, v40
    v_exp_f32 v41, v41
    v_smfmac_f32_32x32x32_bf16 v[88:103], v[232:235], v[64:71], v7
    buffer_load_dwordx4 v[224:227], v157, s[44:47], s66 offen offset:1024
    v_exp_f32 v42, v42
    v_exp_f32 v43, v43
    v_exp_f32 v44, v44
    v_smfmac_f32_16x16x64_bf16 v[140:143], v[152:155], v[64:71], v7
    v_exp_f32 v45, v45
    v_mfma_f32_32x32x16_bf16 v[56:71], v[236:239], v[32:35], 0
    buffer_load_dwordx4 v168, s[32:35], s87 offen offset:0 nt lds
    v_exp_f32 v46, v46
    v_exp_f32 v47, v47
    v_exp_f32 v48, v48
    v_mfma_f32_32x32x16_bf16 v[56:71], v[240:243], v[36:39], v[56:71]
    v_exp_f32 v49, v49
    v_exp_f32 v50, v50
    v_exp_f32 v51, v51
    v_smfmac_f32_32x32x32_bf16 v[104:119], v[244:247], v[40:47], v7
    v_exp_f32 v52, v52
    v_exp_f32 v53, v53
    v_exp_f32 v54, v54
    v_smfmac_f32_16x16x64_bf16 v[144:147], v[152:155], v[40:47], v7
    v_exp_f32 v55, v55
    v_exp_f32 v56, v56
    v_exp_f32 v57, v57
    v_smfmac_f32_32x32x32_bf16 v[104:119], v[248:251], v[48:55], v7
    buffer_load_dwordx4 v[228:231], v157, s[44:47], s66 offen offset:2048
    v_exp_f32 v58, v58
    v_exp_f32 v59, v59
    v_exp_f32 v60, v60
    v_smfmac_f32_16x16x64_bf16 v[144:147], v[152:155], v[48:55], v7
    v_exp_f32 v61, v61
    v_mfma_f32_32x32x16_bf16 v[40:55], v[236:239], v[8:11], 0
    v_exp_f32 v62, v62
    v_exp_f32 v63, v63
    v_exp_f32 v64, v64
    v_mfma_f32_32x32x16_bf16 v[40:55], v[240:243], v[12:15], v[40:55]
    v_exp_f32 v65, v65
    v_exp_f32 v66, v66
    v_exp_f32 v67, v67
    v_smfmac_f32_32x32x32_bf16 v[120:135], v[244:247], v[56:63], v7
    v_exp_f32 v68, v68
    v_exp_f32 v69, v69
    v_exp_f32 v70, v70
    v_smfmac_f32_16x16x64_bf16 v[148:151], v[152:155], v[56:63], v7
    v_exp_f32 v71, v71
    v_exp_f32 v40, v40
    v_exp_f32 v41, v41
    v_smfmac_f32_32x32x32_bf16 v[120:135], v[248:251], v[64:71], v7
    buffer_load_dwordx4 v[232:235], v157, s[44:47], s66 offen offset:3072
    v_exp_f32 v42, v42
    v_exp_f32 v43, v43
    v_exp_f32 v44, v44
    v_smfmac_f32_16x16x64_bf16 v[148:151], v[152:155], v[64:71], v7
    v_exp_f32 v45, v45
    v_mfma_f32_32x32x16_bf16 v[56:71], v[236:239], v[16:19], 0
    v_exp_f32 v46, v46
    v_exp_f32 v47, v47
    v_exp_f32 v48, v48
    v_mfma_f32_32x32x16_bf16 v[56:71], v[240:243], v[20:23], v[56:71]
    v_exp_f32 v49, v49
    v_exp_f32 v50, v50
    v_exp_f32 v51, v51
    v_smfmac_f32_32x32x32_bf16 v[72:87], v[244:247], v[40:47], v7
    v_exp_f32 v52, v52
    v_exp_f32 v53, v53
    v_exp_f32 v54, v54
    v_smfmac_f32_16x16x64_bf16 v[136:139], v[152:155], v[40:47], v7
    v_exp_f32 v55, v55
    s_waitcnt vmcnt(19)
    v_exp_f32 v56, v56
    v_exp_f32 v57, v57
    v_smfmac_f32_32x32x32_bf16 v[72:87], v[248:251], v[48:55], v7
    buffer_load_dwordx4 v[236:239], v157, s[44:47], s67 offen offset:0
    v_exp_f32 v58, v58
    v_exp_f32 v59, v59
    v_exp_f32 v60, v60
    v_smfmac_f32_16x16x64_bf16 v[136:139], v[152:155], v[48:55], v7
    v_exp_f32 v61, v61
    v_mfma_f32_32x32x16_bf16 v[40:55], v[172:175], v[24:27], 0
    buffer_load_dwordx4 v169, s[32:35], s87 offen offset:1024 nt lds
    v_exp_f32 v62, v62
    v_exp_f32 v63, v63
    v_exp_f32 v64, v64
    v_mfma_f32_32x32x16_bf16 v[40:55], v[176:179], v[28:31], v[40:55]
    v_exp_f32 v65, v65
    v_exp_f32 v66, v66
    v_exp_f32 v67, v67
    v_smfmac_f32_32x32x32_bf16 v[88:103], v[244:247], v[56:63], v7
    v_exp_f32 v68, v68
    v_exp_f32 v69, v69
    v_exp_f32 v70, v70
    v_smfmac_f32_16x16x64_bf16 v[140:143], v[152:155], v[56:63], v7
    v_exp_f32 v71, v71
    v_exp_f32 v40, v40
    v_exp_f32 v41, v41
    v_smfmac_f32_32x32x32_bf16 v[88:103], v[248:251], v[64:71], v7
    buffer_load_dwordx4 v[240:243], v157, s[44:47], s67 offen offset:1024
    v_exp_f32 v42, v42
    v_exp_f32 v43, v43
    v_exp_f32 v44, v44
    v_smfmac_f32_16x16x64_bf16 v[140:143], v[152:155], v[64:71], v7
    v_exp_f32 v45, v45
    v_mfma_f32_32x32x16_bf16 v[56:71], v[172:175], v[32:35], 0
    v_exp_f32 v46, v46
    v_exp_f32 v47, v47
    v_exp_f32 v48, v48
    v_mfma_f32_32x32x16_bf16 v[56:71], v[176:179], v[36:39], v[56:71]
    v_exp_f32 v49, v49
    v_exp_f32 v50, v50
    v_exp_f32 v51, v51
    v_smfmac_f32_32x32x32_bf16 v[104:119], v[180:183], v[40:47], v7
    v_exp_f32 v52, v52
    v_exp_f32 v53, v53
    v_exp_f32 v54, v54
    v_smfmac_f32_16x16x64_bf16 v[144:147], v[152:155], v[40:47], v7
    v_exp_f32 v55, v55
    v_exp_f32 v56, v56
    v_exp_f32 v57, v57
    v_smfmac_f32_32x32x32_bf16 v[104:119], v[184:187], v[48:55], v7
    buffer_load_dwordx4 v[244:247], v157, s[44:47], s67 offen offset:2048
    v_exp_f32 v58, v58
    v_exp_f32 v59, v59
    v_exp_f32 v60, v60
    v_smfmac_f32_16x16x64_bf16 v[144:147], v[152:155], v[48:55], v7
    v_exp_f32 v61, v61
    v_mfma_f32_32x32x16_bf16 v[40:55], v[172:175], v[8:11], 0
    buffer_load_dwordx4 v170, s[32:35], s87 offen offset:2048 nt lds
    v_exp_f32 v62, v62
    v_exp_f32 v63, v63
    v_exp_f32 v64, v64
    v_mfma_f32_32x32x16_bf16 v[40:55], v[176:179], v[12:15], v[40:55]
    v_exp_f32 v65, v65
    v_exp_f32 v66, v66
    v_exp_f32 v67, v67
    v_smfmac_f32_32x32x32_bf16 v[120:135], v[180:183], v[56:63], v7
    v_exp_f32 v68, v68
    v_exp_f32 v69, v69
    v_exp_f32 v70, v70
    v_smfmac_f32_16x16x64_bf16 v[148:151], v[152:155], v[56:63], v7
    v_exp_f32 v71, v71
    v_exp_f32 v40, v40
    v_exp_f32 v41, v41
    v_smfmac_f32_32x32x32_bf16 v[120:135], v[184:187], v[64:71], v7
    buffer_load_dwordx4 v[248:251], v157, s[44:47], s67 offen offset:3072
    v_exp_f32 v42, v42
    v_exp_f32 v43, v43
    v_exp_f32 v44, v44
    v_smfmac_f32_16x16x64_bf16 v[148:151], v[152:155], v[64:71], v7
    v_exp_f32 v45, v45
    v_mfma_f32_32x32x16_bf16 v[56:71], v[172:175], v[16:19], 0
    v_exp_f32 v46, v46
    v_exp_f32 v47, v47
    v_exp_f32 v48, v48
    v_mfma_f32_32x32x16_bf16 v[56:71], v[176:179], v[20:23], v[56:71]
    v_exp_f32 v49, v49
    v_exp_f32 v50, v50
    v_exp_f32 v51, v51
    v_smfmac_f32_32x32x32_bf16 v[72:87], v[180:183], v[40:47], v7
    s_waitcnt vmcnt(21)
    v_cmp_eq_u32 vcc, -1, v158
    s_nop 0
    s_lshl_b64 vcc, vcc, 32
    s_cbranch_vccnz L_spin_3
L_spin_3_ok:
    v_exp_f32 v52, v52
    v_exp_f32 v53, v53
    v_exp_f32 v54, v54
    v_smfmac_f32_16x16x64_bf16 v[136:139], v[152:155], v[40:47], v7
    v_exp_f32 v55, v55
    s_waitcnt vmcnt(18)
    v_exp_f32 v56, v56
    v_exp_f32 v57, v57
    v_smfmac_f32_32x32x32_bf16 v[72:87], v[184:187], v[48:55], v7
    buffer_load_dwordx4 v[172:175], v157, s[44:47], s68 offen offset:0
    v_exp_f32 v58, v58
    v_exp_f32 v59, v59
    v_exp_f32 v60, v60
    v_smfmac_f32_16x16x64_bf16 v[136:139], v[152:155], v[48:55], v7
    v_exp_f32 v61, v61
    v_mfma_f32_32x32x16_bf16 v[40:55], v[188:191], v[24:27], 0
    v_exp_f32 v62, v62
    v_exp_f32 v63, v63
    v_exp_f32 v64, v64
    v_mfma_f32_32x32x16_bf16 v[40:55], v[192:195], v[28:31], v[40:55]
    v_exp_f32 v65, v65
    v_exp_f32 v66, v66
    v_exp_f32 v67, v67
    v_smfmac_f32_32x32x32_bf16 v[88:103], v[180:183], v[56:63], v7
    buffer_load_dwordx4 a[0:3], v254, s[44:47], 0 offen offset:0
    buffer_load_dwordx4 a[4:7], v254, s[44:47], 0 offen offset:1024
    v_exp_f32 v68, v68
    v_exp_f32 v69, v69
    v_exp_f32 v70, v70
    v_smfmac_f32_16x16x64_bf16 v[140:143], v[152:155], v[56:63], v7
    v_exp_f32 v71, v71
    v_exp_f32 v40, v40
    v_exp_f32 v41, v41
    v_smfmac_f32_32x32x32_bf16 v[88:103], v[184:187], v[64:71], v7
    buffer_load_dwordx4 v[176:179], v157, s[44:47], s68 offen offset:1024
    v_exp_f32 v42, v42
    v_exp_f32 v43, v43
    v_exp_f32 v44, v44
    v_smfmac_f32_16x16x64_bf16 v[140:143], v[152:155], v[64:71], v7
    v_exp_f32 v45, v45
    v_mfma_f32_32x32x16_bf16 v[56:71], v[188:191], v[32:35], 0
    buffer_load_dwordx4 v171, s[32:35], s87 offen offset:3072 nt lds
    v_exp_f32 v46, v46
    v_exp_f32 v47, v47
    v_exp_f32 v48, v48
    v_mfma_f32_32x32x16_bf16 v[56:71], v[192:195], v[36:39], v[56:71]
    v_exp_f32 v49, v49
    v_exp_f32 v50, v50
    v_exp_f32 v51, v51
    v_smfmac_f32_32x32x32_bf16 v[104:119], v[196:199], v[40:47], v7
    buffer_load_dwordx4 a[8:11], v254, s[44:47], 0 offen offset:2048
    v_exp_f32 v52, v52
    v_exp_f32 v53, v53
    v_exp_f32 v54, v54
    v_smfmac_f32_16x16x64_bf16 v[144:147], v[152:155], v[40:47], v7
    v_exp_f32 v55, v55
    v_exp_f32 v56, v56
    v_exp_f32 v57, v57
    v_smfmac_f32_32x32x32_bf16 v[104:119], v[200:203], v[48:55], v7
    buffer_load_dwordx4 v[180:183], v157, s[44:47], s68 offen offset:2048
    v_exp_f32 v58, v58
    v_exp_f32 v59, v59
    v_exp_f32 v60, v60
    v_smfmac_f32_16x16x64_bf16 v[144:147], v[152:155], v[48:55], v7
    v_exp_f32 v61, v61
    v_mfma_f32_32x32x16_bf16 v[40:55], v[188:191], v[8:11], 0
    v_exp_f32 v62, v62
    v_exp_f32 v63, v63
    v_exp_f32 v64, v64
    v_mfma_f32_32x32x16_bf16 v[40:55], v[192:195], v[12:15], v[40:55]
    v_exp_f32 v65, v65
    v_exp_f32 v66, v66
    v_exp_f32 v67, v67
    v_smfmac_f32_32x32x32_bf16 v[120:135], v[196:199], v[56:63], v7
    buffer_load_dwordx4 a[12:15], v254, s[44:47], 0 offen offset:3072
    buffer_load_dwordx4 a[16:19], v254, s[44:47], s65 offen offset:0
    v_exp_f32 v68, v68
    v_exp_f32 v69, v69
    v_exp_f32 v70, v70
    v_smfmac_f32_16x16x64_bf16 v[148:151], v[152:155], v[56:63], v7
    v_exp_f32 v71, v71
    v_exp_f32 v40, v40
    v_exp_f32 v41, v41
    v_smfmac_f32_32x32x32_bf16 v[120:135], v[200:203], v[64:71], v7
    buffer_load_dwordx4 v[184:187], v157, s[44:47], s68 offen offset:3072
    v_exp_f32 v42, v42
    v_exp_f32 v43, v43
    v_exp_f32 v44, v44
    v_smfmac_f32_16x16x64_bf16 v[148:151], v[152:155], v[64:71], v7
    v_exp_f32 v45, v45
    v_mfma_f32_32x32x16_bf16 v[56:71], v[188:191], v[16:19], 0
    v_exp_f32 v46, v46
    v_exp_f32 v47, v47
    v_exp_f32 v48, v48
    v_mfma_f32_32x32x16_bf16 v[56:71], v[192:195], v[20:23], v[56:71]
    v_exp_f32 v49, v49
    v_exp_f32 v50, v50
    v_exp_f32 v51, v51
    v_smfmac_f32_32x32x32_bf16 v[72:87], v[196:199], v[40:47], v7
    buffer_load_dwordx4 a[20:23], v254, s[44:47], s65 offen offset:1024
    v_exp_f32 v52, v52
    v_exp_f32 v53, v53
    v_exp_f32 v54, v54
    v_smfmac_f32_16x16x64_bf16 v[136:139], v[152:155], v[40:47], v7
    v_exp_f32 v55, v55
    s_waitcnt vmcnt(23)
    v_exp_f32 v56, v56
    v_exp_f32 v57, v57
    v_smfmac_f32_32x32x32_bf16 v[72:87], v[200:203], v[48:55], v7
    buffer_load_dwordx4 v[188:191], v157, s[44:47], s69 offen offset:0
    v_exp_f32 v58, v58
    v_exp_f32 v59, v59
    v_exp_f32 v60, v60
    v_smfmac_f32_16x16x64_bf16 v[136:139], v[152:155], v[48:55], v7
    v_exp_f32 v61, v61
    v_mfma_f32_32x32x16_bf16 v[40:55], v[204:207], v[24:27], 0
    v_exp_f32 v62, v62
    v_exp_f32 v63, v63
    v_exp_f32 v64, v64
    v_mfma_f32_32x32x16_bf16 v[40:55], v[208:211], v[28:31], v[40:55]
    v_exp_f32 v65, v65
    v_exp_f32 v66, v66
    v_exp_f32 v67, v67
    v_smfmac_f32_32x32x32_bf16 v[88:103], v[196:199], v[56:63], v7
    buffer_load_dwordx4 a[24:27], v254, s[44:47], s65 offen offset:2048
    buffer_load_dwordx4 a[28:31], v254, s[44:47], s65 offen offset:3072
    v_exp_f32 v68, v68
    v_exp_f32 v69, v69
    v_exp_f32 v70, v70
    v_smfmac_f32_16x16x64_bf16 v[140:143], v[152:155], v[56:63], v7
    v_exp_f32 v71, v71
    v_exp_f32 v40, v40
    v_exp_f32 v41, v41
    v_smfmac_f32_32x32x32_bf16 v[88:103], v[200:203], v[64:71], v7
    buffer_load_dwordx4 v[192:195], v157, s[44:47], s69 offen offset:1024
    v_exp_f32 v42, v42
    v_exp_f32 v43, v43
    v_exp_f32 v44, v44
    v_smfmac_f32_16x16x64_bf16 v[140:143], v[152:155], v[64:71], v7
    v_exp_f32 v45, v45
    v_mfma_f32_32x32x16_bf16 v[56:71], v[204:207], v[32:35], 0
    v_exp_f32 v46, v46
    v_exp_f32 v47, v47
    v_exp_f32 v48, v48
    v_mfma_f32_32x32x16_bf16 v[56:71], v[208:211], v[36:39], v[56:71]
    v_exp_f32 v49, v49
    v_exp_f32 v50, v50
    v_exp_f32 v51, v51
    v_smfmac_f32_32x32x32_bf16 v[104:119], v[212:215], v[40:47], v7
    buffer_load_dwordx4 a[32:35], v254, s[44:47], s66 offen offset:0
    v_exp_f32 v52, v52
    v_exp_f32 v53, v53
    v_exp_f32 v54, v54
    v_smfmac_f32_16x16x64_bf16 v[144:147], v[152:155], v[40:47], v7
    v_exp_f32 v55, v55
    v_exp_f32 v56, v56
    v_exp_f32 v57, v57
    v_smfmac_f32_32x32x32_bf16 v[104:119], v[216:219], v[48:55], v7
    buffer_load_dwordx4 v[196:199], v157, s[44:47], s69 offen offset:2048
    v_exp_f32 v58, v58
    v_exp_f32 v59, v59
    v_exp_f32 v60, v60
    v_smfmac_f32_16x16x64_bf16 v[144:147], v[152:155], v[48:55], v7
    v_exp_f32 v61, v61
    v_mfma_f32_32x32x16_bf16 v[40:55], v[204:207], v[8:11], 0
    v_exp_f32 v62, v62
    v_exp_f32 v63, v63
    v_exp_f32 v64, v64
    v_mfma_f32_32x32x16_bf16 v[40:55], v[208:211], v[12:15], v[40:55]
    v_exp_f32 v65, v65
    v_exp_f32 v66, v66
    v_exp_f32 v67, v67
    v_smfmac_f32_32x32x32_bf16 v[120:135], v[212:215], v[56:63], v7
    buffer_load_dwordx4 a[36:39], v254, s[44:47], s66 offen offset:1024
    v_exp_f32 v68, v68
    v_exp_f32 v69, v69
    v_exp_f32 v70, v70
    v_smfmac_f32_16x16x64_bf16 v[148:151], v[152:155], v[56:63], v7
    v_exp_f32 v71, v71
    v_exp_f32 v40, v40
    v_exp_f32 v41, v41
    v_smfmac_f32_32x32x32_bf16 v[120:135], v[216:219], v[64:71], v7
    buffer_load_dwordx4 v[200:203], v157, s[44:47], s69 offen offset:3072
    v_exp_f32 v42, v42
    v_exp_f32 v43, v43
    v_exp_f32 v44, v44
    v_smfmac_f32_16x16x64_bf16 v[148:151], v[152:155], v[64:71], v7
    v_exp_f32 v45, v45
    v_mfma_f32_32x32x16_bf16 v[56:71], v[204:207], v[16:19], 0
    v_exp_f32 v46, v46
    v_exp_f32 v47, v47
    v_exp_f32 v48, v48
    v_mfma_f32_32x32x16_bf16 v[56:71], v[208:211], v[20:23], v[56:71]
    v_exp_f32 v49, v49
    v_exp_f32 v50, v50
    v_exp_f32 v51, v51
    v_smfmac_f32_32x32x32_bf16 v[72:87], v[212:215], v[40:47], v7
    buffer_load_dwordx4 a[40:43], v254, s[44:47], s66 offen offset:2048
    buffer_load_dwordx4 a[44:47], v254, s[44:47], s66 offen offset:3072
    v_exp_f32 v52, v52
    v_exp_f32 v53, v53
    v_exp_f32 v54, v54
    v_smfmac_f32_16x16x64_bf16 v[136:139], v[152:155], v[40:47], v7
    v_exp_f32 v55, v55
    s_waitcnt vmcnt(27)
    v_exp_f32 v56, v56
    v_exp_f32 v57, v57
    v_smfmac_f32_32x32x32_bf16 v[72:87], v[216:219], v[48:55], v7
    buffer_load_dwordx4 v[204:207], v157, s[44:47], s70 offen offset:0
    v_exp_f32 v58, v58
    v_exp_f32 v59, v59
    v_exp_f32 v60, v60
    v_smfmac_f32_16x16x64_bf16 v[136:139], v[152:155], v[48:55], v7
    v_exp_f32 v61, v61
    v_mfma_f32_32x32x16_bf16 v[40:55], v[220:223], v[24:27], 0
    v_exp_f32 v62, v62
    v_exp_f32 v63, v63
    v_exp_f32 v64, v64
    v_mfma_f32_32x32x16_bf16 v[40:55], v[224:227], v[28:31], v[40:55]
    v_exp_f32 v65, v65
    v_exp_f32 v66, v66
    v_exp_f32 v67, v67
    v_smfmac_f32_32x32x32_bf16 v[88:103], v[212:215], v[56:63], v7
    buffer_load_dwordx4 a[48:51], v254, s[44:47], s67 offen offset:0
    v_exp_f32 v68, v68
    v_exp_f32 v69, v69
    v_exp_f32 v70, v70
    v_smfmac_f32_16x16x64_bf16 v[140:143], v[152:155], v[56:63], v7
    v_exp_f32 v71, v71
    v_exp_f32 v40, v40
    v_exp_f32 v41, v41
    v_smfmac_f32_32x32x32_bf16 v[88:103], v[216:219], v[64:71], v7
    buffer_load_dwordx4 v[208:211], v157, s[44:47], s70 offen offset:1024
    v_exp_f32 v42, v42
    v_exp_f32 v43, v43
    v_exp_f32 v44, v44
    v_smfmac_f32_16x16x64_bf16 v[140:143], v[152:155], v[64:71], v7
    v_exp_f32 v45, v45
    v_mfma_f32_32x32x16_bf16 v[56:71], v[220:223], v[32:35], 0
    v_exp_f32 v46, v46
    v_exp_f32 v47, v47
    v_exp_f32 v48, v48
    v_mfma_f32_32x32x16_bf16 v[56:71], v[224:227], v[36:39], v[56:71]
    v_exp_f32 v49, v49
    v_exp_f32 v50, v50
    v_exp_f32 v51, v51
    v_smfmac_f32_32x32x32_bf16 v[104:119], v[228:231], v[40:47], v7
    buffer_load_dwordx4 a[52:55], v254, s[44:47], s67 offen offset:1024
    buffer_load_dwordx4 a[56:59], v254, s[44:47], s67 offen offset:2048
    v_exp_f32 v52, v52
    v_exp_f32 v53, v53
    v_exp_f32 v54, v54
    v_smfmac_f32_16x16x64_bf16 v[144:147], v[152:155], v[40:47], v7
    v_exp_f32 v55, v55
    v_exp_f32 v56, v56
    v_exp_f32 v57, v57
    v_smfmac_f32_32x32x32_bf16 v[104:119], v[232:235], v[48:55], v7
    buffer_load_dwordx4 v[212:215], v157, s[44:47], s70 offen offset:2048
    v_exp_f32 v58, v58
    v_exp_f32 v59, v59
    v_exp_f32 v60, v60
    v_smfmac_f32_16x16x64_bf16 v[144:147], v[152:155], v[48:55], v7
    v_exp_f32 v61, v61
    v_mfma_f32_32x32x16_bf16 v[40:55], v[220:223], v[8:11], 0
    v_exp_f32 v62, v62
    v_exp_f32 v63, v63
    v_exp_f32 v64, v64
    v_mfma_f32_32x32x16_bf16 v[40:55], v[224:227], v[12:15], v[40:55]
    v_exp_f32 v65, v65
    v_exp_f32 v66, v66
    v_exp_f32 v67, v67
    v_smfmac_f32_32x32x32_bf16 v[120:135], v[228:231], v[56:63], v7
    buffer_load_dwordx4 a[60:63], v254, s[44:47], s67 offen offset:3072
    v_exp_f32 v68, v68
    v_exp_f32 v69, v69
    v_exp_f32 v70, v70
    v_smfmac_f32_16x16x64_bf16 v[148:151], v[152:155], v[56:63], v7
    v_exp_f32 v71, v71
    v_exp_f32 v40, v40
    v_exp_f32 v41, v41
    v_smfmac_f32_32x32x32_bf16 v[120:135], v[232:235], v[64:71], v7
    buffer_load_dwordx4 v[216:219], v157, s[44:47], s70 offen offset:3072
    v_exp_f32 v42, v42
    v_exp_f32 v43, v43
    v_exp_f32 v44, v44
    v_smfmac_f32_16x16x64_bf16 v[148:151], v[152:155], v[64:71], v7
    v_exp_f32 v45, v45
    v_mfma_f32_32x32x16_bf16 v[56:71], v[220:223], v[16:19], 0
    v_exp_f32 v46, v46
    v_exp_f32 v47, v47
    v_exp_f32 v48, v48
    v_mfma_f32_32x32x16_bf16 v[56:71], v[224:227], v[20:23], v[56:71]
    v_exp_f32 v49, v49
    v_exp_f32 v50, v50
    v_exp_f32 v51, v51
    v_smfmac_f32_32x32x32_bf16 v[72:87], v[228:231], v[40:47], v7
    buffer_load_dwordx4 a[64:67], v254, s[44:47], s68 offen offset:0
    buffer_load_dwordx4 a[68:71], v254, s[44:47], s68 offen offset:1024
    v_exp_f32 v52, v52
    v_exp_f32 v53, v53
    v_exp_f32 v54, v54
    v_smfmac_f32_16x16x64_bf16 v[136:139], v[152:155], v[40:47], v7
    v_exp_f32 v55, v55
    s_waitcnt vmcnt(31)
    v_exp_f32 v56, v56
    v_exp_f32 v57, v57
    v_smfmac_f32_32x32x32_bf16 v[72:87], v[232:235], v[48:55], v7
    buffer_load_dwordx4 v[220:223], v157, s[44:47], s71 offen offset:0
    v_exp_f32 v58, v58
    v_exp_f32 v59, v59
    v_exp_f32 v60, v60
    v_smfmac_f32_16x16x64_bf16 v[136:139], v[152:155], v[48:55], v7
    v_exp_f32 v61, v61
    v_mfma_f32_32x32x16_bf16 v[40:55], v[236:239], v[24:27], 0
    v_exp_f32 v62, v62
    v_exp_f32 v63, v63
    v_exp_f32 v64, v64
    v_mfma_f32_32x32x16_bf16 v[40:55], v[240:243], v[28:31], v[40:55]
    v_exp_f32 v65, v65
    v_exp_f32 v66, v66
    v_exp_f32 v67, v67
    v_smfmac_f32_32x32x32_bf16 v[88:103], v[228:231], v[56:63], v7
    buffer_load_dwordx4 a[72:75], v254, s[44:47], s68 offen offset:2048
    v_exp_f32 v68, v68
    v_exp_f32 v69, v69
    v_exp_f32 v70, v70
    v_smfmac_f32_16x16x64_bf16 v[140:143], v[152:155], v[56:63], v7
    v_exp_f32 v71, v71
    v_exp_f32 v40, v40
    v_exp_f32 v41, v41
    v_smfmac_f32_32x32x32_bf16 v[88:103], v[232:235], v[64:71], v7
    buffer_load_dwordx4 v[224:227], v157, s[44:47], s71 offen offset:1024
    v_exp_f32 v42, v42
    v_exp_f32 v43, v43
    v_exp_f32 v44, v44
    v_smfmac_f32_16x16x64_bf16 v[140:143], v[152:155], v[64:71], v7
    v_exp_f32 v45, v45
    v_mfma_f32_32x32x16_bf16 v[56:71], v[236:239], v[32:35], 0
    v_exp_f32 v46, v46
    v_exp_f32 v47, v47
    v_exp_f32 v48, v48
    v_mfma_f32_32x32x16_bf16 v[56:71], v[240:243], v[36:39], v[56:71]
    v_exp_f32 v49, v49
    v_exp_f32 v50, v50
    v_exp_f32 v51, v51
    v_smfmac_f32_32x32x32_bf16 v[104:119], v[244:247], v[40:47], v7
    buffer_load_dwordx4 a[76:79], v254, s[44:47], s68 offen offset:3072
    v_exp_f32 v52, v52
    v_exp_f32 v53, v53
    v_exp_f32 v54, v54
    v_smfmac_f32_16x16x64_bf16 v[144:147], v[152:155], v[40:47], v7
    v_exp_f32 v55, v55
    v_exp_f32 v56, v56
    v_exp_f32 v57, v57
    v_smfmac_f32_32x32x32_bf16 v[104:119], v[248:251], v[48:55], v7
    buffer_load_dwordx4 v[228:231], v157, s[44:47], s71 offen offset:2048
    v_exp_f32 v58, v58
    v_exp_f32 v59, v59
    v_exp_f32 v60, v60
    v_smfmac_f32_16x16x64_bf16 v[144:147], v[152:155], v[48:55], v7
    v_exp_f32 v61, v61
    v_mfma_f32_32x32x16_bf16 v[40:55], v[236:239], v[8:11], 0
    v_exp_f32 v62, v62
    v_exp_f32 v63, v63
    v_exp_f32 v64, v64
    v_mfma_f32_32x32x16_bf16 v[40:55], v[240:243], v[12:15], v[40:55]
    v_exp_f32 v65, v65
    v_exp_f32 v66, v66
    v_exp_f32 v67, v67
    v_smfmac_f32_32x32x32_bf16 v[120:135], v[244:247], v[56:63], v7
    buffer_load_dwordx4 a[80:83], v254, s[44:47], s69 offen offset:0
    buffer_load_dwordx4 a[84:87], v254, s[44:47], s69 offen offset:1024
    v_exp_f32 v68, v68
    v_exp_f32 v69, v69
    v_exp_f32 v70, v70
    v_smfmac_f32_16x16x64_bf16 v[148:151], v[152:155], v[56:63], v7
    v_exp_f32 v71, v71
    v_exp_f32 v40, v40
    v_exp_f32 v41, v41
    v_smfmac_f32_32x32x32_bf16 v[120:135], v[248:251], v[64:71], v7
    buffer_load_dwordx4 v[232:235], v157, s[44:47], s71 offen offset:3072
    v_exp_f32 v42, v42
    v_exp_f32 v43, v43
    v_exp_f32 v44, v44
    v_smfmac_f32_16x16x64_bf16 v[148:151], v[152:155], v[64:71], v7
    v_exp_f32 v45, v45
    v_mfma_f32_32x32x16_bf16 v[56:71], v[236:239], v[16:19], 0
    v_exp_f32 v46, v46
    v_exp_f32 v47, v47
    v_exp_f32 v48, v48
    v_mfma_f32_32x32x16_bf16 v[56:71], v[240:243], v[20:23], v[56:71]
    v_exp_f32 v49, v49
    v_exp_f32 v50, v50
    v_exp_f32 v51, v51
    v_smfmac_f32_32x32x32_bf16 v[72:87], v[244:247], v[40:47], v7
    buffer_load_dwordx4 a[88:91], v254, s[44:47], s69 offen offset:2048
    v_exp_f32 v52, v52
    v_exp_f32 v53, v53
    v_exp_f32 v54, v54
    v_smfmac_f32_16x16x64_bf16 v[136:139], v[152:155], v[40:47], v7
    v_exp_f32 v55, v55
    s_waitcnt vmcnt(30)
    v_exp_f32 v56, v56
    v_exp_f32 v57, v57
    v_smfmac_f32_32x32x32_bf16 v[72:87], v[248:251], v[48:55], v7
    buffer_load_dwordx4 v[236:239], v157, s[44:47], s72 offen offset:0
    v_exp_f32 v58, v58
    v_exp_f32 v59, v59
    v_exp_f32 v60, v60
    v_smfmac_f32_16x16x64_bf16 v[136:139], v[152:155], v[48:55], v7
    v_exp_f32 v61, v61
    v_mfma_f32_32x32x16_bf16 v[40:55], v[172:175], v[24:27], 0
    v_exp_f32 v62, v62
    v_exp_f32 v63, v63
    v_exp_f32 v64, v64
    v_mfma_f32_32x32x16_bf16 v[40:55], v[176:179], v[28:31], v[40:55]
    v_exp_f32 v65, v65
    v_exp_f32 v66, v66
    v_exp_f32 v67, v67
    v_smfmac_f32_32x32x32_bf16 v[88:103], v[244:247], v[56:63], v7
    buffer_load_dwordx4 a[92:95], v254, s[44:47], s69 offen offset:3072
    buffer_load_dwordx4 a[96:99], v254, s[44:47], s70 offen offset:0
    v_exp_f32 v68, v68
    v_exp_f32 v69, v69
    v_exp_f32 v70, v70
    v_smfmac_f32_16x16x64_bf16 v[140:143], v[152:155], v[56:63], v7
    v_exp_f32 v71, v71
    v_exp_f32 v40, v40
    v_exp_f32 v41, v41
    v_smfmac_f32_32x32x32_bf16 v[88:103], v[248:251], v[64:71], v7
    buffer_load_dwordx4 v[240:243], v157, s[44:47], s72 offen offset:1024
    global_load_dword v159, v[4:5], off
    v_exp_f32 v42, v42
    v_exp_f32 v43, v43
    v_exp_f32 v44, v44
    v_smfmac_f32_16x16x64_bf16 v[140:143], v[152:155], v[64:71], v7
    v_exp_f32 v45, v45
    v_mfma_f32_32x32x16_bf16 v[56:71], v[172:175], v[32:35], 0
    v_exp_f32 v46, v46
    v_exp_f32 v47, v47
    v_exp_f32 v48, v48
    v_mfma_f32_32x32x16_bf16 v[56:71], v[176:179], v[36:39], v[56:71]
    v_exp_f32 v49, v49
    v_exp_f32 v50, v50
    v_exp_f32 v51, v51
    v_smfmac_f32_32x32x32_bf16 v[104:119], v[180:183], v[40:47], v7
    buffer_load_dwordx4 a[100:103], v254, s[44:47], s70 offen offset:1024
    v_exp_f32 v52, v52
    v_exp_f32 v53, v53
    v_exp_f32 v54, v54
    v_smfmac_f32_16x16x64_bf16 v[144:147], v[152:155], v[40:47], v7
    v_exp_f32 v55, v55
    v_exp_f32 v56, v56
    v_exp_f32 v57, v57
    v_smfmac_f32_32x32x32_bf16 v[104:119], v[184:187], v[48:55], v7
    buffer_load_dwordx4 v[244:247], v157, s[44:47], s72 offen offset:2048
    v_exp_f32 v58, v58
    v_exp_f32 v59, v59
    v_exp_f32 v60, v60
    v_smfmac_f32_16x16x64_bf16 v[144:147], v[152:155], v[48:55], v7
    v_exp_f32 v61, v61
    v_mfma_f32_32x32x16_bf16 v[40:55], v[172:175], v[8:11], 0
    v_exp_f32 v62, v62
    v_exp_f32 v63, v63
    v_exp_f32 v64, v64
    v_mfma_f32_32x32x16_bf16 v[40:55], v[176:179], v[12:15], v[40:55]
    v_exp_f32 v65, v65
    v_exp_f32 v66, v66
    v_exp_f32 v67, v67
    v_smfmac_f32_32x32x32_bf16 v[120:135], v[180:183], v[56:63], v7
    buffer_load_dwordx4 a[104:107], v254, s[44:47], s70 offen offset:2048
    buffer_load_dwordx4 a[108:111], v254, s[44:47], s70 offen offset:3072
    v_exp_f32 v68, v68
    v_exp_f32 v69, v69
    v_exp_f32 v70, v70
    v_smfmac_f32_16x16x64_bf16 v[148:151], v[152:155], v[56:63], v7
    v_exp_f32 v71, v71
    v_exp_f32 v40, v40
    v_exp_f32 v41, v41
    v_smfmac_f32_32x32x32_bf16 v[120:135], v[184:187], v[64:71], v7
    buffer_load_dwordx4 v[248:251], v157, s[44:47], s72 offen offset:3072
    v_exp_f32 v42, v42
    v_exp_f32 v43, v43
    v_exp_f32 v44, v44
    v_smfmac_f32_16x16x64_bf16 v[148:151], v[152:155], v[64:71], v7
    v_exp_f32 v45, v45
    v_mfma_f32_32x32x16_bf16 v[56:71], v[172:175], v[16:19], 0
    v_exp_f32 v46, v46
    v_exp_f32 v47, v47
    v_exp_f32 v48, v48
    v_mfma_f32_32x32x16_bf16 v[56:71], v[176:179], v[20:23], v[56:71]
    v_exp_f32 v49, v49
    v_exp_f32 v50, v50
    v_exp_f32 v51, v51
    v_smfmac_f32_32x32x32_bf16 v[72:87], v[180:183], v[40:47], v7
    buffer_load_dwordx4 a[112:115], v254, s[44:47], s71 offen offset:0
    v_exp_f32 v52, v52
    v_exp_f32 v53, v53
    v_exp_f32 v54, v54
    v_smfmac_f32_16x16x64_bf16 v[136:139], v[152:155], v[40:47], v7
    v_exp_f32 v55, v55
    s_waitcnt vmcnt(32)
    v_exp_f32 v56, v56
    v_exp_f32 v57, v57
    v_smfmac_f32_32x32x32_bf16 v[72:87], v[184:187], v[48:55], v7
    buffer_load_dwordx4 v[172:175], v157, s[44:47], s73 offen offset:0
    v_exp_f32 v58, v58
    v_exp_f32 v59, v59
    v_exp_f32 v60, v60
    v_smfmac_f32_16x16x64_bf16 v[136:139], v[152:155], v[48:55], v7
    v_exp_f32 v61, v61
    v_mfma_f32_32x32x16_bf16 v[40:55], v[188:191], v[24:27], 0
    v_exp_f32 v62, v62
    v_exp_f32 v63, v63
    v_exp_f32 v64, v64
    v_mfma_f32_32x32x16_bf16 v[40:55], v[192:195], v[28:31], v[40:55]
    v_exp_f32 v65, v65
    v_exp_f32 v66, v66
    v_exp_f32 v67, v67
    v_smfmac_f32_32x32x32_bf16 v[88:103], v[180:183], v[56:63], v7
    buffer_load_dwordx4 a[116:119], v254, s[44:47], s71 offen offset:1024
    v_exp_f32 v68, v68
    v_exp_f32 v69, v69
    v_exp_f32 v70, v70
    v_smfmac_f32_16x16x64_bf16 v[140:143], v[152:155], v[56:63], v7
    v_exp_f32 v71, v71
    v_exp_f32 v40, v40
    v_exp_f32 v41, v41
    v_smfmac_f32_32x32x32_bf16 v[88:103], v[184:187], v[64:71], v7
    buffer_load_dwordx4 v[176:179], v157, s[44:47], s73 offen offset:1024
    v_exp_f32 v42, v42
    v_exp_f32 v43, v43
    v_exp_f32 v44, v44
    v_smfmac_f32_16x16x64_bf16 v[140:143], v[152:155], v[64:71], v7
    v_exp_f32 v45, v45
    v_mfma_f32_32x32x16_bf16 v[56:71], v[188:191], v[32:35], 0
    v_exp_f32 v46, v46
    v_exp_f32 v47, v47
    v_exp_f32 v48, v48
    v_mfma_f32_32x32x16_bf16 v[56:71], v[192:195], v[36:39], v[56:71]
    v_exp_f32 v49, v49
    v_exp_f32 v50, v50
    v_exp_f32 v51, v51
    v_smfmac_f32_32x32x32_bf16 v[104:119], v[196:199], v[40:47], v7
    buffer_load_dwordx4 a[120:123], v254, s[44:47], s71 offen offset:2048
    buffer_load_dwordx4 a[124:127], v254, s[44:47], s71 offen offset:3072
    v_exp_f32 v52, v52
    v_exp_f32 v53, v53
    v_exp_f32 v54, v54
    v_smfmac_f32_16x16x64_bf16 v[144:147], v[152:155], v[40:47], v7
    v_exp_f32 v55, v55
    v_exp_f32 v56, v56
    v_exp_f32 v57, v57
    v_smfmac_f32_32x32x32_bf16 v[104:119], v[200:203], v[48:55], v7
    buffer_load_dwordx4 v[180:183], v157, s[44:47], s73 offen offset:2048
    v_exp_f32 v58, v58
    v_exp_f32 v59, v59
    v_exp_f32 v60, v60
    v_smfmac_f32_16x16x64_bf16 v[144:147], v[152:155], v[48:55], v7
    v_exp_f32 v61, v61
    v_mfma_f32_32x32x16_bf16 v[40:55], v[188:191], v[8:11], 0
    v_exp_f32 v62, v62
    v_exp_f32 v63, v63
    v_exp_f32 v64, v64
    v_mfma_f32_32x32x16_bf16 v[40:55], v[192:195], v[12:15], v[40:55]
    v_exp_f32 v65, v65
    v_exp_f32 v66, v66
    v_exp_f32 v67, v67
    v_smfmac_f32_32x32x32_bf16 v[120:135], v[196:199], v[56:63], v7
    buffer_load_dwordx4 a[128:131], v254, s[44:47], s72 offen offset:0
    v_exp_f32 v68, v68
    v_exp_f32 v69, v69
    v_exp_f32 v70, v70
    v_smfmac_f32_16x16x64_bf16 v[148:151], v[152:155], v[56:63], v7
    v_exp_f32 v71, v71
    v_exp_f32 v40, v40
    v_exp_f32 v41, v41
    v_smfmac_f32_32x32x32_bf16 v[120:135], v[200:203], v[64:71], v7
    buffer_load_dwordx4 v[184:187], v157, s[44:47], s73 offen offset:3072
    v_exp_f32 v42, v42
    v_exp_f32 v43, v43
    v_exp_f32 v44, v44
    v_smfmac_f32_16x16x64_bf16 v[148:151], v[152:155], v[64:71], v7
    v_exp_f32 v45, v45
    v_mfma_f32_32x32x16_bf16 v[56:71], v[188:191], v[16:19], 0
    v_exp_f32 v46, v46
    v_exp_f32 v47, v47
    v_exp_f32 v48, v48
    v_mfma_f32_32x32x16_bf16 v[56:71], v[192:195], v[20:23], v[56:71]
    v_exp_f32 v49, v49
    v_exp_f32 v50, v50
    v_exp_f32 v51, v51
    v_smfmac_f32_32x32x32_bf16 v[72:87], v[196:199], v[40:47], v7
    buffer_load_dwordx4 a[132:135], v254, s[44:47], s72 offen offset:1024
    buffer_load_dwordx4 a[136:139], v254, s[44:47], s72 offen offset:2048
    v_exp_f32 v52, v52
    v_exp_f32 v53, v53
    v_exp_f32 v54, v54
    v_smfmac_f32_16x16x64_bf16 v[136:139], v[152:155], v[40:47], v7
    v_exp_f32 v55, v55
    s_waitcnt vmcnt(32)
    v_exp_f32 v56, v56
    v_exp_f32 v57, v57
    v_smfmac_f32_32x32x32_bf16 v[72:87], v[200:203], v[48:55], v7
    buffer_load_dwordx4 v[188:191], v157, s[44:47], s74 offen offset:0
    v_exp_f32 v58, v58
    v_exp_f32 v59, v59
    v_exp_f32 v60, v60
    v_smfmac_f32_16x16x64_bf16 v[136:139], v[152:155], v[48:55], v7
    v_exp_f32 v61, v61
    v_mfma_f32_32x32x16_bf16 v[40:55], v[204:207], v[24:27], 0
    v_exp_f32 v62, v62
    v_exp_f32 v63, v63
    v_exp_f32 v64, v64
    v_mfma_f32_32x32x16_bf16 v[40:55], v[208:211], v[28:31], v[40:55]
    v_exp_f32 v65, v65
    v_exp_f32 v66, v66
    v_exp_f32 v67, v67
    v_smfmac_f32_32x32x32_bf16 v[88:103], v[196:199], v[56:63], v7
    buffer_load_dwordx4 a[140:143], v254, s[44:47], s72 offen offset:3072
    v_exp_f32 v68, v68
    v_exp_f32 v69, v69
    v_exp_f32 v70, v70
    v_smfmac_f32_16x16x64_bf16 v[140:143], v[152:155], v[56:63], v7
    v_exp_f32 v71, v71
    v_exp_f32 v40, v40
    v_exp_f32 v41, v41
    v_smfmac_f32_32x32x32_bf16 v[88:103], v[200:203], v[64:71], v7
    buffer_load_dwordx4 v[192:195], v157, s[44:47], s74 offen offset:1024
    v_exp_f32 v42, v42
    v_exp_f32 v43, v43
    v_exp_f32 v44, v44
    v_smfmac_f32_16x16x64_bf16 v[140:143], v[152:155], v[64:71], v7
    v_exp_f32 v45, v45
    v_mfma_f32_32x32x16_bf16 v[56:71], v[204:207], v[32:35], 0
    v_exp_f32 v46, v46
    v_exp_f32 v47, v47
    v_exp_f32 v48, v48
    v_mfma_f32_32x32x16_bf16 v[56:71], v[208:211], v[36:39], v[56:71]
    v_exp_f32 v49, v49
    v_exp_f32 v50, v50
    v_exp_f32 v51, v51
    v_smfmac_f32_32x32x32_bf16 v[104:119], v[212:215], v[40:47], v7
    buffer_load_dwordx4 a[144:147], v254, s[44:47], s73 offen offset:0
    v_exp_f32 v52, v52
    v_exp_f32 v53, v53
    v_exp_f32 v54, v54
    v_smfmac_f32_16x16x64_bf16 v[144:147], v[152:155], v[40:47], v7
    v_exp_f32 v55, v55
    v_exp_f32 v56, v56
    v_exp_f32 v57, v57
    v_smfmac_f32_32x32x32_bf16 v[104:119], v[216:219], v[48:55], v7
    buffer_load_dwordx4 v[196:199], v157, s[44:47], s74 offen offset:2048
    v_exp_f32 v58, v58
    v_exp_f32 v59, v59
    v_exp_f32 v60, v60
    v_smfmac_f32_16x16x64_bf16 v[144:147], v[152:155], v[48:55], v7
    v_exp_f32 v61, v61
    v_mfma_f32_32x32x16_bf16 v[40:55], v[204:207], v[8:11], 0
    v_exp_f32 v62, v62
    v_exp_f32 v63, v63
    v_exp_f32 v64, v64
    v_mfma_f32_32x32x16_bf16 v[40:55], v[208:211], v[12:15], v[40:55]
    v_exp_f32 v65, v65
    v_exp_f32 v66, v66
    v_exp_f32 v67, v67
    v_smfmac_f32_32x32x32_bf16 v[120:135], v[212:215], v[56:63], v7
    buffer_load_dwordx4 a[148:151], v254, s[44:47], s73 offen offset:1024
    buffer_load_dwordx4 a[152:155], v254, s[44:47], s73 offen offset:2048
    v_exp_f32 v68, v68
    v_exp_f32 v69, v69
    v_exp_f32 v70, v70
    v_smfmac_f32_16x16x64_bf16 v[148:151], v[152:155], v[56:63], v7
    v_exp_f32 v71, v71
    v_exp_f32 v40, v40
    v_exp_f32 v41, v41
    v_smfmac_f32_32x32x32_bf16 v[120:135], v[216:219], v[64:71], v7
    buffer_load_dwordx4 v[200:203], v157, s[44:47], s74 offen offset:3072
    v_exp_f32 v42, v42
    v_exp_f32 v43, v43
    v_exp_f32 v44, v44
    v_smfmac_f32_16x16x64_bf16 v[148:151], v[152:155], v[64:71], v7
    v_exp_f32 v45, v45
    v_mfma_f32_32x32x16_bf16 v[56:71], v[204:207], v[16:19], 0
    v_exp_f32 v46, v46
    v_exp_f32 v47, v47
    v_exp_f32 v48, v48
    v_mfma_f32_32x32x16_bf16 v[56:71], v[208:211], v[20:23], v[56:71]
    v_exp_f32 v49, v49
    v_exp_f32 v50, v50
    v_exp_f32 v51, v51
    v_smfmac_f32_32x32x32_bf16 v[72:87], v[212:215], v[40:47], v7
    buffer_load_dwordx4 a[156:159], v254, s[44:47], s73 offen offset:3072
    v_exp_f32 v52, v52
    v_exp_f32 v53, v53
    v_exp_f32 v54, v54
    v_smfmac_f32_16x16x64_bf16 v[136:139], v[152:155], v[40:47], v7
    v_exp_f32 v55, v55
    s_waitcnt vmcnt(31)
    v_exp_f32 v56, v56
    v_exp_f32 v57, v57
    v_smfmac_f32_32x32x32_bf16 v[72:87], v[216:219], v[48:55], v7
    buffer_load_dwordx4 v[204:207], v157, s[44:47], s75 offen offset:0
    v_exp_f32 v58, v58
    v_exp_f32 v59, v59
    v_exp_f32 v60, v60
    v_smfmac_f32_16x16x64_bf16 v[136:139], v[152:155], v[48:55], v7
    v_exp_f32 v61, v61
    v_mfma_f32_32x32x16_bf16 v[40:55], v[220:223], v[24:27], 0
    v_exp_f32 v62, v62
    v_exp_f32 v63, v63
    v_exp_f32 v64, v64
    v_mfma_f32_32x32x16_bf16 v[40:55], v[224:227], v[28:31], v[40:55]
    v_exp_f32 v65, v65
    v_exp_f32 v66, v66
    v_exp_f32 v67, v67
    v_smfmac_f32_32x32x32_bf16 v[88:103], v[212:215], v[56:63], v7
    buffer_load_dwordx4 a[160:163], v254, s[44:47], s74 offen offset:0
    buffer_load_dwordx4 a[164:167], v254, s[44:47], s74 offen offset:1024
    v_exp_f32 v68, v68
    v_exp_f32 v69, v69
    v_exp_f32 v70, v70
    v_smfmac_f32_16x16x64_bf16 v[140:143], v[152:155], v[56:63], v7
    v_exp_f32 v71, v71
    v_exp_f32 v40, v40
    v_exp_f32 v41, v41
    v_smfmac_f32_32x32x32_bf16 v[88:103], v[216:219], v[64:71], v7
    buffer_load_dwordx4 v[208:211], v157, s[44:47], s75 offen offset:1024
    v_exp_f32 v42, v42
    v_exp_f32 v43, v43
    v_exp_f32 v44, v44
    v_smfmac_f32_16x16x64_bf16 v[140:143], v[152:155], v[64:71], v7
    v_exp_f32 v45, v45
    v_mfma_f32_32x32x16_bf16 v[56:71], v[220:223], v[32:35], 0
    v_exp_f32 v46, v46
    v_exp_f32 v47, v47
    v_exp_f32 v48, v48
    v_mfma_f32_32x32x16_bf16 v[56:71], v[224:227], v[36:39], v[56:71]
    v_exp_f32 v49, v49
    v_exp_f32 v50, v50
    v_exp_f32 v51, v51
    v_smfmac_f32_32x32x32_bf16 v[104:119], v[228:231], v[40:47], v7
    buffer_load_dwordx4 a[168:171], v254, s[44:47], s74 offen offset:2048
    v_exp_f32 v52, v52
    v_exp_f32 v53, v53
    v_exp_f32 v54, v54
    v_smfmac_f32_16x16x64_bf16 v[144:147], v[152:155], v[40:47], v7
    v_exp_f32 v55, v55
    v_exp_f32 v56, v56
    v_exp_f32 v57, v57
    v_smfmac_f32_32x32x32_bf16 v[104:119], v[232:235], v[48:55], v7
    buffer_load_dwordx4 v[212:215], v157, s[44:47], s75 offen offset:2048
    v_exp_f32 v58, v58
    v_exp_f32 v59, v59
    v_exp_f32 v60, v60
    v_smfmac_f32_16x16x64_bf16 v[144:147], v[152:155], v[48:55], v7
    v_exp_f32 v61, v61
    v_mfma_f32_32x32x16_bf16 v[40:55], v[220:223], v[8:11], 0
    v_exp_f32 v62, v62
    v_exp_f32 v63, v63
    v_exp_f32 v64, v64
    v_mfma_f32_32x32x16_bf16 v[40:55], v[224:227], v[12:15], v[40:55]
    v_exp_f32 v65, v65
    v_exp_f32 v66, v66
    v_exp_f32 v67, v67
    v_smfmac_f32_32x32x32_bf16 v[120:135], v[228:231], v[56:63], v7
    buffer_load_dwordx4 a[172:175], v254, s[44:47], s74 offen offset:3072
    buffer_load_dwordx4 a[176:179], v254, s[44:47], s75 offen offset:0
    v_exp_f32 v68, v68
    v_exp_f32 v69, v69
    v_exp_f32 v70, v70
    v_smfmac_f32_16x16x64_bf16 v[148:151], v[152:155], v[56:63], v7
    v_exp_f32 v71, v71
    v_exp_f32 v40, v40
    v_exp_f32 v41, v41
    v_smfmac_f32_32x32x32_bf16 v[120:135], v[232:235], v[64:71], v7
    buffer_load_dwordx4 v[216:219], v157, s[44:47], s75 offen offset:3072
    v_exp_f32 v42, v42
    v_exp_f32 v43, v43
    v_exp_f32 v44, v44
    v_smfmac_f32_16x16x64_bf16 v[148:151], v[152:155], v[64:71], v7
    v_exp_f32 v45, v45
    v_mfma_f32_32x32x16_bf16 v[56:71], v[220:223], v[16:19], 0
    v_exp_f32 v46, v46
    v_exp_f32 v47, v47
    v_exp_f32 v48, v48
    v_mfma_f32_32x32x16_bf16 v[56:71], v[224:227], v[20:23], v[56:71]
    v_exp_f32 v49, v49
    v_exp_f32 v50, v50
    v_exp_f32 v51, v51
    v_smfmac_f32_32x32x32_bf16 v[72:87], v[228:231], v[40:47], v7
    buffer_load_dwordx4 a[180:183], v254, s[44:47], s75 offen offset:1024
    v_exp_f32 v52, v52
    v_exp_f32 v53, v53
    v_exp_f32 v54, v54
    v_smfmac_f32_16x16x64_bf16 v[136:139], v[152:155], v[40:47], v7
    v_exp_f32 v55, v55
    s_waitcnt vmcnt(30)
    v_exp_f32 v56, v56
    v_exp_f32 v57, v57
    v_smfmac_f32_32x32x32_bf16 v[72:87], v[232:235], v[48:55], v7
    buffer_load_dwordx4 v[220:223], v157, s[44:47], s76 offen offset:0
    v_exp_f32 v58, v58
    v_exp_f32 v59, v59
    v_exp_f32 v60, v60
    v_smfmac_f32_16x16x64_bf16 v[136:139], v[152:155], v[48:55], v7
    v_exp_f32 v61, v61
    v_mfma_f32_32x32x16_bf16 v[40:55], v[236:239], v[24:27], 0
    v_exp_f32 v62, v62
    v_exp_f32 v63, v63
    v_exp_f32 v64, v64
    v_mfma_f32_32x32x16_bf16 v[40:55], v[240:243], v[28:31], v[40:55]
    v_exp_f32 v65, v65
    v_exp_f32 v66, v66
    v_exp_f32 v67, v67
    v_smfmac_f32_32x32x32_bf16 v[88:103], v[228:231], v[56:63], v7
    buffer_load_dwordx4 a[184:187], v254, s[44:47], s75 offen offset:2048
    v_exp_f32 v68, v68
    v_exp_f32 v69, v69
    v_exp_f32 v70, v70
    v_smfmac_f32_16x16x64_bf16 v[140:143], v[152:155], v[56:63], v7
    v_exp_f32 v71, v71
    v_exp_f32 v40, v40
    v_exp_f32 v41, v41
    v_smfmac_f32_32x32x32_bf16 v[88:103], v[232:235], v[64:71], v7
    buffer_load_dwordx4 v[224:227], v157, s[44:47], s76 offen offset:1024
    v_exp_f32 v42, v42
    v_exp_f32 v43, v43
    v_exp_f32 v44, v44
    v_smfmac_f32_16x16x64_bf16 v[140:143], v[152:155], v[64:71], v7
    v_exp_f32 v45, v45
    v_mfma_f32_32x32x16_bf16 v[56:71], v[236:239], v[32:35], 0
    v_exp_f32 v46, v46
    v_exp_f32 v47, v47
    v_exp_f32 v48, v48
    v_mfma_f32_32x32x16_bf16 v[56:71], v[240:243], v[36:39], v[56:71]
    v_exp_f32 v49, v49
    v_exp_f32 v50, v50
    v_exp_f32 v51, v51
    v_smfmac_f32_32x32x32_bf16 v[104:119], v[244:247], v[40:47], v7
    buffer_load_dwordx4 a[188:191], v254, s[44:47], s75 offen offset:3072
    buffer_load_dwordx4 a[192:195], v254, s[44:47], s76 offen offset:0
    v_exp_f32 v52, v52
    v_exp_f32 v53, v53
    v_exp_f32 v54, v54
    v_smfmac_f32_16x16x64_bf16 v[144:147], v[152:155], v[40:47], v7
    v_exp_f32 v55, v55
    v_exp_f32 v56, v56
    v_exp_f32 v57, v57
    v_smfmac_f32_32x32x32_bf16 v[104:119], v[248:251], v[48:55], v7
    buffer_load_dwordx4 v[228:231], v157, s[44:47], s76 offen offset:2048
    v_exp_f32 v58, v58
    v_exp_f32 v59, v59
    v_exp_f32 v60, v60
    v_smfmac_f32_16x16x64_bf16 v[144:147], v[152:155], v[48:55], v7
    v_exp_f32 v61, v61
    v_mfma_f32_32x32x16_bf16 v[40:55], v[236:239], v[8:11], 0
    v_exp_f32 v62, v62
    v_exp_f32 v63, v63
    v_exp_f32 v64, v64
    v_mfma_f32_32x32x16_bf16 v[40:55], v[240:243], v[12:15], v[40:55]
    v_exp_f32 v65, v65
    v_exp_f32 v66, v66
    v_exp_f32 v67, v67
    v_smfmac_f32_32x32x32_bf16 v[120:135], v[244:247], v[56:63], v7
    buffer_load_dwordx4 a[196:199], v254, s[44:47], s76 offen offset:1024
    v_exp_f32 v68, v68
    v_exp_f32 v69, v69
    v_exp_f32 v70, v70
    v_smfmac_f32_16x16x64_bf16 v[148:151], v[152:155], v[56:63], v7
    v_exp_f32 v71, v71
    v_exp_f32 v40, v40
    v_exp_f32 v41, v41
    v_smfmac_f32_32x32x32_bf16 v[120:135], v[248:251], v[64:71], v7
    buffer_load_dwordx4 v[232:235], v157, s[44:47], s76 offen offset:3072
    v_exp_f32 v42, v42
    v_exp_f32 v43, v43
    v_exp_f32 v44, v44
    v_smfmac_f32_16x16x64_bf16 v[148:151], v[152:155], v[64:71], v7
    v_exp_f32 v45, v45
    v_mfma_f32_32x32x16_bf16 v[56:71], v[236:239], v[16:19], 0
    v_exp_f32 v46, v46
    v_exp_f32 v47, v47
    v_exp_f32 v48, v48
    v_mfma_f32_32x32x16_bf16 v[56:71], v[240:243], v[20:23], v[56:71]
    v_exp_f32 v49, v49
    v_exp_f32 v50, v50
    v_exp_f32 v51, v51
    v_smfmac_f32_32x32x32_bf16 v[72:87], v[244:247], v[40:47], v7
    buffer_load_dwordx4 a[200:203], v254, s[44:47], s76 offen offset:2048
    buffer_load_dwordx4 a[204:207], v254, s[44:47], s76 offen offset:3072
    v_exp_f32 v52, v52
    v_exp_f32 v53, v53
    v_exp_f32 v54, v54
    v_smfmac_f32_16x16x64_bf16 v[136:139], v[152:155], v[40:47], v7
    v_exp_f32 v55, v55
    s_waitcnt vmcnt(31)
    v_exp_f32 v56, v56
    v_exp_f32 v57, v57
    v_smfmac_f32_32x32x32_bf16 v[72:87], v[248:251], v[48:55], v7
    buffer_load_dwordx4 v[236:239], v157, s[44:47], s77 offen offset:0
    v_exp_f32 v58, v58
    v_exp_f32 v59, v59
    v_exp_f32 v60, v60
    v_smfmac_f32_16x16x64_bf16 v[136:139], v[152:155], v[48:55], v7
    v_exp_f32 v61, v61
    v_mfma_f32_32x32x16_bf16 v[40:55], v[172:175], v[24:27], 0
    v_exp_f32 v62, v62
    v_exp_f32 v63, v63
    v_exp_f32 v64, v64
    v_mfma_f32_32x32x16_bf16 v[40:55], v[176:179], v[28:31], v[40:55]
    v_exp_f32 v65, v65
    v_exp_f32 v66, v66
    v_exp_f32 v67, v67
    v_smfmac_f32_32x32x32_bf16 v[88:103], v[244:247], v[56:63], v7
    buffer_load_dwordx4 a[208:211], v254, s[44:47], s77 offen offset:0
    v_exp_f32 v68, v68
    v_exp_f32 v69, v69
    v_exp_f32 v70, v70
    v_smfmac_f32_16x16x64_bf16 v[140:143], v[152:155], v[56:63], v7
    v_exp_f32 v71, v71
    v_exp_f32 v40, v40
    v_exp_f32 v41, v41
    v_smfmac_f32_32x32x32_bf16 v[88:103], v[248:251], v[64:71], v7
    buffer_load_dwordx4 v[240:243], v157, s[44:47], s77 offen offset:1024
    v_exp_f32 v42, v42
    v_exp_f32 v43, v43
    v_exp_f32 v44, v44
    v_smfmac_f32_16x16x64_bf16 v[140:143], v[152:155], v[64:71], v7
    v_exp_f32 v45, v45
    v_mfma_f32_32x32x16_bf16 v[56:71], v[172:175], v[32:35], 0
    v_exp_f32 v46, v46
    v_exp_f32 v47, v47
    v_exp_f32 v48, v48
    v_mfma_f32_32x32x16_bf16 v[56:71], v[176:179], v[36:39], v[56:71]
    v_exp_f32 v49, v49
    v_exp_f32 v50, v50
    v_exp_f32 v51, v51
    v_smfmac_f32_32x32x32_bf16 v[104:119], v[180:183], v[40:47], v7
    buffer_load_dwordx4 a[212:215], v254, s[44:47], s77 offen offset:1024
    buffer_load_dwordx4 a[216:219], v254, s[44:47], s77 offen offset:2048
    v_exp_f32 v52, v52
    v_exp_f32 v53, v53
    v_exp_f32 v54, v54
    v_smfmac_f32_16x16x64_bf16 v[144:147], v[152:155], v[40:47], v7
    v_exp_f32 v55, v55
    v_exp_f32 v56, v56
    v_exp_f32 v57, v57
    v_smfmac_f32_32x32x32_bf16 v[104:119], v[184:187], v[48:55], v7
    buffer_load_dwordx4 v[244:247], v157, s[44:47], s77 offen offset:2048
    v_exp_f32 v58, v58
    v_exp_f32 v59, v59
    v_exp_f32 v60, v60
    v_smfmac_f32_16x16x64_bf16 v[144:147], v[152:155], v[48:55], v7
    v_exp_f32 v61, v61
    v_mfma_f32_32x32x16_bf16 v[40:55], v[172:175], v[8:11], 0
    v_exp_f32 v62, v62
    v_exp_f32 v63, v63
    v_exp_f32 v64, v64
    v_mfma_f32_32x32x16_bf16 v[40:55], v[176:179], v[12:15], v[40:55]
    buffer_load_dwordx4 v[248:251], v157, s[44:47], s77 offen offset:3072
    v_exp_f32 v65, v65
    v_exp_f32 v66, v66
    v_exp_f32 v67, v67
    v_smfmac_f32_32x32x32_bf16 v[120:135], v[180:183], v[56:63], v7
    buffer_load_dwordx4 a[220:223], v254, s[44:47], s77 offen offset:3072
    v_exp_f32 v68, v68
    v_exp_f32 v69, v69
    v_exp_f32 v70, v70
    v_smfmac_f32_16x16x64_bf16 v[148:151], v[152:155], v[56:63], v7
    v_exp_f32 v71, v71
    v_exp_f32 v40, v40
    v_exp_f32 v41, v41
    v_smfmac_f32_32x32x32_bf16 v[120:135], v[184:187], v[64:71], v7
    v_exp_f32 v42, v42
    v_exp_f32 v43, v43
    v_exp_f32 v44, v44
    v_smfmac_f32_16x16x64_bf16 v[148:151], v[152:155], v[64:71], v7
    v_exp_f32 v45, v45
    v_mfma_f32_32x32x16_bf16 v[56:71], v[172:175], v[16:19], 0
    v_exp_f32 v46, v46
    v_exp_f32 v47, v47
    v_exp_f32 v48, v48
    v_mfma_f32_32x32x16_bf16 v[56:71], v[176:179], v[20:23], v[56:71]
    buffer_load_dwordx4 v[172:175], v157, s[44:47], s78 offen offset:0
    v_exp_f32 v49, v49
    v_exp_f32 v50, v50
    v_exp_f32 v51, v51
    v_smfmac_f32_32x32x32_bf16 v[72:87], v[180:183], v[40:47], v7
    buffer_load_dwordx4 a[224:227], v254, s[44:47], s78 offen offset:0
    v_exp_f32 v52, v52
    v_exp_f32 v53, v53
    v_exp_f32 v54, v54
    v_smfmac_f32_16x16x64_bf16 v[136:139], v[152:155], v[40:47], v7
    v_exp_f32 v55, v55
    s_waitcnt vmcnt(31)
    v_exp_f32 v56, v56
    v_exp_f32 v57, v57
    v_smfmac_f32_32x32x32_bf16 v[72:87], v[184:187], v[48:55], v7
    buffer_load_dwordx4 v[176:179], v157, s[44:47], s78 offen offset:1024
    v_exp_f32 v58, v58
    v_exp_f32 v59, v59
    v_exp_f32 v60, v60
    v_smfmac_f32_16x16x64_bf16 v[136:139], v[152:155], v[48:55], v7
    v_exp_f32 v61, v61
    v_mfma_f32_32x32x16_bf16 v[40:55], v[188:191], v[24:27], 0
    v_exp_f32 v62, v62
    v_exp_f32 v63, v63
    v_exp_f32 v64, v64
    v_mfma_f32_32x32x16_bf16 v[40:55], v[192:195], v[28:31], v[40:55]
    v_exp_f32 v65, v65
    v_exp_f32 v66, v66
    v_exp_f32 v67, v67
    v_smfmac_f32_32x32x32_bf16 v[88:103], v[180:183], v[56:63], v7
    buffer_load_dwordx4 a[228:231], v254, s[44:47], s78 offen offset:1024
    buffer_load_dwordx4 a[232:235], v254, s[44:47], s78 offen offset:2048
    v_exp_f32 v68, v68
    v_exp_f32 v69, v69
    v_exp_f32 v70, v70
    v_smfmac_f32_16x16x64_bf16 v[140:143], v[152:155], v[56:63], v7
    v_exp_f32 v71, v71
    v_exp_f32 v40, v40
    v_exp_f32 v41, v41
    v_smfmac_f32_32x32x32_bf16 v[88:103], v[184:187], v[64:71], v7
    buffer_load_dwordx4 v[180:183], v157, s[44:47], s78 offen offset:2048
    v_exp_f32 v42, v42
    v_exp_f32 v43, v43
    v_exp_f32 v44, v44
    v_smfmac_f32_16x16x64_bf16 v[140:143], v[152:155], v[64:71], v7
    v_exp_f32 v45, v45
    v_mfma_f32_32x32x16_bf16 v[56:71], v[188:191], v[32:35], 0
    v_exp_f32 v46, v46
    v_exp_f32 v47, v47
    v_exp_f32 v48, v48
    v_mfma_f32_32x32x16_bf16 v[56:71], v[192:195], v[36:39], v[56:71]
    buffer_load_dwordx4 v[184:187], v157, s[44:47], s78 offen offset:3072
    v_exp_f32 v49, v49
    v_exp_f32 v50, v50
    v_exp_f32 v51, v51
    v_smfmac_f32_32x32x32_bf16 v[104:119], v[196:199], v[40:47], v7
    buffer_load_dwordx4 a[236:239], v254, s[44:47], s78 offen offset:3072
    v_exp_f32 v52, v52
    v_exp_f32 v53, v53
    v_exp_f32 v54, v54
    v_smfmac_f32_16x16x64_bf16 v[144:147], v[152:155], v[40:47], v7
    v_exp_f32 v55, v55
    v_exp_f32 v56, v56
    v_exp_f32 v57, v57
    v_smfmac_f32_32x32x32_bf16 v[104:119], v[200:203], v[48:55], v7
    v_exp_f32 v58, v58
    v_exp_f32 v59, v59
    v_exp_f32 v60, v60
    v_smfmac_f32_16x16x64_bf16 v[144:147], v[152:155], v[48:55], v7
    v_exp_f32 v61, v61
    v_mfma_f32_32x32x16_bf16 v[40:55], v[188:191], v[8:11], 0
    v_exp_f32 v62, v62
    v_exp_f32 v63, v63
    v_exp_f32 v64, v64
    v_mfma_f32_32x32x16_bf16 v[40:55], v[192:195], v[12:15], v[40:55]
    v_exp_f32 v65, v65
    v_exp_f32 v66, v66
    v_exp_f32 v67, v67
    v_smfmac_f32_32x32x32_bf16 v[120:135], v[196:199], v[56:63], v7
    buffer_load_dwordx4 a[240:243], v254, s[44:47], s79 offen offset:0
    buffer_load_dwordx4 a[244:247], v254, s[44:47], s79 offen offset:1024
    v_exp_f32 v68, v68
    v_exp_f32 v69, v69
    v_exp_f32 v70, v70
    v_smfmac_f32_16x16x64_bf16 v[148:151], v[152:155], v[56:63], v7
    v_exp_f32 v71, v71
    v_exp_f32 v40, v40
    v_exp_f32 v41, v41
    v_smfmac_f32_32x32x32_bf16 v[120:135], v[200:203], v[64:71], v7
    v_exp_f32 v42, v42
    v_exp_f32 v43, v43
    v_exp_f32 v44, v44
    v_smfmac_f32_16x16x64_bf16 v[148:151], v[152:155], v[64:71], v7
    v_exp_f32 v45, v45
    v_mfma_f32_32x32x16_bf16 v[56:71], v[188:191], v[16:19], 0
    v_exp_f32 v46, v46
    v_exp_f32 v47, v47
    v_exp_f32 v48, v48
    v_mfma_f32_32x32x16_bf16 v[56:71], v[192:195], v[20:23], v[56:71]
    buffer_load_dwordx4 v[188:191], v157, s[44:47], s79 offen offset:0
    v_exp_f32 v49, v49
    v_exp_f32 v50, v50
    v_exp_f32 v51, v51
    v_smfmac_f32_32x32x32_bf16 v[72:87], v[196:199], v[40:47], v7
    buffer_load_dwordx4 a[248:251], v254, s[44:47], s79 offen offset:2048
    v_exp_f32 v52, v52
    v_exp_f32 v53, v53
    v_exp_f32 v54, v54
    v_smfmac_f32_16x16x64_bf16 v[136:139], v[152:155], v[40:47], v7
    v_exp_f32 v55, v55
    s_waitcnt vmcnt(31)
    v_exp_f32 v56, v56
    v_exp_f32 v57, v57
    v_smfmac_f32_32x32x32_bf16 v[72:87], v[200:203], v[48:55], v7
    buffer_load_dwordx4 v[192:195], v157, s[44:47], s79 offen offset:1024
    v_exp_f32 v58, v58
    v_exp_f32 v59, v59
    v_exp_f32 v60, v60
    v_smfmac_f32_16x16x64_bf16 v[136:139], v[152:155], v[48:55], v7
    v_exp_f32 v61, v61
    v_mfma_f32_32x32x16_bf16 v[40:55], v[204:207], v[24:27], 0
    v_exp_f32 v62, v62
    v_exp_f32 v63, v63
    v_exp_f32 v64, v64
    v_mfma_f32_32x32x16_bf16 v[40:55], v[208:211], v[28:31], v[40:55]
    v_exp_f32 v65, v65
    v_exp_f32 v66, v66
    v_exp_f32 v67, v67
    v_smfmac_f32_32x32x32_bf16 v[88:103], v[196:199], v[56:63], v7
    buffer_load_dwordx4 a[252:255], v254, s[44:47], s79 offen offset:3072
    v_exp_f32 v68, v68
    v_exp_f32 v69, v69
    v_exp_f32 v70, v70
    v_smfmac_f32_16x16x64_bf16 v[140:143], v[152:155], v[56:63], v7
    v_exp_f32 v71, v71
    v_exp_f32 v40, v40
    v_exp_f32 v41, v41
    v_smfmac_f32_32x32x32_bf16 v[88:103], v[200:203], v[64:71], v7
    buffer_load_dwordx4 v[196:199], v157, s[44:47], s79 offen offset:2048
    v_exp_f32 v42, v42
    v_exp_f32 v43, v43
    v_exp_f32 v44, v44
    v_smfmac_f32_16x16x64_bf16 v[140:143], v[152:155], v[64:71], v7
    v_exp_f32 v45, v45
    v_mfma_f32_32x32x16_bf16 v[56:71], v[204:207], v[8:11], 0
    v_exp_f32 v46, v46
    v_exp_f32 v47, v47
    v_exp_f32 v48, v48
    v_mfma_f32_32x32x16_bf16 v[56:71], v[208:211], v[12:15], v[56:71]
    buffer_load_dwordx4 v[200:203], v157, s[44:47], s79 offen offset:3072
    v_exp_f32 v49, v49
    v_exp_f32 v50, v50
    v_exp_f32 v51, v51
    v_smfmac_f32_32x32x32_bf16 v[104:119], v[212:215], v[40:47], v7
    v_exp_f32 v52, v52
    v_exp_f32 v53, v53
    v_exp_f32 v54, v54
    v_smfmac_f32_16x16x64_bf16 v[144:147], v[152:155], v[40:47], v7
    v_exp_f32 v55, v55
    s_waitcnt vmcnt(26)
    v_exp_f32 v56, v56
    v_exp_f32 v57, v57
    v_smfmac_f32_32x32x32_bf16 v[104:119], v[216:219], v[48:55], v7
    buffer_load_dword v159, v2, s[44:47], 0 offen sc1
    v_exp_f32 v58, v58
    v_exp_f32 v59, v59
    v_exp_f32 v60, v60
    v_smfmac_f32_16x16x64_bf16 v[144:147], v[152:155], v[48:55], v7
    v_exp_f32 v61, v61
    v_mfma_f32_32x32x16_bf16 v[40:55], v[220:223], v[24:27], 0
    v_exp_f32 v62, v62
    v_exp_f32 v63, v63
    v_exp_f32 v64, v64
    v_mfma_f32_32x32x16_bf16 v[40:55], v[224:227], v[28:31], v[40:55]
    v_exp_f32 v65, v65
    v_exp_f32 v66, v66
    v_exp_f32 v67, v67
    v_smfmac_f32_32x32x32_bf16 v[72:87], v[212:215], v[56:63], v7
    v_exp_f32 v68, v68
    v_exp_f32 v69, v69
    v_exp_f32 v70, v70
    v_smfmac_f32_16x16x64_bf16 v[136:139], v[152:155], v[56:63], v7
    v_exp_f32 v71, v71
    v_exp_f32 v40, v40
    v_exp_f32 v41, v41
    v_smfmac_f32_32x32x32_bf16 v[72:87], v[216:219], v[64:71], v7
    global_load_dword v159, v[4:5], off
    v_exp_f32 v42, v42
    v_exp_f32 v43, v43
    v_exp_f32 v44, v44
    v_smfmac_f32_16x16x64_bf16 v[136:139], v[152:155], v[64:71], v7
    v_exp_f32 v45, v45
    v_mfma_f32_32x32x16_bf16 v[56:71], v[220:223], v[8:11], 0
    v_mov_b32 v169, v3
    v_exp_f32 v46, v46
    v_exp_f32 v47, v47
    v_exp_f32 v48, v48
    v_mfma_f32_32x32x16_bf16 v[56:71], v[224:227], v[12:15], v[56:71]
    buffer_load_dwordx4 v[160:163], v0, s[20:23], s82 offen
    v_exp_f32 v49, v49
    v_exp_f32 v50, v50
    v_exp_f32 v51, v51
    v_smfmac_f32_32x32x32_bf16 v[104:119], v[228:231], v[40:47], v7
    v_exp_f32 v52, v52
    v_exp_f32 v53, v53
    v_exp_f32 v54, v54
    v_smfmac_f32_16x16x64_bf16 v[144:147], v[152:155], v[40:47], v7
    v_exp_f32 v55, v55
    s_waitcnt vmcnt(20)
    v_exp_f32 v56, v56
    v_exp_f32 v57, v57
    v_smfmac_f32_32x32x32_bf16 v[104:119], v[232:235], v[48:55], v7
    v_exp_f32 v58, v58
    v_exp_f32 v59, v59
    v_exp_f32 v60, v60
    v_smfmac_f32_16x16x64_bf16 v[144:147], v[152:155], v[48:55], v7
    v_exp_f32 v61, v61
    v_mfma_f32_32x32x16_bf16 v[40:55], v[236:239], v[24:27], 0
    v_exp_f32 v62, v62
    v_exp_f32 v63, v63
    v_exp_f32 v64, v64
    v_mfma_f32_32x32x16_bf16 v[40:55], v[240:243], v[28:31], v[40:55]
    v_exp_f32 v65, v65
    v_exp_f32 v66, v66
    v_exp_f32 v67, v67
    v_smfmac_f32_32x32x32_bf16 v[72:87], v[228:231], v[56:63], v7
    v_exp_f32 v68, v68
    v_exp_f32 v69, v69
    v_exp_f32 v70, v70
    v_smfmac_f32_16x16x64_bf16 v[136:139], v[152:155], v[56:63], v7
    v_exp_f32 v71, v71
    v_exp_f32 v40, v40
    v_exp_f32 v41, v41
    v_smfmac_f32_32x32x32_bf16 v[72:87], v[232:235], v[64:71], v7
    v_exp_f32 v42, v42
    v_exp_f32 v43, v43
    v_exp_f32 v44, v44
    v_smfmac_f32_16x16x64_bf16 v[136:139], v[152:155], v[64:71], v7
    v_exp_f32 v45, v45
    v_mfma_f32_32x32x16_bf16 v[56:71], v[236:239], v[8:11], 0
    v_exp_f32 v46, v46
    v_exp_f32 v47, v47
    v_exp_f32 v48, v48
    v_mfma_f32_32x32x16_bf16 v[56:71], v[240:243], v[12:15], v[56:71]
    v_exp_f32 v49, v49
    v_exp_f32 v50, v50
    v_exp_f32 v51, v51
    v_smfmac_f32_32x32x32_bf16 v[104:119], v[244:247], v[40:47], v7
    v_exp_f32 v52, v52
    v_exp_f32 v53, v53
    v_exp_f32 v54, v54
    v_smfmac_f32_16x16x64_bf16 v[144:147], v[152:155], v[40:47], v7
    v_exp_f32 v55, v55
    s_waitcnt vmcnt(12)
    v_exp_f32 v56, v56
    v_exp_f32 v57, v57
    v_smfmac_f32_32x32x32_bf16 v[104:119], v[248:251], v[48:55], v7
    v_exp_f32 v58, v58
    v_exp_f32 v59, v59
    v_exp_f32 v60, v60
    v_smfmac_f32_16x16x64_bf16 v[144:147], v[152:155], v[48:55], v7
    v_exp_f32 v61, v61
    v_mfma_f32_32x32x16_bf16 v[40:55], v[172:175], v[24:27], 0
    v_exp_f32 v62, v62
    v_exp_f32 v63, v63
    v_exp_f32 v64, v64
    v_mfma_f32_32x32x16_bf16 v[40:55], v[176:179], v[28:31], v[40:55]
    v_exp_f32 v65, v65
    v_exp_f32 v66, v66
    v_exp_f32 v67, v67
    v_smfmac_f32_32x32x32_bf16 v[72:87], v[244:247], v[56:63], v7
    v_exp_f32 v68, v68
    v_exp_f32 v69, v69
    v_exp_f32 v70, v70
    v_smfmac_f32_16x16x64_bf16 v[136:139], v[152:155], v[56:63], v7
    v_exp_f32 v71, v71
    s_waitcnt vmcnt(3)
    v_exp_f32 v40, v40
    v_exp_f32 v41, v41
    v_smfmac_f32_32x32x32_bf16 v[72:87], v[248:251], v[64:71], v7
    v_exp_f32 v42, v42
    v_exp_f32 v43, v43
    v_exp_f32 v44, v44
    v_smfmac_f32_16x16x64_bf16 v[136:139], v[152:155], v[64:71], v7
    v_exp_f32 v45, v45
    v_mfma_f32_32x32x16_bf16 v[56:71], v[188:191], v[24:27], 0
    v_exp_f32 v46, v46
    v_exp_f32 v47, v47
    v_exp_f32 v48, v48
    v_mfma_f32_32x32x16_bf16 v[56:71], v[192:195], v[28:31], v[56:71]
    v_exp_f32 v49, v49
    v_exp_f32 v50, v50
    v_exp_f32 v51, v51
    v_smfmac_f32_32x32x32_bf16 v[104:119], v[180:183], v[40:47], v7
    v_exp_f32 v52, v52
    v_exp_f32 v53, v53
    v_exp_f32 v54, v54
    v_smfmac_f32_16x16x64_bf16 v[144:147], v[152:155], v[40:47], v7
    v_exp_f32 v55, v55
    v_exp_f32 v56, v56
    v_exp_f32 v57, v57
    v_smfmac_f32_32x32x32_bf16 v[104:119], v[184:187], v[48:55], v7
    v_exp_f32 v58, v58
    v_exp_f32 v59, v59
    v_exp_f32 v60, v60
    v_smfmac_f32_16x16x64_bf16 v[144:147], v[152:155], v[48:55], v7
    v_exp_f32 v61, v61
    v_mfma_f32_32x32x16_bf16 v[40:55], v[172:175], v[8:11], 0
    v_exp_f32 v62, v62
    v_exp_f32 v63, v63
    v_exp_f32 v64, v64
    v_mfma_f32_32x32x16_bf16 v[40:55], v[176:179], v[12:15], v[40:55]
    v_exp_f32 v65, v65
    v_exp_f32 v66, v66
    v_exp_f32 v67, v67
    v_smfmac_f32_32x32x32_bf16 v[104:119], v[196:199], v[56:63], v7
    v_exp_f32 v68, v68
    v_exp_f32 v69, v69
    v_exp_f32 v70, v70
    v_smfmac_f32_16x16x64_bf16 v[144:147], v[152:155], v[56:63], v7
    v_exp_f32 v71, v71
    v_exp_f32 v40, v40
    v_exp_f32 v41, v41
    v_smfmac_f32_32x32x32_bf16 v[104:119], v[200:203], v[64:71], v7
    v_exp_f32 v42, v42
    v_exp_f32 v43, v43
    v_exp_f32 v44, v44
    v_smfmac_f32_16x16x64_bf16 v[144:147], v[152:155], v[64:71], v7
    v_exp_f32 v45, v45
    v_mfma_f32_32x32x16_bf16 v[56:71], v[188:191], v[8:11], 0
    s_nop 0
    ds_write_b128 v252, v[104:107] offset:8192
    v_exp_f32 v46, v46
    v_exp_f32 v47, v47
    v_exp_f32 v48, v48
    v_mfma_f32_32x32x16_bf16 v[56:71], v[192:195], v[12:15], v[56:71]
    ds_write_b128 v252, v[108:111] offset:9216
    v_exp_f32 v49, v49
    v_exp_f32 v50, v50
    v_exp_f32 v51, v51
    v_smfmac_f32_32x32x32_bf16 v[72:87], v[180:183], v[40:47], v7
    ds_write_b128 v252, v[112:115] offset:10240
    v_exp_f32 v52, v52
    v_exp_f32 v53, v53
    v_exp_f32 v54, v54
    v_smfmac_f32_16x16x64_bf16 v[136:139], v[152:155], v[40:47], v7
    v_exp_f32 v55, v55
    v_exp_f32 v56, v56
    v_exp_f32 v57, v57
    v_smfmac_f32_32x32x32_bf16 v[72:87], v[184:187], v[48:55], v7
    ds_write_b128 v252, v[116:119] offset:11264
    v_exp_f32 v58, v58
    v_exp_f32 v59, v59
    v_exp_f32 v60, v60
    v_smfmac_f32_16x16x64_bf16 v[136:139], v[152:155], v[48:55], v7
    v_exp_f32 v61, v61
    v_mfma_f32_32x32x16_bf16 v[40:55], v[204:207], v[32:35], 0
    ds_write_b32 v252, v144 offset:6144
    v_exp_f32 v62, v62
    v_exp_f32 v63, v63
    v_exp_f32 v64, v64
    v_mfma_f32_32x32x16_bf16 v[40:55], v[208:211], v[36:39], v[40:55]
    v_exp_f32 v65, v65
    v_exp_f32 v66, v66
    v_exp_f32 v67, v67
    v_smfmac_f32_32x32x32_bf16 v[72:87], v[196:199], v[56:63], v7
    s_waitcnt lgkmcnt(0)
    s_barrier
    ds_read_b32 v254, v253 offset:6144
    ds_read_b128 v[104:107], v253 offset:8192
    ds_read_b128 v[108:111], v253 offset:9216
    ds_read_b128 v[112:115], v253 offset:10240
    ds_read_b128 v[116:119], v253 offset:11264
    v_exp_f32 v68, v68
    v_exp_f32 v69, v69
    v_exp_f32 v70, v70
    v_smfmac_f32_16x16x64_bf16 v[136:139], v[152:155], v[56:63], v7
    v_exp_f32 v71, v71
    v_exp_f32 v40, v40
    v_exp_f32 v41, v41
    v_smfmac_f32_32x32x32_bf16 v[72:87], v[200:203], v[64:71], v7
    v_exp_f32 v42, v42
    v_exp_f32 v43, v43
    v_exp_f32 v44, v44
    v_smfmac_f32_16x16x64_bf16 v[136:139], v[152:155], v[64:71], v7
    v_exp_f32 v45, v45
    v_mfma_f32_32x32x16_bf16 v[56:71], v[220:223], v[32:35], 0
    v_exp_f32 v46, v46
    v_exp_f32 v47, v47
    v_exp_f32 v48, v48
    v_mfma_f32_32x32x16_bf16 v[56:71], v[224:227], v[36:39], v[56:71]
    s_waitcnt lgkmcnt(0)
    v_add_f32 v2, v136, v254
    v_mov_b32 v3, v2
    v_pk_add_f32 v[72:73], v[72:73], v[104:105]
    v_pk_add_f32 v[74:75], v[74:75], v[106:107]
    v_permlane32_swap_b32 v2, v3
    v_pk_add_f32 v[76:77], v[76:77], v[108:109]
    v_pk_add_f32 v[78:79], v[78:79], v[110:111]
    v_pk_add_f32 v[80:81], v[80:81], v[112:113]
    v_pk_add_f32 v[82:83], v[82:83], v[114:115]
    v_pk_add_f32 v[84:85], v[84:85], v[116:117]
    v_pk_add_f32 v[86:87], v[86:87], v[118:119]
    v_subrev_u32 v3, 0x1f800000, v2
    v_cmp_lt_u32 vcc, 0x50000000, v3
    s_nop 0
    s_cmp_lg_u64 vcc, 0
    s_cselect_b32 s1, 1, 0
    v_rcp_f32 v2, v2
    s_nop 0
    v_pk_mul_f32 v[72:73], v[72:73], v[2:3] op_sel_hi:[1,0]
    v_pk_mul_f32 v[74:75], v[74:75], v[2:3] op_sel_hi:[1,0]
    v_pk_mul_f32 v[76:77], v[76:77], v[2:3] op_sel_hi:[1,0]
    v_pk_mul_f32 v[78:79], v[78:79], v[2:3] op_sel_hi:[1,0]
    v_pk_mul_f32 v[80:81], v[80:81], v[2:3] op_sel_hi:[1,0]
    v_pk_mul_f32 v[82:83], v[82:83], v[2:3] op_sel_hi:[1,0]
    v_pk_mul_f32 v[84:85], v[84:85], v[2:3] op_sel_hi:[1,0]
    v_pk_mul_f32 v[86:87], v[86:87], v[2:3] op_sel_hi:[1,0]
    v_cvt_pk_bf16_f32 v24, v72, v73
    v_cvt_pk_bf16_f32 v25, v74, v75
    v_cvt_pk_bf16_f32 v26, v76, v77
    v_cvt_pk_bf16_f32 v27, v78, v79
    v_cvt_pk_bf16_f32 v28, v80, v81
    v_cvt_pk_bf16_f32 v29, v82, v83
    v_cvt_pk_bf16_f32 v30, v84, v85
    v_cvt_pk_bf16_f32 v31, v86, v87
    buffer_store_dwordx4 v[24:27], v6, s[44:47], s12 offen offset:0 sc1
    buffer_store_dwordx4 v[28:31], v6, s[44:47], s12 offen offset:1024 sc1
    v_exp_f32 v49, v49
    v_exp_f32 v50, v50
    v_exp_f32 v51, v51
    v_smfmac_f32_32x32x32_bf16 v[120:135], v[212:215], v[40:47], v7
    ds_write_b128 v252, v[24:27] offset:0
    v_exp_f32 v52, v52
    v_exp_f32 v53, v53
    v_exp_f32 v54, v54
    v_smfmac_f32_16x16x64_bf16 v[148:151], v[152:155], v[40:47], v7
    v_exp_f32 v55, v55
    v_exp_f32 v56, v56
    v_exp_f32 v57, v57
    v_smfmac_f32_32x32x32_bf16 v[120:135], v[216:219], v[48:55], v7
    ds_write_b128 v252, v[28:31] offset:1024
    v_exp_f32 v58, v58
    v_exp_f32 v59, v59
    v_exp_f32 v60, v60
    v_smfmac_f32_16x16x64_bf16 v[148:151], v[152:155], v[48:55], v7
    v_exp_f32 v61, v61
    v_mfma_f32_32x32x16_bf16 v[40:55], v[236:239], v[32:35], 0
    v_lshl_add_u32 v170, v0, 4, v6
    v_add_u32 v170, 98304, v170
    v_exp_f32 v62, v62
    v_exp_f32 v63, v63
    v_exp_f32 v64, v64
    v_mfma_f32_32x32x16_bf16 v[40:55], v[240:243], v[36:39], v[40:55]
    ds_read_b128 v[72:75], v169 offset:2048
    ds_read_b128 v[76:79], v169 offset:3072
    ds_read_b128 v[80:83], v169 offset:4096
    ds_read_b128 v[84:87], v169 offset:5120
    v_exp_f32 v65, v65
    v_exp_f32 v66, v66
    v_exp_f32 v67, v67
    v_smfmac_f32_32x32x32_bf16 v[120:135], v[228:231], v[56:63], v7
    v_exp_f32 v68, v68
    v_exp_f32 v69, v69
    v_exp_f32 v70, v70
    v_smfmac_f32_16x16x64_bf16 v[148:151], v[152:155], v[56:63], v7
    v_exp_f32 v71, v71
    v_exp_f32 v40, v40
    v_exp_f32 v41, v41
    v_smfmac_f32_32x32x32_bf16 v[120:135], v[232:235], v[64:71], v7
    v_exp_f32 v42, v42
    v_exp_f32 v43, v43
    v_exp_f32 v44, v44
    v_smfmac_f32_16x16x64_bf16 v[148:151], v[152:155], v[64:71], v7
    v_exp_f32 v45, v45
    v_mfma_f32_32x32x16_bf16 v[56:71], v[172:175], v[32:35], 0
    v_exp_f32 v46, v46
    v_exp_f32 v47, v47
    v_exp_f32 v48, v48
    v_mfma_f32_32x32x16_bf16 v[56:71], v[176:179], v[36:39], v[56:71]
    v_exp_f32 v49, v49
    v_exp_f32 v50, v50
    v_exp_f32 v51, v51
    v_smfmac_f32_32x32x32_bf16 v[120:135], v[244:247], v[40:47], v7
    v_exp_f32 v52, v52
    v_exp_f32 v53, v53
    v_exp_f32 v54, v54
    v_smfmac_f32_16x16x64_bf16 v[148:151], v[152:155], v[40:47], v7
    v_exp_f32 v55, v55
    v_exp_f32 v56, v56
    v_exp_f32 v57, v57
    v_smfmac_f32_32x32x32_bf16 v[120:135], v[248:251], v[48:55], v7
    v_exp_f32 v58, v58
    v_exp_f32 v59, v59
    v_exp_f32 v60, v60
    v_smfmac_f32_16x16x64_bf16 v[148:151], v[152:155], v[48:55], v7
    v_exp_f32 v61, v61
    v_mfma_f32_32x32x16_bf16 v[40:55], v[188:191], v[32:35], 0
    v_exp_f32 v62, v62
    v_exp_f32 v63, v63
    v_exp_f32 v64, v64
    v_mfma_f32_32x32x16_bf16 v[40:55], v[192:195], v[36:39], v[40:55]
    v_exp_f32 v65, v65
    v_exp_f32 v66, v66
    v_exp_f32 v67, v67
    v_smfmac_f32_32x32x32_bf16 v[120:135], v[180:183], v[56:63], v7
    v_exp_f32 v68, v68
    v_exp_f32 v69, v69
    v_exp_f32 v70, v70
    v_smfmac_f32_16x16x64_bf16 v[148:151], v[152:155], v[56:63], v7
    v_exp_f32 v71, v71
    v_exp_f32 v40, v40
    v_exp_f32 v41, v41
    v_smfmac_f32_32x32x32_bf16 v[120:135], v[184:187], v[64:71], v7
    s_waitcnt vmcnt(0)
    s_cmp_eq_u32 s1, 1
    s_cbranch_scc1 L_nf0
    s_mov_b64 exec, 1
    s_cmp_eq_u32 s59, 0
    s_cbranch_scc1 L_slow_4
    buffer_store_dword v6, v6, s[44:47], s13 offen offset:0
L_join_5:
    s_mov_b64 exec, -1
L_nf0:
    v_exp_f32 v42, v42
    v_exp_f32 v43, v43
    v_exp_f32 v44, v44
    v_smfmac_f32_16x16x64_bf16 v[148:151], v[152:155], v[64:71], v7
    v_exp_f32 v45, v45
    v_mfma_f32_32x32x16_bf16 v[56:71], v[204:207], v[16:19], 0
    v_exp_f32 v46, v46
    v_exp_f32 v47, v47
    v_exp_f32 v48, v48
    v_mfma_f32_32x32x16_bf16 v[56:71], v[208:211], v[20:23], v[56:71]
    v_exp_f32 v49, v49
    v_exp_f32 v50, v50
    v_exp_f32 v51, v51
    v_smfmac_f32_32x32x32_bf16 v[120:135], v[196:199], v[40:47], v7
    v_exp_f32 v52, v52
    v_exp_f32 v53, v53
    v_exp_f32 v54, v54
    v_smfmac_f32_16x16x64_bf16 v[148:151], v[152:155], v[40:47], v7
    v_exp_f32 v55, v55
    v_exp_f32 v56, v56
    v_exp_f32 v57, v57
    v_smfmac_f32_32x32x32_bf16 v[120:135], v[200:203], v[48:55], v7
    v_exp_f32 v58, v58
    v_exp_f32 v59, v59
    v_exp_f32 v60, v60
    v_smfmac_f32_16x16x64_bf16 v[148:151], v[152:155], v[48:55], v7
    v_exp_f32 v61, v61
    v_mfma_f32_32x32x16_bf16 v[40:55], v[220:223], v[16:19], 0
    s_nop 0
    ds_write_b128 v252, v[120:123] offset:12288
    v_exp_f32 v62, v62
    v_exp_f32 v63, v63
    v_exp_f32 v64, v64
    v_mfma_f32_32x32x16_bf16 v[40:55], v[224:227], v[20:23], v[40:55]
    ds_write_b128 v252, v[124:127] offset:13312
    v_exp_f32 v65, v65
    v_exp_f32 v66, v66
    v_exp_f32 v67, v67
    v_smfmac_f32_32x32x32_bf16 v[88:103], v[212:215], v[56:63], v7
    ds_write_b128 v252, v[128:131] offset:14336
    ds_write_b128 v252, v[132:135] offset:15360
    v_exp_f32 v68, v68
    v_exp_f32 v69, v69
    v_exp_f32 v70, v70
    v_smfmac_f32_16x16x64_bf16 v[140:143], v[152:155], v[56:63], v7
    v_exp_f32 v71, v71
    v_exp_f32 v40, v40
    v_exp_f32 v41, v41
    v_smfmac_f32_32x32x32_bf16 v[88:103], v[216:219], v[64:71], v7
    ds_write_b32 v252, v148 offset:7168
    v_exp_f32 v42, v42
    v_exp_f32 v43, v43
    v_exp_f32 v44, v44
    v_smfmac_f32_16x16x64_bf16 v[140:143], v[152:155], v[64:71], v7
    v_exp_f32 v45, v45
    v_mfma_f32_32x32x16_bf16 v[56:71], v[236:239], v[16:19], 0
    v_exp_f32 v46, v46
    v_exp_f32 v47, v47
    v_exp_f32 v48, v48
    v_mfma_f32_32x32x16_bf16 v[56:71], v[240:243], v[20:23], v[56:71]
    s_waitcnt lgkmcnt(0)
    s_barrier
    ds_read_b32 v254, v253 offset:7168
    ds_read_b128 v[120:123], v253 offset:12288
    ds_read_b128 v[124:127], v253 offset:13312
    ds_read_b128 v[128:131], v253 offset:14336
    ds_read_b128 v[132:135], v253 offset:15360
    v_exp_f32 v49, v49
    v_exp_f32 v50, v50
    v_exp_f32 v51, v51
    v_smfmac_f32_32x32x32_bf16 v[88:103], v[228:231], v[40:47], v7
    buffer_load_dword v171, v6, s[44:47], s14 offen sc1
    v_exp_f32 v52, v52
    v_exp_f32 v53, v53
    v_exp_f32 v54, v54
    v_smfmac_f32_16x16x64_bf16 v[140:143], v[152:155], v[40:47], v7
    v_exp_f32 v55, v55
    v_exp_f32 v56, v56
    v_exp_f32 v57, v57
    v_smfmac_f32_32x32x32_bf16 v[88:103], v[232:235], v[48:55], v7
    v_exp_f32 v58, v58
    v_exp_f32 v59, v59
    v_exp_f32 v60, v60
    v_smfmac_f32_16x16x64_bf16 v[140:143], v[152:155], v[48:55], v7
    v_exp_f32 v61, v61
    v_mfma_f32_32x32x16_bf16 v[40:55], v[172:175], v[16:19], 0
    v_exp_f32 v62, v62
    v_exp_f32 v63, v63
    v_exp_f32 v64, v64
    v_mfma_f32_32x32x16_bf16 v[40:55], v[176:179], v[20:23], v[40:55]
    v_exp_f32 v65, v65
    v_exp_f32 v66, v66
    v_exp_f32 v67, v67
    v_smfmac_f32_32x32x32_bf16 v[88:103], v[244:247], v[56:63], v7
    v_exp_f32 v68, v68
    v_exp_f32 v69, v69
    v_exp_f32 v70, v70
    v_smfmac_f32_16x16x64_bf16 v[140:143], v[152:155], v[56:63], v7
    v_exp_f32 v71, v71
    v_exp_f32 v40, v40
    v_exp_f32 v41, v41
    v_smfmac_f32_32x32x32_bf16 v[88:103], v[248:251], v[64:71], v7
    s_cmp_eq_u32 s1, 1
    s_cbranch_scc1 L_nc0
    s_add_u32 m0, s89, 2048
    s_waitcnt vmcnt(0)
    v_cmp_eq_u32 vcc, -1, v171
    s_nop 0
    s_lshl_b64 vcc, vcc, 32
    s_cbranch_vccnz L_spin_6
L_spin_6_ok:
    buffer_load_dwordx4 v6, s[44:47], s40 offen offset:0 sc1 lds
    buffer_load_dwordx4 v6, s[44:47], s40 offen offset:1024 sc1 lds
    s_add_u32 m0, s89, 4096
    s_nop 0
    buffer_load_dwordx4 v6, s[44:47], s41 offen offset:0 sc1 lds
    buffer_load_dwordx4 v6, s[44:47], s41 offen offset:1024 sc1 lds
L_nc0:
    v_exp_f32 v42, v42
    v_exp_f32 v43, v43
    v_exp_f32 v44, v44
    v_smfmac_f32_16x16x64_bf16 v[140:143], v[152:155], v[64:71], v7
    v_exp_f32 v45, v45
    v_mfma_f32_32x32x16_bf16 v[56:71], v[188:191], v[16:19], 0
    v_exp_f32 v46, v46
    v_exp_f32 v47, v47
    v_exp_f32 v48, v48
    v_mfma_f32_32x32x16_bf16 v[56:71], v[192:195], v[20:23], v[56:71]
    v_exp_f32 v49, v49
    v_exp_f32 v50, v50
    v_exp_f32 v51, v51
    v_smfmac_f32_32x32x32_bf16 v[88:103], v[180:183], v[40:47], v7
    v_exp_f32 v52, v52
    v_exp_f32 v53, v53
    v_exp_f32 v54, v54
    v_smfmac_f32_16x16x64_bf16 v[140:143], v[152:155], v[40:47], v7
    v_exp_f32 v55, v55
    v_exp_f32 v56, v56
    v_exp_f32 v57, v57
    v_smfmac_f32_32x32x32_bf16 v[88:103], v[184:187], v[48:55], v7
    v_exp_f32 v58, v58
    v_exp_f32 v59, v59
    v_exp_f32 v60, v60
    v_smfmac_f32_16x16x64_bf16 v[140:143], v[152:155], v[48:55], v7
    v_exp_f32 v61, v61
    v_exp_f32 v62, v62
    v_exp_f32 v63, v63
    v_exp_f32 v64, v64
    v_exp_f32 v65, v65
    v_exp_f32 v66, v66
    v_exp_f32 v67, v67
    v_smfmac_f32_32x32x32_bf16 v[88:103], v[196:199], v[56:63], v7
    v_exp_f32 v68, v68
    v_exp_f32 v69, v69
    v_exp_f32 v70, v70
    v_smfmac_f32_16x16x64_bf16 v[140:143], v[152:155], v[56:63], v7
    v_exp_f32 v71, v71
    s_cmp_eq_u32 s1, 1
    s_nop 0
    v_smfmac_f32_16x16x64_bf16 v[140:143], v[152:155], v[64:71], v7
    v_smfmac_f32_32x32x32_bf16 v[88:103], v[200:203], v[64:71], v7
    s_cbranch_scc1 L_exact0
L_back0:
    s_waitcnt vmcnt(4) lgkmcnt(0)
    s_barrier
    ds_read_b128 v[220:223], v170 offset:0
    ds_read_b128 v[224:227], v170 offset:256
    ds_read_b128 v[228:231], v170 offset:16384
    ds_read_b128 v[232:235], v170 offset:16640
    ds_read_b128 v[236:239], v170 offset:32768
    ds_read_b128 v[240:243], v170 offset:33024
    ds_read_b128 v[244:247], v170 offset:49152
    ds_read_b128 v[248:251], v170 offset:49408
    s_add_u32 m0, s89, 6144
    v_add_f32 v2, v140, v254
    buffer_load_dwordx4 v6, s[44:47], s42 offen offset:0 sc1 lds
    buffer_load_dwordx4 v6, s[44:47], s42 offen offset:1024 sc1 lds
    s_add_u32 m0, s89, 8192
    v_mov_b32 v3, v2
    buffer_load_dwordx4 v6, s[44:47], s43 offen offset:0 sc1 lds
    buffer_load_dwordx4 v6, s[44:47], s43 offen offset:1024 sc1 lds
    v_pk_add_f32 v[88:89], v[88:89], v[120:121]
    v_pk_add_f32 v[90:91], v[90:91], v[122:123]
    v_permlane32_swap_b32 v2, v3
    v_pk_add_f32 v[92:93], v[92:93], v[124:125]
    v_pk_add_f32 v[94:95], v[94:95], v[126:127]
    v_pk_add_f32 v[96:97], v[96:97], v[128:129]
    v_pk_add_f32 v[98:99], v[98:99], v[130:131]
    v_pk_add_f32 v[100:101], v[100:101], v[132:133]
    v_pk_add_f32 v[102:103], v[102:103], v[134:135]
    v_subrev_u32 v3, 0x1f800000, v2
    v_cmp_lt_u32 vcc, 0x50000000, v3
    s_nop 0
    s_cbranch_vccnz L_exact1
L_back1:
    v_rcp_f32 v2, v2
    s_nop 0
    v_pk_mul_f32 v[88:89], v[88:89], v[2:3] op_sel_hi:[1,0]
    v_pk_mul_f32 v[90:91], v[90:91], v[2:3] op_sel_hi:[1,0]
    v_pk_mul_f32 v[92:93], v[92:93], v[2:3] op_sel_hi:[1,0]
    v_pk_mul_f32 v[94:95], v[94:95], v[2:3] op_sel_hi:[1,0]
    v_pk_mul_f32 v[96:97], v[96:97], v[2:3] op_sel_hi:[1,0]
    v_pk_mul_f32 v[98:99], v[98:99], v[2:3] op_sel_hi:[1,0]
    v_pk_mul_f32 v[100:101], v[100:101], v[2:3] op_sel_hi:[1,0]
    v_pk_mul_f32 v[102:103], v[102:103], v[2:3] op_sel_hi:[1,0]
    v_cvt_pk_bf16_f32 v32, v88, v89
    v_cvt_pk_bf16_f32 v33, v90, v91
    v_cvt_pk_bf16_f32 v34, v92, v93
    v_cvt_pk_bf16_f32 v35, v94, v95
    v_cvt_pk_bf16_f32 v36, v96, v97
    v_cvt_pk_bf16_f32 v37, v98, v99
    v_cvt_pk_bf16_f32 v38, v100, v101
    v_cvt_pk_bf16_f32 v39, v102, v103
    s_waitcnt lgkmcnt(6)
    v_mfma_f32_16x16x32_bf16 v[104:107], a[0:3], v[220:223], 0
    v_mfma_f32_16x16x32_bf16 v[108:111], a[4:7], v[220:223], 0
    buffer_store_dwordx4 v[32:35], v6, s[44:47], s12 offen offset:2048 sc1
    buffer_store_dwordx4 v[36:39], v6, s[44:47], s12 offen offset:3072 sc1
    v_mfma_f32_16x16x32_bf16 v[116:119], a[4:7], v[224:227], 0
    s_add_u32 m0, s89, 10240
    v_mfma_f32_16x16x32_bf16 v[112:115], a[0:3], v[224:227], 0
    v_lshlrev_b32 v120, 16, v80
    s_waitcnt lgkmcnt(4)
    v_mfma_f32_16x16x32_bf16 v[104:107], a[8:11], v[228:231], v[104:107]
    v_and_b32 v121, 0xffff0000, v80
    v_mfma_f32_16x16x32_bf16 v[108:111], a[12:15], v[228:231], v[108:111]
    v_lshlrev_b32 v122, 16, v81
    v_and_b32 v123, 0xffff0000, v81
    v_mfma_f32_16x16x32_bf16 v[116:119], a[12:15], v[232:235], v[116:119]
    buffer_load_dwordx4 v6, s[44:47], s81 offen offset:0 sc1 lds
    v_mfma_f32_16x16x32_bf16 v[112:115], a[8:11], v[232:235], v[112:115]
    s_waitcnt vmcnt(7)
    s_barrier
    s_waitcnt lgkmcnt(2)
    v_mfma_f32_16x16x32_bf16 v[104:107], a[16:19], v[236:239], v[104:107]
    ds_read_b128 v[172:175], v170 offset:2048
    v_mfma_f32_16x16x32_bf16 v[108:111], a[20:23], v[236:239], v[108:111]
    ds_read_b128 v[176:179], v170 offset:2304
    v_lshlrev_b32 v124, 16, v82
    v_mfma_f32_16x16x32_bf16 v[116:119], a[20:23], v[240:243], v[116:119]
    ds_read_b128 v[180:183], v170 offset:18432
    ds_read_b128 v[184:187], v170 offset:18688
    v_mfma_f32_16x16x32_bf16 v[112:115], a[16:19], v[240:243], v[112:115]
    buffer_load_dwordx4 v6, s[44:47], s81 offen offset:1024 sc1 lds
    s_waitcnt lgkmcnt(4)
    v_mfma_f32_16x16x32_bf16 v[104:107], a[24:27], v[244:247], v[104:107]
    ds_read_b128 v[188:191], v170 offset:34816
    v_mfma_f32_16x16x32_bf16 v[108:111], a[28:31], v[244:247], v[108:111]
    ds_read_b128 v[192:195], v170 offset:35072
    s_add_u32 m0, s89, 12288
    v_mfma_f32_16x16x32_bf16 v[116:119], a[28:31], v[248:251], v[116:119]
    ds_read_b128 v[196:199], v170 offset:51200
    ds_read_b128 v[200:203], v170 offset:51456
    v_mfma_f32_16x16x32_bf16 v[112:115], a[24:27], v[248:251], v[112:115]
    buffer_load_dwordx4 v6, s[44:47], s83 offen offset:0 sc1 lds
    s_waitcnt lgkmcnt(6)
    v_mfma_f32_16x16x32_bf16 v[104:107], a[32:35], v[172:175], v[104:107]
    ds_read_b128 v[220:223], v170 offset:4096
    v_mfma_f32_16x16x32_bf16 v[108:111], a[36:39], v[172:175], v[108:111]
    v_and_b32 v125, 0xffff0000, v82
    v_lshlrev_b32 v126, 16, v83
    v_mfma_f32_16x16x32_bf16 v[116:119], a[36:39], v[176:179], v[116:119]
    ds_read_b128 v[224:227], v170 offset:4352
    v_mfma_f32_16x16x32_bf16 v[112:115], a[32:35], v[176:179], v[112:115]
    buffer_load_dwordx4 v6, s[44:47], s83 offen offset:1024 sc1 lds
    s_waitcnt lgkmcnt(6)
    v_mfma_f32_16x16x32_bf16 v[104:107], a[40:43], v[180:183], v[104:107]
    ds_read_b128 v[228:231], v170 offset:20480
    v_mfma_f32_16x16x32_bf16 v[108:111], a[44:47], v[180:183], v[108:111]
    s_add_u32 m0, s89, 14336
    v_and_b32 v127, 0xffff0000, v83
    v_mfma_f32_16x16x32_bf16 v[116:119], a[44:47], v[184:187], v[116:119]
    ds_read_b128 v[232:235], v170 offset:20736
    v_mfma_f32_16x16x32_bf16 v[112:115], a[40:43], v[184:187], v[112:115]
    buffer_load_dwordx4 v6, s[44:47], s11 offen offset:0 sc1 lds
    s_waitcnt lgkmcnt(6)
    v_mfma_f32_16x16x32_bf16 v[104:107], a[48:51], v[188:191], v[104:107]
    ds_read_b128 v[236:239], v170 offset:36864
    v_mfma_f32_16x16x32_bf16 v[108:111], a[52:55], v[188:191], v[108:111]
    v_lshlrev_b32 v128, 16, v84
    v_and_b32 v129, 0xffff0000, v84
    v_mfma_f32_16x16x32_bf16 v[116:119], a[52:55], v[192:195], v[116:119]
    ds_read_b128 v[240:243], v170 offset:37120
    v_mfma_f32_16x16x32_bf16 v[112:115], a[48:51], v[192:195], v[112:115]
    buffer_load_dwordx4 v6, s[44:47], s11 offen offset:1024 sc1 lds
    s_waitcnt lgkmcnt(6)
    v_mfma_f32_16x16x32_bf16 v[104:107], a[56:59], v[196:199], v[104:107]
    ds_read_b128 v[244:247], v170 offset:53248
    v_mfma_f32_16x16x32_bf16 v[108:111], a[60:63], v[196:199], v[108:111]
    v_lshlrev_b32 v130, 16, v85
    v_and_b32 v131, 0xffff0000, v85
    v_mfma_f32_16x16x32_bf16 v[116:119], a[60:63], v[200:203], v[116:119]
    ds_read_b128 v[248:251], v170 offset:53504
    v_mfma_f32_16x16x32_bf16 v[112:115], a[56:59], v[200:203], v[112:115]
    v_lshlrev_b32 v132, 16, v86
    s_waitcnt vmcnt(8)
    s_barrier
    s_waitcnt lgkmcnt(4)
    v_mfma_f32_16x16x32_bf16 v[104:107], a[64:67], v[220:223], v[104:107]
    ds_read_b128 v[172:175], v170 offset:6144
    v_mfma_f32_16x16x32_bf16 v[108:111], a[68:71], v[220:223], v[108:111]
    ds_write_b128 v252, v[32:35] offset:0
    v_mfma_f32_16x16x32_bf16 v[116:119], a[68:71], v[224:227], v[116:119]
    ds_read_b128 v[176:179], v170 offset:6400
    v_mfma_f32_16x16x32_bf16 v[112:115], a[64:67], v[224:227], v[112:115]
    ds_write_b128 v252, v[36:39] offset:1024
    v_mfma_f32_16x16x32_bf16 v[104:107], a[72:75], v[228:231], v[104:107]
    ds_read_b128 v[180:183], v170 offset:22528
    v_mfma_f32_16x16x32_bf16 v[108:111], a[76:79], v[228:231], v[108:111]
    v_and_b32 v133, 0xffff0000, v86
    v_lshlrev_b32 v134, 16, v87
    v_mfma_f32_16x16x32_bf16 v[116:119], a[76:79], v[232:235], v[116:119]
    ds_read_b128 v[184:187], v170 offset:22784
    v_mfma_f32_16x16x32_bf16 v[112:115], a[72:75], v[232:235], v[112:115]
    v_and_b32 v135, 0xffff0000, v87
    s_waitcnt lgkmcnt(6)
    v_mfma_f32_16x16x32_bf16 v[104:107], a[80:83], v[236:239], v[104:107]
    ds_read_b128 v[188:191], v170 offset:38912
    v_mfma_f32_16x16x32_bf16 v[108:111], a[84:87], v[236:239], v[108:111]
    s_waitcnt vmcnt(6)
    s_mov_b64 exec, 1
    s_cmp_eq_u32 s59, 0
    s_cbranch_scc1 L_slow_9
    buffer_store_dword v6, v6, s[44:47], s13 offen offset:512
L_join_10:
    s_mov_b64 exec, -1
    v_mfma_f32_16x16x32_bf16 v[116:119], a[84:87], v[240:243], v[116:119]
    ds_read_b128 v[192:195], v170 offset:39168
    v_mfma_f32_16x16x32_bf16 v[112:115], a[80:83], v[240:243], v[112:115]
    v_lshlrev_b32 v56, 16, v72
    v_and_b32 v57, 0xffff0000, v72
    v_mfma_f32_16x16x32_bf16 v[104:107], a[88:91], v[244:247], v[104:107]
    ds_read_b128 v[196:199], v170 offset:55296
    v_mfma_f32_16x16x32_bf16 v[108:111], a[92:95], v[244:247], v[108:111]
    v_lshlrev_b32 v58, 16, v73
    v_and_b32 v59, 0xffff0000, v73
    v_mfma_f32_16x16x32_bf16 v[116:119], a[92:95], v[248:251], v[116:119]
    ds_read_b128 v[200:203], v170 offset:55552
    v_mfma_f32_16x16x32_bf16 v[112:115], a[88:91], v[248:251], v[112:115]
    v_lshlrev_b32 v60, 16, v74
    s_waitcnt lgkmcnt(4)
    v_mfma_f32_16x16x32_bf16 v[104:107], a[96:99], v[172:175], v[104:107]
    ds_read_b128 v[220:223], v170 offset:8192
    v_mfma_f32_16x16x32_bf16 v[108:111], a[100:103], v[172:175], v[108:111]
    v_and_b32 v61, 0xffff0000, v74
    v_lshlrev_b32 v62, 16, v75
    v_mfma_f32_16x16x32_bf16 v[116:119], a[100:103], v[176:179], v[116:119]
    ds_read_b128 v[224:227], v170 offset:8448
    v_mfma_f32_16x16x32_bf16 v[112:115], a[96:99], v[176:179], v[112:115]
    v_and_b32 v63, 0xffff0000, v75
    v_lshlrev_b32 v64, 16, v76
    v_mfma_f32_16x16x32_bf16 v[104:107], a[104:107], v[180:183], v[104:107]
    ds_read_b128 v[228:231], v170 offset:24576
    v_mfma_f32_16x16x32_bf16 v[108:111], a[108:111], v[180:183], v[108:111]
    v_and_b32 v65, 0xffff0000, v76
    v_lshlrev_b32 v66, 16, v77
    v_mfma_f32_16x16x32_bf16 v[116:119], a[108:111], v[184:187], v[116:119]
    ds_read_b128 v[232:235], v170 offset:24832
    v_mfma_f32_16x16x32_bf16 v[112:115], a[104:107], v[184:187], v[112:115]
    v_and_b32 v67, 0xffff0000, v77
    s_waitcnt lgkmcnt(4)
    v_mfma_f32_16x16x32_bf16 v[104:107], a[112:115], v[188:191], v[104:107]
    ds_read_b128 v[236:239], v170 offset:40960
    v_mfma_f32_16x16x32_bf16 v[108:111], a[116:119], v[188:191], v[108:111]
    v_lshlrev_b32 v68, 16, v78
    v_and_b32 v69, 0xffff0000, v78
    v_mfma_f32_16x16x32_bf16 v[116:119], a[116:119], v[192:195], v[116:119]
    ds_read_b128 v[240:243], v170 offset:41216
    v_mfma_f32_16x16x32_bf16 v[112:115], a[112:115], v[192:195], v[112:115]
    v_lshlrev_b32 v70, 16, v79
    v_and_b32 v71, 0xffff0000, v79
    v_mfma_f32_16x16x32_bf16 v[104:107], a[120:123], v[196:199], v[104:107]
    ds_read_b128 v[244:247], v170 offset:57344
    v_mfma_f32_16x16x32_bf16 v[108:111], a[124:127], v[196:199], v[108:111]
    v_lshrrev_b32 v2, 4, v1
    v_bfe_u32 v3, v1, 2, 2
    v_mfma_f32_16x16x32_bf16 v[116:119], a[124:127], v[200:203], v[116:119]
    ds_read_b128 v[248:251], v170 offset:57600
    v_mfma_f32_16x16x32_bf16 v[112:115], a[120:123], v[200:203], v[112:115]
    v_lshl_add_u32 v4, v2, 3, v3
    s_waitcnt vmcnt(1)
    s_barrier
    s_waitcnt lgkmcnt(4)
    v_mfma_f32_16x16x32_bf16 v[104:107], a[128:131], v[220:223], v[104:107]
    ds_read_b128 v[172:175], v170 offset:10240
    v_mfma_f32_16x16x32_bf16 v[108:111], a[132:135], v[220:223], v[108:111]
    v_and_b32 v2, 1, v2
    v_lshrrev_b32 v5, 1, v3
    v_mfma_f32_16x16x32_bf16 v[116:119], a[132:135], v[224:227], v[116:119]
    ds_read_b128 v[176:179], v170 offset:10496
    v_mfma_f32_16x16x32_bf16 v[112:115], a[128:131], v[224:227], v[112:115]
    buffer_load_dword v171, v6, s[44:47], s14 offen sc1
    v_mfma_f32_16x16x32_bf16 v[104:107], a[136:139], v[228:231], v[104:107]
    ds_read_b128 v[180:183], v170 offset:26624
    v_mfma_f32_16x16x32_bf16 v[108:111], a[140:143], v[228:231], v[108:111]
    v_lshl_or_b32 v5, v2, 1, v5
    v_xor_b32 v5, s3, v5
    v_mfma_f32_16x16x32_bf16 v[116:119], a[140:143], v[232:235], v[116:119]
    ds_read_b128 v[184:187], v170 offset:26880
    v_mfma_f32_16x16x32_bf16 v[112:115], a[136:139], v[232:235], v[112:115]
    v_lshlrev_b32 v5, 5, v5
    s_waitcnt lgkmcnt(4)
    v_mfma_f32_16x16x32_bf16 v[104:107], a[144:147], v[236:239], v[104:107]
    ds_read_b128 v[188:191], v170 offset:43008
    v_mfma_f32_16x16x32_bf16 v[108:111], a[148:151], v[236:239], v[108:111]
    v_lshl_add_u32 v156, v4, 7, v5
    v_and_b32 v5, 3, v1
    v_mfma_f32_16x16x32_bf16 v[116:119], a[148:151], v[240:243], v[116:119]
    ds_read_b128 v[192:195], v170 offset:43264
    v_mfma_f32_16x16x32_bf16 v[112:115], a[144:147], v[240:243], v[112:115]
    v_lshl_add_u32 v156, v5, 3, v156
    v_lshl_or_b32 v2, v2, 2, v3
    v_mfma_f32_16x16x32_bf16 v[104:107], a[152:155], v[244:247], v[104:107]
    ds_read_b128 v[196:199], v170 offset:59392
    v_mfma_f32_16x16x32_bf16 v[108:111], a[156:159], v[244:247], v[108:111]
    s_lshl_b32 s62, s3, 2
    v_xor_b32 v2, s62, v2
    v_mfma_f32_16x16x32_bf16 v[116:119], a[156:159], v[248:251], v[116:119]
    ds_read_b128 v[200:203], v170 offset:59648
    v_mfma_f32_16x16x32_bf16 v[112:115], a[152:155], v[248:251], v[112:115]
    v_lshlrev_b32 v2, 5, v2
    s_waitcnt lgkmcnt(4)
    v_mfma_f32_16x16x32_bf16 v[104:107], a[160:163], v[172:175], v[104:107]
    ds_read_b128 v[220:223], v170 offset:12288
    v_mfma_f32_16x16x32_bf16 v[108:111], a[164:167], v[172:175], v[108:111]
    v_lshl_add_u32 v2, v4, 9, v2
    v_lshl_add_u32 v2, v5, 3, v2
    v_mfma_f32_16x16x32_bf16 v[116:119], a[164:167], v[176:179], v[116:119]
    ds_read_b128 v[224:227], v170 offset:12544
    v_mfma_f32_16x16x32_bf16 v[112:115], a[160:163], v[176:179], v[112:115]
    v_add_u32 v152, 65536, v2
    v_xor_b32 v153, 32, v152
    v_mfma_f32_16x16x32_bf16 v[104:107], a[168:171], v[180:183], v[104:107]
    ds_read_b128 v[228:231], v170 offset:28672
    v_mfma_f32_16x16x32_bf16 v[108:111], a[172:175], v[180:183], v[108:111]
    s_add_u32 m0, s89, 0
    s_waitcnt vmcnt(0)
    v_cmp_eq_u32 vcc, -1, v171
    s_nop 0
    s_lshr_b64 vcc, vcc, 32
    s_cbranch_vccnz L_spin_11
L_spin_11_ok:
    buffer_load_dwordx4 v6, s[44:47], s40 offen offset:2048 sc1 lds
    v_mfma_f32_16x16x32_bf16 v[116:119], a[172:175], v[184:187], v[116:119]
    ds_read_b128 v[232:235], v170 offset:28928
    v_mfma_f32_16x16x32_bf16 v[112:115], a[168:171], v[184:187], v[112:115]
    buffer_load_dwordx4 v6, s[44:47], s40 offen offset:3072 sc1 lds
    s_waitcnt lgkmcnt(4)
    v_mfma_f32_16x16x32_bf16 v[104:107], a[176:179], v[188:191], v[104:107]
    ds_read_b128 v[236:239], v170 offset:45056
    v_mfma_f32_16x16x32_bf16 v[108:111], a[180:183], v[188:191], v[108:111]
    s_add_u32 m0, s89, 2048
    v_xor_b32 v154, 64, v152
    v_mfma_f32_16x16x32_bf16 v[116:119], a[180:183], v[192:195], v[116:119]
    ds_read_b128 v[240:243], v170 offset:45312
    v_mfma_f32_16x16x32_bf16 v[112:115], a[176:179], v[192:195], v[112:115]
    buffer_load_dwordx4 v6, s[44:47], s41 offen offset:2048 sc1 lds
    v_mfma_f32_16x16x32_bf16 v[104:107], a[184:187], v[196:199], v[104:107]
    ds_read_b128 v[244:247], v170 offset:61440
    v_mfma_f32_16x16x32_bf16 v[108:111], a[188:191], v[196:199], v[108:111]
    buffer_load_dwordx4 v6, s[44:47], s41 offen offset:3072 sc1 lds
    v_mfma_f32_16x16x32_bf16 v[116:119], a[188:191], v[200:203], v[116:119]
    ds_read_b128 v[248:251], v170 offset:61696
    v_mfma_f32_16x16x32_bf16 v[112:115], a[184:187], v[200:203], v[112:115]
    s_add_u32 m0, s89, 4096
    s_waitcnt lgkmcnt(4)
    v_mfma_f32_16x16x32_bf16 v[104:107], a[192:195], v[220:223], v[104:107]
    ds_read_b128 v[172:175], v170 offset:14336
    v_mfma_f32_16x16x32_bf16 v[108:111], a[196:199], v[220:223], v[108:111]
    buffer_load_dwordx4 v6, s[44:47], s42 offen offset:2048 sc1 lds
    v_mfma_f32_16x16x32_bf16 v[116:119], a[196:199], v[224:227], v[116:119]
    ds_read_b128 v[176:179], v170 offset:14592
    v_mfma_f32_16x16x32_bf16 v[112:115], a[192:195], v[224:227], v[112:115]
    buffer_load_dwordx4 v6, s[44:47], s42 offen offset:3072 sc1 lds
    v_mfma_f32_16x16x32_bf16 v[104:107], a[200:203], v[228:231], v[104:107]
    ds_read_b128 v[180:183], v170 offset:30720
    v_mfma_f32_16x16x32_bf16 v[108:111], a[204:207], v[228:231], v[108:111]
    v_xor_b32 v155, 96, v152
    v_lshlrev_b32 v40, 16, v160
    v_mfma_f32_16x16x32_bf16 v[116:119], a[204:207], v[232:235], v[116:119]
    ds_read_b128 v[184:187], v170 offset:30976
    v_mfma_f32_16x16x32_bf16 v[112:115], a[200:203], v[232:235], v[112:115]
    v_and_b32 v41, 0xffff0000, v160
    s_waitcnt lgkmcnt(4)
    v_mfma_f32_16x16x32_bf16 v[104:107], a[208:211], v[236:239], v[104:107]
    ds_read_b128 v[188:191], v170 offset:47104
    v_mfma_f32_16x16x32_bf16 v[108:111], a[212:215], v[236:239], v[108:111]
    v_lshlrev_b32 v42, 16, v161
    v_and_b32 v43, 0xffff0000, v161
    v_mfma_f32_16x16x32_bf16 v[116:119], a[212:215], v[240:243], v[116:119]
    ds_read_b128 v[192:195], v170 offset:47360
    v_mfma_f32_16x16x32_bf16 v[112:115], a[208:211], v[240:243], v[112:115]
    v_lshlrev_b32 v44, 16, v162
    v_and_b32 v45, 0xffff0000, v162
    v_mfma_f32_16x16x32_bf16 v[104:107], a[216:219], v[244:247], v[104:107]
    ds_read_b128 v[196:199], v170 offset:63488
    v_mfma_f32_16x16x32_bf16 v[108:111], a[220:223], v[244:247], v[108:111]
    v_lshlrev_b32 v46, 16, v163
    v_and_b32 v47, 0xffff0000, v163
    v_mfma_f32_16x16x32_bf16 v[116:119], a[220:223], v[248:251], v[116:119]
    ds_read_b128 v[200:203], v170 offset:63744
    v_mfma_f32_16x16x32_bf16 v[112:115], a[216:219], v[248:251], v[112:115]
    v_add_f32 v91, v40, v41
    s_waitcnt lgkmcnt(4)
    v_mfma_f32_16x16x32_bf16 v[104:107], a[224:227], v[172:175], v[104:107]
    ds_read_b128 v[220:223], v170 offset:0
    v_mfma_f32_16x16x32_bf16 v[108:111], a[228:231], v[172:175], v[108:111]
    v_add_f32 v91, v91, v42
    v_add_f32 v91, v91, v43
    v_mfma_f32_16x16x32_bf16 v[116:119], a[228:231], v[176:179], v[116:119]
    ds_read_b128 v[224:227], v170 offset:256
    v_mfma_f32_16x16x32_bf16 v[112:115], a[224:227], v[176:179], v[112:115]
    v_add_f32 v91, v91, v44
    v_add_f32 v91, v91, v45
    v_mfma_f32_16x16x32_bf16 v[104:107], a[232:235], v[180:183], v[104:107]
    ds_read_b128 v[228:231], v170 offset:16384
    v_mfma_f32_16x16x32_bf16 v[108:111], a[236:239], v[180:183], v[108:111]
    v_add_f32 v91, v91, v46
    v_add_f32 v91, v91, v47
    v_mfma_f32_16x16x32_bf16 v[116:119], a[236:239], v[184:187], v[116:119]
    ds_read_b128 v[232:235], v170 offset:16640
    v_mfma_f32_16x16x32_bf16 v[112:115], a[232:235], v[184:187], v[112:115]
    v_mov_b32 v95, v91
    s_waitcnt lgkmcnt(4)
    v_mfma_f32_16x16x32_bf16 v[104:107], a[240:243], v[188:191], v[104:107]
    ds_read_b128 v[236:239], v170 offset:32768
    v_mfma_f32_16x16x32_bf16 v[108:111], a[244:247], v[188:191], v[108:111]
    v_permlane16_swap_b32 v91, v95
    v_add_f32 v91, v91, v95
    v_mfma_f32_16x16x32_bf16 v[116:119], a[244:247], v[192:195], v[116:119]
    ds_read_b128 v[240:243], v170 offset:33024
    v_mfma_f32_16x16x32_bf16 v[112:115], a[240:243], v[192:195], v[112:115]
    v_mov_b32 v95, v91
    s_nop 1
    v_permlane32_swap_b32 v91, v95
    v_mfma_f32_16x16x32_bf16 v[104:107], a[248:251], v[196:199], v[104:107]
    ds_read_b128 v[244:247], v170 offset:49152
    v_mfma_f32_16x16x32_bf16 v[108:111], a[252:255], v[196:199], v[108:111]
    v_and_b32 v2, 31, v1
    v_lshlrev_b32 v100, 7, v2
    v_mfma_f32_16x16x32_bf16 v[116:119], a[252:255], v[200:203], v[116:119]
    ds_read_b128 v[248:251], v170 offset:49408
    v_mfma_f32_16x16x32_bf16 v[112:115], a[248:251], v[200:203], v[112:115]
    v_and_b32 v2, 15, v1
    s_waitcnt lgkmcnt(6)
    v_mfma_f32_16x16x32_bf16 v[120:123], a[0:3], v[220:223], v[120:123]
    v_mul_u32_u24 v2, 272, v2
    v_mfma_f32_16x16x32_bf16 v[124:127], a[4:7], v[220:223], v[124:127]
    s_lshl_b32 s62, s3, 6
    v_add3_u32 v96, v2, v0, s62
    v_mfma_f32_16x16x32_bf16 v[132:135], a[4:7], v[224:227], v[132:135]
    s_lshl_b32 s62, s3, 10
    v_mfma_f32_16x16x32_bf16 v[128:131], a[0:3], v[224:227], v[128:131]
    s_add_u32 s62, s62, 17408
    s_waitcnt lgkmcnt(4)
    v_mfma_f32_16x16x32_bf16 v[120:123], a[8:11], v[228:231], v[120:123]
    v_add_f32 v104, v104, v56
    v_mfma_f32_16x16x32_bf16 v[124:127], a[12:15], v[228:231], v[124:127]
    v_add_f32 v105, v105, v57
    v_add_f32 v106, v106, v58
    v_mfma_f32_16x16x32_bf16 v[132:135], a[12:15], v[232:235], v[132:135]
    v_add_f32 v107, v107, v59
    v_mfma_f32_16x16x32_bf16 v[128:131], a[8:11], v[232:235], v[128:131]
    v_add_f32 v108, v108, v60
    s_waitcnt vmcnt(4)
    s_barrier
    s_waitcnt lgkmcnt(2)
    v_mfma_f32_16x16x32_bf16 v[120:123], a[16:19], v[236:239], v[120:123]
    ds_read_b128 v[172:175], v170 offset:2048
    v_mfma_f32_16x16x32_bf16 v[124:127], a[20:23], v[236:239], v[124:127]
    ds_read_b128 v[176:179], v170 offset:2304
    s_add_u32 m0, s89, 6144
    v_mfma_f32_16x16x32_bf16 v[132:135], a[20:23], v[240:243], v[132:135]
    ds_read_b128 v[180:183], v170 offset:18432
    ds_read_b128 v[184:187], v170 offset:18688
    v_mfma_f32_16x16x32_bf16 v[128:131], a[16:19], v[240:243], v[128:131]
    buffer_load_dwordx4 v6, s[44:47], s43 offen offset:2048 sc1 lds
    s_waitcnt lgkmcnt(4)
    v_mfma_f32_16x16x32_bf16 v[120:123], a[24:27], v[244:247], v[120:123]
    ds_read_b128 v[188:191], v170 offset:34816
    v_mfma_f32_16x16x32_bf16 v[124:127], a[28:31], v[244:247], v[124:127]
    ds_read_b128 v[192:195], v170 offset:35072
    buffer_load_dwordx4 v6, s[44:47], s43 offen offset:3072 sc1 lds
    v_mfma_f32_16x16x32_bf16 v[132:135], a[28:31], v[248:251], v[132:135]
    ds_read_b128 v[196:199], v170 offset:51200
    ds_read_b128 v[200:203], v170 offset:51456
    v_mfma_f32_16x16x32_bf16 v[128:131], a[24:27], v[248:251], v[128:131]
    s_add_u32 m0, s89, 8192
    s_waitcnt vmcnt(2)
    s_barrier
    s_waitcnt lgkmcnt(6)
    v_mfma_f32_16x16x32_bf16 v[120:123], a[32:35], v[172:175], v[120:123]
    ds_read_b128 v[220:223], v170 offset:4096
    v_mfma_f32_16x16x32_bf16 v[124:127], a[36:39], v[172:175], v[124:127]
    buffer_load_dwordx4 v6, s[44:47], s81 offen offset:2048 sc1 lds
    ds_read_b64_tr_b16 a[0:1], v156 offset:0
    v_mfma_f32_16x16x32_bf16 v[132:135], a[36:39], v[176:179], v[132:135]
    ds_read_b128 v[224:227], v170 offset:4352
    buffer_load_dwordx4 v6, s[44:47], s81 offen offset:3072 sc1 lds
    v_mfma_f32_16x16x32_bf16 v[128:131], a[32:35], v[176:179], v[128:131]
    ds_read_b64_tr_b16 a[2:3], v156 offset:512
    s_waitcnt lgkmcnt(8)
    v_mfma_f32_16x16x32_bf16 v[120:123], a[40:43], v[180:183], v[120:123]
    ds_read_b128 v[228:231], v170 offset:20480
    s_add_u32 m0, s89, 10240
    v_mfma_f32_16x16x32_bf16 v[124:127], a[44:47], v[180:183], v[124:127]
    ds_read_b64_tr_b16 a[4:5], v156 offset:4096
    v_add_f32 v109, v109, v61
    v_mfma_f32_16x16x32_bf16 v[132:135], a[44:47], v[184:187], v[132:135]
    ds_read_b128 v[232:235], v170 offset:20736
    buffer_load_dwordx4 v6, s[44:47], s83 offen offset:2048 sc1 lds
    v_mfma_f32_16x16x32_bf16 v[128:131], a[40:43], v[184:187], v[128:131]
    ds_read_b64_tr_b16 a[6:7], v156 offset:4608
    s_waitcnt lgkmcnt(10)
    v_mfma_f32_16x16x32_bf16 v[120:123], a[48:51], v[188:191], v[120:123]
    ds_read_b128 v[236:239], v170 offset:36864
    v_mfma_f32_16x16x32_bf16 v[124:127], a[52:55], v[188:191], v[124:127]
    buffer_load_dwordx4 v6, s[44:47], s83 offen offset:3072 sc1 lds
    ds_read_b64_tr_b16 a[8:9], v156 offset:8192
    v_mfma_f32_16x16x32_bf16 v[132:135], a[52:55], v[192:195], v[132:135]
    ds_read_b128 v[240:243], v170 offset:37120
    s_add_u32 m0, s89, 12288
    v_mfma_f32_16x16x32_bf16 v[128:131], a[48:51], v[192:195], v[128:131]
    ds_read_b64_tr_b16 a[10:11], v156 offset:8704
    s_waitcnt lgkmcnt(12)
    v_mfma_f32_16x16x32_bf16 v[120:123], a[56:59], v[196:199], v[120:123]
    ds_read_b128 v[244:247], v170 offset:53248
    v_mfma_f32_16x16x32_bf16 v[124:127], a[60:63], v[196:199], v[124:127]
    buffer_load_dwordx4 v6, s[44:47], s11 offen offset:2048 sc1 lds
    ds_read_b64_tr_b16 a[12:13], v156 offset:12288
    v_mfma_f32_16x16x32_bf16 v[132:135], a[60:63], v[200:203], v[132:135]
    ds_read_b128 v[248:251], v170 offset:53504
    buffer_load_dwordx4 v6, s[44:47], s11 offen offset:3072 sc1 lds
    v_mfma_f32_16x16x32_bf16 v[128:131], a[56:59], v[200:203], v[128:131]
    ds_read_b64_tr_b16 a[14:15], v156 offset:12800
    s_waitcnt lgkmcnt(9)
    v_mfma_f32_16x16x32_bf16 v[120:123], a[64:67], v[220:223], v[120:123]
    ds_read_b128 v[172:175], v170 offset:6144
    ds_read_b64_tr_b16 a[16:17], v156 offset:16384
    v_mfma_f32_16x16x32_bf16 v[124:127], a[68:71], v[220:223], v[124:127]
    v_add_f32 v110, v110, v62
    v_add_f32 v111, v111, v63
    v_mfma_f32_16x16x32_bf16 v[132:135], a[68:71], v[224:227], v[132:135]
    ds_read_b128 v[176:179], v170 offset:6400
    ds_read_b64_tr_b16 a[18:19], v156 offset:16896
    v_mfma_f32_16x16x32_bf16 v[128:131], a[64:67], v[224:227], v[128:131]
    v_add_f32 v112, v112, v64
    v_add_f32 v113, v113, v65
    v_mfma_f32_16x16x32_bf16 v[120:123], a[72:75], v[228:231], v[120:123]
    ds_read_b128 v[180:183], v170 offset:22528
    ds_read_b64_tr_b16 a[20:21], v156 offset:20480
    v_mfma_f32_16x16x32_bf16 v[124:127], a[76:79], v[228:231], v[124:127]
    v_add_f32 v114, v114, v66
    v_add_f32 v115, v115, v67
    v_mfma_f32_16x16x32_bf16 v[132:135], a[76:79], v[232:235], v[132:135]
    ds_read_b128 v[184:187], v170 offset:22784
    ds_read_b64_tr_b16 a[22:23], v156 offset:20992
    v_mfma_f32_16x16x32_bf16 v[128:131], a[72:75], v[232:235], v[128:131]
    v_add_f32 v116, v116, v68
    s_waitcnt lgkmcnt(9)
    v_mfma_f32_16x16x32_bf16 v[120:123], a[80:83], v[236:239], v[120:123]
    ds_read_b128 v[188:191], v170 offset:38912
    ds_read_b64_tr_b16 a[24:25], v156 offset:24576
    v_mfma_f32_16x16x32_bf16 v[124:127], a[84:87], v[236:239], v[124:127]
    v_add_f32 v117, v117, v69
    v_add_f32 v118, v118, v70
    v_mfma_f32_16x16x32_bf16 v[132:135], a[84:87], v[240:243], v[132:135]
    ds_read_b128 v[192:195], v170 offset:39168
    ds_read_b64_tr_b16 a[26:27], v156 offset:25088
    v_mfma_f32_16x16x32_bf16 v[128:131], a[80:83], v[240:243], v[128:131]
    v_add_f32 v119, v119, v71
    v_add_f32 v88, v104, v105
    v_mfma_f32_16x16x32_bf16 v[120:123], a[88:91], v[244:247], v[120:123]
    ds_read_b128 v[196:199], v170 offset:55296
    ds_read_b64_tr_b16 a[28:29], v156 offset:28672
    v_mfma_f32_16x16x32_bf16 v[124:127], a[92:95], v[244:247], v[124:127]
    v_mul_f32 v89, v104, v104
    v_mul_f32 v90, v104, v40
    v_mfma_f32_16x16x32_bf16 v[132:135], a[92:95], v[248:251], v[132:135]
    ds_read_b128 v[200:203], v170 offset:55552
    ds_read_b64_tr_b16 a[30:31], v156 offset:29184
    v_mfma_f32_16x16x32_bf16 v[128:131], a[88:91], v[248:251], v[128:131]
    v_fmac_f32 v89, v105, v105
    s_waitcnt vmcnt(4)
    s_barrier
    s_waitcnt lgkmcnt(9)
    v_mfma_f32_16x16x32_bf16 v[120:123], a[96:99], v[172:175], v[120:123]
    ds_read_b128 v[220:223], v170 offset:8192
    ds_read_b64_tr_b16 a[32:33], v156 offset:32768
    v_mfma_f32_16x16x32_bf16 v[124:127], a[100:103], v[172:175], v[124:127]
    v_fmac_f32 v90, v105, v41
    v_add_f32 v88, v88, v106
    v_mfma_f32_16x16x32_bf16 v[132:135], a[100:103], v[176:179], v[132:135]
    ds_read_b128 v[224:227], v170 offset:8448
    ds_read_b64_tr_b16 a[34:35], v156 offset:33280
    v_mfma_f32_16x16x32_bf16 v[128:131], a[96:99], v[176:179], v[128:131]
    v_fmac_f32 v89, v106, v106
    v_fmac_f32 v90, v106, v42
    v_mfma_f32_16x16x32_bf16 v[120:123], a[104:107], v[180:183], v[120:123]
    ds_read_b128 v[228:231], v170 offset:24576
    ds_read_b64_tr_b16 a[36:37], v156 offset:36864
    v_mfma_f32_16x16x32_bf16 v[124:127], a[108:111], v[180:183], v[124:127]
    v_add_f32 v88, v88, v107
    v_fmac_f32 v89, v107, v107
    v_mfma_f32_16x16x32_bf16 v[132:135], a[108:111], v[184:187], v[132:135]
    ds_read_b128 v[232:235], v170 offset:24832
    ds_read_b64_tr_b16 a[38:39], v156 offset:37376
    v_mfma_f32_16x16x32_bf16 v[128:131], a[104:107], v[184:187], v[128:131]
    v_fmac_f32 v90, v107, v43
    s_waitcnt lgkmcnt(9)
    v_mfma_f32_16x16x32_bf16 v[120:123], a[112:115], v[188:191], v[120:123]
    ds_read_b128 v[236:239], v170 offset:40960
    ds_read_b64_tr_b16 a[40:41], v156 offset:40960
    v_mfma_f32_16x16x32_bf16 v[124:127], a[116:119], v[188:191], v[124:127]
    v_add_f32 v88, v88, v108
    v_fmac_f32 v89, v108, v108
    v_mfma_f32_16x16x32_bf16 v[132:135], a[116:119], v[192:195], v[132:135]
    ds_read_b128 v[240:243], v170 offset:41216
    ds_read_b64_tr_b16 a[42:43], v156 offset:41472
    v_mfma_f32_16x16x32_bf16 v[128:131], a[112:115], v[192:195], v[128:131]
    v_fmac_f32 v90, v108, v44
    v_add_f32 v88, v88, v109
    v_mfma_f32_16x16x32_bf16 v[120:123], a[120:123], v[196:199], v[120:123]
    ds_read_b128 v[244:247], v170 offset:57344
    ds_read_b64_tr_b16 a[44:45], v156 offset:45056
    v_mfma_f32_16x16x32_bf16 v[124:127], a[124:127], v[196:199], v[124:127]
    v_fmac_f32 v89, v109, v109
    v_fmac_f32 v90, v109, v45
    v_mfma_f32_16x16x32_bf16 v[132:135], a[124:127], v[200:203], v[132:135]
    ds_read_b128 v[248:251], v170 offset:57600
    ds_read_b64_tr_b16 a[46:47], v156 offset:45568
    v_mfma_f32_16x16x32_bf16 v[128:131], a[120:123], v[200:203], v[128:131]
    v_add_f32 v88, v88, v110
    s_waitcnt lgkmcnt(9)
    v_mfma_f32_16x16x32_bf16 v[120:123], a[128:131], v[220:223], v[120:123]
    ds_read_b128 v[172:175], v170 offset:10240
    ds_read_b64_tr_b16 a[48:49], v156 offset:49152
    v_mfma_f32_16x16x32_bf16 v[124:127], a[132:135], v[220:223], v[124:127]
    v_fmac_f32 v89, v110, v110
    v_fmac_f32 v90, v110, v46
    v_mfma_f32_16x16x32_bf16 v[132:135], a[132:135], v[224:227], v[132:135]
    ds_read_b128 v[176:179], v170 offset:10496
    ds_read_b64_tr_b16 a[50:51], v156 offset:49664
    v_mfma_f32_16x16x32_bf16 v[128:131], a[128:131], v[224:227], v[128:131]
    v_add_f32 v88, v88, v111
    v_fmac_f32 v89, v111, v111
    v_mfma_f32_16x16x32_bf16 v[120:123], a[136:139], v[228:231], v[120:123]
    ds_read_b128 v[180:183], v170 offset:26624
    ds_read_b64_tr_b16 a[52:53], v156 offset:53248
    v_mfma_f32_16x16x32_bf16 v[124:127], a[140:143], v[228:231], v[124:127]
    v_fmac_f32 v90, v111, v47
    v_add_f32 v48, v112, v113
    v_mfma_f32_16x16x32_bf16 v[132:135], a[140:143], v[232:235], v[132:135]
    ds_read_b128 v[184:187], v170 offset:26880
    ds_read_b64_tr_b16 a[54:55], v156 offset:53760
    v_mfma_f32_16x16x32_bf16 v[128:131], a[136:139], v[232:235], v[128:131]
    v_mul_f32 v49, v112, v112
    s_waitcnt lgkmcnt(9)
    v_mfma_f32_16x16x32_bf16 v[120:123], a[144:147], v[236:239], v[120:123]
    ds_read_b128 v[188:191], v170 offset:43008
    ds_read_b64_tr_b16 a[56:57], v156 offset:57344
    v_mfma_f32_16x16x32_bf16 v[124:127], a[148:151], v[236:239], v[124:127]
    v_mul_f32 v50, v112, v40
    v_fmac_f32 v49, v113, v113
    v_mfma_f32_16x16x32_bf16 v[132:135], a[148:151], v[240:243], v[132:135]
    ds_read_b128 v[192:195], v170 offset:43264
    ds_read_b64_tr_b16 a[58:59], v156 offset:57856
    v_mfma_f32_16x16x32_bf16 v[128:131], a[144:147], v[240:243], v[128:131]
    v_fmac_f32 v50, v113, v41
    v_add_f32 v48, v48, v114
    v_mfma_f32_16x16x32_bf16 v[120:123], a[152:155], v[244:247], v[120:123]
    ds_read_b128 v[196:199], v170 offset:59392
    ds_read_b64_tr_b16 a[60:61], v156 offset:61440
    v_mfma_f32_16x16x32_bf16 v[124:127], a[156:159], v[244:247], v[124:127]
    v_fmac_f32 v49, v114, v114
    v_fmac_f32 v50, v114, v42
    v_mfma_f32_16x16x32_bf16 v[132:135], a[156:159], v[248:251], v[132:135]
    ds_read_b128 v[200:203], v170 offset:59648
    ds_read_b64_tr_b16 a[62:63], v156 offset:61952
    v_mfma_f32_16x16x32_bf16 v[128:131], a[152:155], v[248:251], v[128:131]
    v_add_f32 v48, v48, v115
    s_waitcnt vmcnt(0)
    s_barrier
    s_waitcnt lgkmcnt(9)
    v_mfma_f32_16x16x32_bf16 v[120:123], a[160:163], v[172:175], v[120:123]
    ds_read_b128 v[220:223], v170 offset:12288
    v_fmac_f32 v49, v115, v115
    v_mfma_f32_16x16x32_bf16 v[124:127], a[164:167], v[172:175], v[124:127]
    v_fmac_f32 v50, v115, v43
    v_add_f32 v48, v48, v116
    v_mfma_f32_16x16x32_bf16 v[132:135], a[164:167], v[176:179], v[132:135]
    ds_read_b128 v[224:227], v170 offset:28672
    v_fmac_f32 v49, v116, v116
    v_mfma_f32_16x16x32_bf16 v[128:131], a[160:163], v[176:179], v[128:131]
    v_fmac_f32 v50, v116, v44
    v_add_f32 v48, v48, v117
    v_mfma_f32_16x16x32_bf16 v[120:123], a[168:171], v[180:183], v[120:123]
    ds_read_b128 v[228:231], v170 offset:45056
    v_fmac_f32 v49, v117, v117
    v_mfma_f32_16x16x32_bf16 v[124:127], a[172:175], v[180:183], v[124:127]
    v_fmac_f32 v50, v117, v45
    v_add_f32 v48, v48, v118
    v_mfma_f32_16x16x32_bf16 v[132:135], a[172:175], v[184:187], v[132:135]
    ds_read_b128 v[232:235], v170 offset:61440
    v_fmac_f32 v49, v118, v118
    v_mfma_f32_16x16x32_bf16 v[128:131], a[168:171], v[184:187], v[128:131]
    v_fmac_f32 v50, v118, v46
    s_waitcnt lgkmcnt(5)
    v_mfma_f32_16x16x32_bf16 v[120:123], a[176:179], v[188:191], v[120:123]
    ds_read_b128 v[236:239], v170 offset:14336
    v_add_f32 v48, v48, v119
    v_mfma_f32_16x16x32_bf16 v[124:127], a[180:183], v[188:191], v[124:127]
    v_fmac_f32 v49, v119, v119
    v_fmac_f32 v50, v119, v47
    v_mfma_f32_16x16x32_bf16 v[132:135], a[180:183], v[192:195], v[132:135]
    ds_read_b128 v[240:243], v170 offset:30720
    v_permlane16_swap_b32 v88, v48
    v_mfma_f32_16x16x32_bf16 v[128:131], a[176:179], v[192:195], v[128:131]
    v_permlane16_swap_b32 v89, v49
    v_permlane16_swap_b32 v90, v50
    v_mfma_f32_16x16x32_bf16 v[120:123], a[184:187], v[196:199], v[120:123]
    ds_read_b128 v[244:247], v170 offset:47104
    v_add_f32 v88, v88, v48
    v_mfma_f32_16x16x32_bf16 v[124:127], a[188:191], v[196:199], v[124:127]
    v_add_f32 v89, v89, v49
    v_add_f32 v90, v90, v50
    v_mfma_f32_16x16x32_bf16 v[132:135], a[188:191], v[200:203], v[132:135]
    ds_read_b128 v[248:251], v170 offset:63488
    v_cvt_pk_bf16_f32 v8, v104, v105
    v_mfma_f32_16x16x32_bf16 v[128:131], a[184:187], v[200:203], v[128:131]
    v_cvt_pk_bf16_f32 v9, v106, v107
    s_waitcnt lgkmcnt(4)
    v_mfma_f32_16x16x32_bf16 v[120:123], a[192:195], v[220:223], v[120:123]
    ds_read_b128 v[172:175], v170 offset:12544
    v_cvt_pk_bf16_f32 v10, v108, v109
    v_mfma_f32_16x16x32_bf16 v[124:127], a[196:199], v[220:223], v[124:127]
    v_cvt_pk_bf16_f32 v11, v110, v111
    v_cvt_pk_bf16_f32 v12, v112, v113
    v_mfma_f32_16x16x32_bf16 v[120:123], a[200:203], v[224:227], v[120:123]
    ds_read_b128 v[176:179], v170 offset:28928
    v_cvt_pk_bf16_f32 v13, v114, v115
    v_mfma_f32_16x16x32_bf16 v[124:127], a[204:207], v[224:227], v[124:127]
    v_cvt_pk_bf16_f32 v14, v116, v117
    v_cvt_pk_bf16_f32 v15, v118, v119
    v_mfma_f32_16x16x32_bf16 v[120:123], a[208:211], v[228:231], v[120:123]
    ds_read_b128 v[180:183], v170 offset:45312
    v_add_u32 v97, s62, v6
    v_mfma_f32_16x16x32_bf16 v[124:127], a[212:215], v[228:231], v[124:127]
    s_lshl_b32 s64, s55, 12
    s_add_u32 s64, s64, 1310720
    v_mfma_f32_16x16x32_bf16 v[120:123], a[216:219], v[232:235], v[120:123]
    ds_read_b128 v[184:187], v170 offset:61696
    s_lshl_b32 s82, s53, 5
    v_mfma_f32_16x16x32_bf16 v[124:127], a[220:223], v[232:235], v[124:127]
    s_add_u32 s82, s82, s52
    s_waitcnt lgkmcnt(4)
    v_mfma_f32_16x16x32_bf16 v[120:123], a[224:227], v[236:239], v[120:123]
    ds_read_b128 v[188:191], v170 offset:14592
    s_lshl_b32 s82, s82, 7
    v_mfma_f32_16x16x32_bf16 v[124:127], a[228:231], v[236:239], v[124:127]
    s_add_u32 s82, s82, 1310720
    s_lshl_b32 s87, s52, 7
    v_mfma_f32_16x16x32_bf16 v[120:123], a[232:235], v[240:243], v[120:123]
    ds_read_b128 v[192:195], v170 offset:30976
    s_add_u32 s87, s87, 1343488
    v_mfma_f32_16x16x32_bf16 v[124:127], a[236:239], v[240:243], v[124:127]
    s_sub_u32 s62, 1343488, s64
    s_mul_i32 s62, s62, s59
    v_mfma_f32_16x16x32_bf16 v[120:123], a[240:243], v[244:247], v[120:123]
    ds_read_b128 v[196:199], v170 offset:47360
    v_bfe_u32 v2, v1, 2, 3
    v_mfma_f32_16x16x32_bf16 v[124:127], a[244:247], v[244:247], v[124:127]
    v_cmp_eq_u32 s[84:85], s55, v2
    v_add_u32 v2, s62, v100
    v_mfma_f32_16x16x32_bf16 v[120:123], a[248:251], v[248:251], v[120:123]
    ds_read_b128 v[200:203], v170 offset:63744
    v_cndmask_b32 v100, v100, v2, s[84:85]
    v_mfma_f32_16x16x32_bf16 v[124:127], a[252:255], v[248:251], v[124:127]
    s_lshl_b32 s65, s52, 13
    s_waitcnt lgkmcnt(4)
    v_mfma_f32_16x16x32_bf16 v[132:135], a[196:199], v[172:175], v[132:135]
    s_add_u32 s65, s65, 524288
    s_add_u32 s66, s65, 4096
    v_mfma_f32_16x16x32_bf16 v[128:131], a[192:195], v[172:175], v[128:131]
    s_lshl_b32 s67, s54, 10
    s_add_u32 s67, s67, 524288
    v_mfma_f32_16x16x32_bf16 v[132:135], a[204:207], v[176:179], v[132:135]
    v_mfma_f32_16x16x32_bf16 v[128:131], a[200:203], v[176:179], v[128:131]
    ds_write_b128 v96, v[8:11] offset:0
    v_mfma_f32_16x16x32_bf16 v[132:135], a[212:215], v[180:183], v[132:135]
    v_mfma_f32_16x16x32_bf16 v[128:131], a[208:211], v[180:183], v[128:131]
    ds_write_b128 v96, v[12:15] offset:4352
    v_mfma_f32_16x16x32_bf16 v[132:135], a[220:223], v[184:187], v[132:135]
    v_add_f32 v92, v120, v121
    v_mul_f32 v93, v120, v120
    v_mfma_f32_16x16x32_bf16 v[128:131], a[216:219], v[184:187], v[128:131]
    v_mul_f32 v94, v120, v40
    s_waitcnt lgkmcnt(2)
    v_mfma_f32_16x16x32_bf16 v[132:135], a[228:231], v[188:191], v[132:135]
    v_fmac_f32 v93, v121, v121
    v_fmac_f32 v94, v121, v41
    v_mfma_f32_16x16x32_bf16 v[128:131], a[224:227], v[188:191], v[128:131]
    v_add_f32 v92, v92, v122
    v_fmac_f32 v93, v122, v122
    v_mfma_f32_16x16x32_bf16 v[132:135], a[236:239], v[192:195], v[132:135]
    v_fmac_f32 v94, v122, v42
    v_add_f32 v92, v92, v123
    v_mfma_f32_16x16x32_bf16 v[128:131], a[232:235], v[192:195], v[128:131]
    v_fmac_f32 v93, v123, v123
    v_fmac_f32 v94, v123, v43
    v_mfma_f32_16x16x32_bf16 v[132:135], a[244:247], v[196:199], v[132:135]
    v_add_f32 v92, v92, v124
    v_fmac_f32 v93, v124, v124
    v_mfma_f32_16x16x32_bf16 v[128:131], a[240:243], v[196:199], v[128:131]
    v_fmac_f32 v94, v124, v44
    v_add_f32 v92, v92, v125
    v_mfma_f32_16x16x32_bf16 v[132:135], a[252:255], v[200:203], v[132:135]
    v_fmac_f32 v93, v125, v125
    v_fmac_f32 v94, v125, v45
    v_mfma_f32_16x16x32_bf16 v[128:131], a[248:251], v[200:203], v[128:131]
    v_add_f32 v92, v92, v126
    v_fmac_f32 v93, v126, v126
    v_fmac_f32 v94, v126, v46
    v_add_f32 v92, v92, v127
    v_fmac_f32 v93, v127, v127
    v_fmac_f32 v94, v127, v47
    s_nop 1
    v_pk_add_f32 v[56:57], v[128:129], v[130:131]
    v_pk_mul_f32 v[58:59], v[128:129], v[128:129]
    v_pk_mul_f32 v[60:61], v[128:129], v[40:41]
    v_pk_fma_f32 v[58:59], v[130:131], v[130:131], v[58:59]
    v_pk_fma_f32 v[60:61], v[130:131], v[42:43], v[60:61]
    v_pk_add_f32 v[56:57], v[56:57], v[132:133]
    v_pk_fma_f32 v[58:59], v[132:133], v[132:133], v[58:59]
    v_pk_fma_f32 v[60:61], v[132:133], v[44:45], v[60:61]
    v_pk_add_f32 v[56:57], v[56:57], v[134:135]
    v_pk_fma_f32 v[58:59], v[134:135], v[134:135], v[58:59]
    v_pk_fma_f32 v[60:61], v[134:135], v[46:47], v[60:61]
    v_add_f32 v48, v56, v57
    v_add_f32 v49, v58, v59
    v_add_f32 v50, v60, v61
    v_permlane16_swap_b32 v92, v48
    v_permlane16_swap_b32 v93, v49
    v_permlane16_swap_b32 v94, v50
    v_add_f32 v92, v92, v48
    v_add_f32 v93, v93, v49
    v_add_f32 v94, v94, v50
    v_permlane32_swap_b32 v88, v92
    v_permlane32_swap_b32 v89, v93
    v_permlane32_swap_b32 v90, v94
    v_pk_add_f32 v[88:89], v[88:89], v[92:93]
    v_pk_add_f32 v[90:91], v[90:91], v[94:95]
    ds_write_b128 v97, v[88:91]
    s_cmp_eq_u32 s3, 0
    s_waitcnt lgkmcnt(0)
    s_barrier
    s_cbranch_scc0 L_bulk
    ds_read_b128 v[40:43], v6 offset:17408
    ds_read_b128 v[44:47], v6 offset:18432
    ds_read_b128 v[48:51], v6 offset:19456
    ds_read_b128 v[52:55], v6 offset:20480
    s_waitcnt lgkmcnt(0)
    v_pk_add_f32 v[40:41], v[40:41], v[44:45]
    v_pk_add_f32 v[42:43], v[42:43], v[46:47]
    v_pk_add_f32 v[48:49], v[48:49], v[52:53]
    v_pk_add_f32 v[50:51], v[50:51], v[54:55]
    v_pk_add_f32 v[40:41], v[40:41], v[48:49]
    v_pk_add_f32 v[42:43], v[42:43], v[50:51]
    s_cmp_eq_u32 s59, 0
    s_cbranch_scc1 L_slow_12
    buffer_store_dwordx4 v[40:43], v6, s[44:47], s67 offen
L_join_13:
    v_cvt_pk_bf16_f32 v16, v120, v121
    v_cvt_pk_bf16_f32 v17, v122, v123
    v_cvt_pk_bf16_f32 v18, v124, v125
    v_cvt_pk_bf16_f32 v19, v126, v127
    v_cvt_pk_bf16_f32 v20, v128, v129
    v_cvt_pk_bf16_f32 v21, v130, v131
    v_cvt_pk_bf16_f32 v22, v132, v133
    v_cvt_pk_bf16_f32 v23, v134, v135
    ds_write_b128 v96, v[16:19] offset:8704
    ds_write_b128 v96, v[20:23] offset:13056
    v_bfe_u32 v3, v1, 4, 1
    v_and_b32 v4, 0xf0, v6
    v_lshl_add_u32 v101, v3, 9, v4
    v_lshlrev_b32 v144, 2, v1
    v_lshlrev_b32 v142, 3, v1
    v_and_b32 v3, 56, v142
    v_and_b32 v4, 0x180, v6
    v_add_u32 v3, 22528, v3
    v_add_u32 v145, v3, v4
    v_and_b32 v3, 1, v1
    v_and_b32 v4, 48, v1
    v_lshl_add_u32 v140, v3, 6, v4
    v_mul_u32_u24 v141, 0xaaaa, v3
    v_add_u32 v141, 0x4444, v141
    v_and_b32 v4, 60, v1
    v_lshl_add_u32 v4, v3, 1, v4
    v_and_b32 v3, 2, v1
    v_lshl_add_u32 v146, v3, 5, v4
    s_lshl_b32 s71, s58, 10
    s_add_u32 s71, s71, 1179648
    v_and_b32 v3, 14, v1
    v_mov_b32 v5, 128
    v_cmp_eq_u32 vcc, 0, v3
    v_cmp_eq_u32 s[84:85], 4, v3
    v_and_b32 v4, 124, v144
    v_cndmask_b32 v136, v5, v140, vcc
    v_cmp_eq_u32 vcc, 8, v3
    v_cndmask_b32 v137, v5, v140, s[84:85]
    v_cmp_eq_u32 s[84:85], 12, v3
    v_lshrrev_b32 v3, 5, v1
    buffer_load_dwordx4 v[172:175], v6, s[44:47], s65 offen offset:0 sc1
    buffer_load_dwordx4 v[176:179], v6, s[44:47], s65 offen offset:1024 sc1
    buffer_load_dwordx4 v[180:183], v6, s[44:47], s65 offen offset:2048 sc1
    buffer_load_dwordx4 v[184:187], v6, s[44:47], s65 offen offset:3072 sc1
    buffer_load_dwordx4 v[188:191], v6, s[44:47], s66 offen offset:0 sc1
    buffer_load_dwordx4 v[192:195], v6, s[44:47], s66 offen offset:1024 sc1
    buffer_load_dwordx4 v[196:199], v6, s[44:47], s66 offen offset:2048 sc1
    buffer_load_dwordx4 v[200:203], v6, s[44:47], s66 offen offset:3072 sc1
    v_cndmask_b32 v138, v5, v140, vcc
    v_lshl_add_u32 v143, v3, 13, v4
    v_cndmask_b32 v139, v5, v140, s[84:85]
    v_mov_b64 v[24:25], 0
    v_mov_b64 v[28:29], 0
    v_mov_b64 v[32:33], 0
    s_lshl2_add_u32 s72, s54, s3
    s_lshl_b32 s72, s72, 7
    s_add_u32 s72, s72, 1048576
    s_andn2_b32 s73, s72, 0x7ff
    s_lshl2_add_u32 s74, s58, s3
    s_lshl_b32 s74, s74, 7
    s_add_u32 s74, s74, s56
    s_lshl_b32 s74, s74, 7
    s_add_u32 s74, s74, 786432
    s_lshl_b32 s75, s53, 8
    s_add_u32 s75, s75, s88
    v_mov_b32 v3, 0
    ds_write_b16 v146, v3 offset:23168
    s_waitcnt lgkmcnt(0)
    s_barrier
    buffer_load_dwordx4 v[204:207], v6, s[44:47], s65 offen offset:0 sc1
    buffer_load_dwordx4 v[208:211], v6, s[44:47], s65 offen offset:1024 sc1
    buffer_load_dwordx4 v[212:215], v6, s[44:47], s65 offen offset:2048 sc1
    buffer_load_dwordx4 v[216:219], v6, s[44:47], s65 offen offset:3072 sc1
    buffer_load_dwordx4 v[220:223], v6, s[44:47], s66 offen offset:0 sc1
    buffer_load_dwordx4 v[224:227], v6, s[44:47], s66 offen offset:1024 sc1
    buffer_load_dwordx4 v[228:231], v6, s[44:47], s66 offen offset:2048 sc1
    buffer_load_dwordx4 v[232:235], v6, s[44:47], s66 offen offset:3072 sc1
    buffer_load_dwordx2 v[98:99], v100, s[44:47], s64 offen sc1
    s_mov_b32 s61, 400000
L_sa:
    s_waitcnt vmcnt(13)
    v_pk_add_f32 v[40:41], v[172:173], v[176:177]
    v_pk_add_f32 v[44:45], v[180:181], v[184:185]
    v_pk_add_f32 v[42:43], v[174:175], v[178:179]
    v_pk_add_f32 v[46:47], v[182:183], v[186:187]
    v_pk_add_f32 v[40:41], v[40:41], v[44:45]
    v_pk_add_f32 v[42:43], v[42:43], v[46:47]
    s_waitcnt vmcnt(12)
    v_pk_add_f32 v[40:41], v[40:41], v[188:189]
    v_pk_add_f32 v[42:43], v[42:43], v[190:191]
    s_waitcnt vmcnt(11)
    v_pk_add_f32 v[40:41], v[40:41], v[192:193]
    v_pk_add_f32 v[42:43], v[42:43], v[194:195]
    s_waitcnt vmcnt(10)
    v_pk_add_f32 v[40:41], v[40:41], v[196:197]
    v_pk_add_f32 v[42:43], v[42:43], v[198:199]
    s_waitcnt vmcnt(9)
    v_pk_add_f32 v[40:41], v[40:41], v[200:201]
    v_pk_add_f32 v[42:43], v[42:43], v[202:203]
    v_pk_add_f32 v[44:45], v[40:41], v[42:43]
    v_cmp_u_f32 vcc, v44, v45
    s_nop 0
    s_cbranch_vccnz L_sb
L_sd:
    v_mul_f32 v72, 0x3a800000, v40
    v_mul_f32 v2, 0x3a800000, v41
    v_fma_f32 v2, -v72, v72, v2
    v_max_f32 v2, 0, v2
    v_cvt_pk_bf16_f32 v2, v2, v2
    v_and_b32 v2, 0xffff0000, v2
    v_add_f32 v2, 0x3727c5ac, v2
    v_cvt_pk_bf16_f32 v2, v2, v2
    v_and_b32 v2, 0xffff0000, v2
    v_sqrt_f32 v2, v2
    v_cvt_pk_bf16_f32 v72, v72, v72
    v_and_b32 v72, 0xffff0000, v72
    v_cvt_pk_bf16_f32 v2, v2, v2
    v_and_b32 v2, 0xffff0000, v2
    v_rcp_f32 v73, v2
    v_fma_f32 v74, -v72, v43, v42
    v_mul_f32 v74, v73, v74
    v_max_f32 v74, 0xff800000, v74
    s_lshl_b32 s66, s52, 6
    s_mov_b32 m0, s52
    v_max_f32_dpp v40, v74, v74 quad_perm:[1,0,3,2] row_mask:0xf bank_mask:0xf
    v_add_f32 v78, 1.0, v73
    v_mul_f32 v79, -v72, v73
    v_max_f32_dpp v40, v40, v40 quad_perm:[2,3,0,1] row_mask:0xf bank_mask:0xf
    v_lshlrev_b32 v4, 3, v1
    ds_write_b64 v4, v[78:79] offset:21504
    v_max_f32_dpp v40, v40, v40 row_half_mirror row_mask:0xf bank_mask:0xf
    s_lshl_b32 s67, s54, 9
    s_add_u32 s67, s67, 1179648
    v_max_f32_dpp v40, v40, v40 row_mirror row_mask:0xf bank_mask:0xf
    v_mov_b32 v5, v40
    s_nop 1
    v_permlane16_swap_b32 v40, v5
    v_max_f32 v40, v40, v5
    v_mov_b32 v5, v40
    s_nop 1
    v_permlane32_swap_b32 v40, v5
    v_max_f32 v40, v40, v5
    v_cmp_eq_f32 vcc, v40, v74
    s_nop 0
    s_ff1_i32_b64 s76, vcc
    s_add_u32 s66, s66, s76
    v_mov_b32 v41, s66
    s_mov_b64 exec, 1
    buffer_store_dwordx2 v[40:41], v3, s[44:47], s82 offen sc1
    buffer_store_dwordx2 v[40:41], v3, s[44:47], s87 offen
    ds_write_b32 v3, v41 offset:22016
    s_mov_b64 exec, -1
    s_mul_i32 s62, s76, 272
    v_add_u32 v4, s62, v144
    ds_read_b32 v75, v4 offset:0
    v_readlane_b32 s77, v72, s76
    v_readlane_b32 s78, v73, s76
    v_readfirstlane_b32 s79, v40
    s_waitcnt lgkmcnt(0)
    s_barrier
    v_lshlrev_b32 v2, 16, v75
    v_and_b32 v3, 0xffff0000, v75
    v_subrev_f32 v4, s77, v2
    v_subrev_f32 v5, s77, v3
    v_mul_f32 v4, s78, v4
    v_mul_f32 v5, s78, v5
    v_cvt_pk_bf16_f32 v76, v4, v5
    v_min_u32 v76, -2, v76
    buffer_store_dword v76, v144, s[44:47], s67 offen sc1
    s_waitcnt vmcnt(3)
    v_writelane_b32 v98, s79, m0
    s_mov_b32 s61, 400000
L_g0:
    s_nop 0
    v_max_f32_dpp v2, v98, v98 quad_perm:[1,0,3,2] row_mask:0xf bank_mask:0xf
    s_nop 1
    v_max_f32_dpp v2, v2, v2 quad_perm:[2,3,0,1] row_mask:0xf bank_mask:0xf
    s_nop 1
    v_max_f32_dpp v2, v2, v2 row_half_mirror row_mask:0xf bank_mask:0xf
    s_nop 1
    v_max_f32_dpp v2, v2, v2 row_mirror row_mask:0xf bank_mask:0xf
    v_mov_b32 v5, v2
    s_nop 1
    v_permlane16_swap_b32 v2, v5
    v_max_f32 v2, v2, v5
    v_cmp_eq_f32 vcc, v2, v98
    s_nop 0
    s_ff1_i32_b32 s68, vcc_lo
    s_max_i32 s68, s68, 0
    s_lshl_b32 s70, s68, 12
    s_add_u32 s63, s70, s71
    v_readfirstlane_b32 s86, v2
    buffer_load_dwordx4 v[80:83], v101, s[44:47], s63 offen sc1
    buffer_load_dwordx2 v[90:91], v100, s[44:47], s64 offen sc1
    s_sub_u32 s61, s61, 1
    s_cbranch_scc1 L_g3
    s_waitcnt vmcnt(1)
    buffer_load_dwordx2 v[92:93], v100, s[44:47], s64 offen sc1
    ds_write2_b32 v145, v80, v82 offset1:1
    ds_write2_b32 v145, v81, v83 offset0:16 offset1:17
    v_max3_u32 v3, v80, v81, v82
    v_max_u32 v3, v3, v83
    v_cmp_eq_u32 vcc, -1, v3
    s_nop 0
    s_cbranch_vccnz L_g5
L_g2:
    s_waitcnt vmcnt(1)
    v_mov_b64 v[98:99], v[90:91]
    s_nop 0
    v_writelane_b32 v98, s79, m0
    v_writelane_b32 v99, s66, m0
    v_cmp_lt_f32 vcc, s86, v98
    v_cmp_eq_f32 s[96:97], s86, v98
    v_max_u32 v3, v98, v99
    s_cbranch_vccnz L_g0
    v_cmp_eq_u32 vcc, -1, v3
    s_ff1_i32_b32 s69, s96
    s_cmp_lg_u32 s68, s69
    s_cbranch_scc1 L_g0
    s_cmp_lg_u32 vcc_lo, 0
    s_cbranch_scc1 L_g4
L_g3:
    s_cmp_eq_u32 s57, 1
    s_cbranch_scc1 L_red
L_moe:
    s_waitcnt lgkmcnt(0)
    s_barrier
    ds_read_b128 v[172:175], v140 offset:22528
    ds_read_b128 v[176:179], v140 offset:22656
    ds_read_b128 v[180:183], v140 offset:22784
    ds_read_b128 v[184:187], v140 offset:22912
    s_waitcnt lgkmcnt(3)
    v_smfmac_f32_16x16x64_bf16 v[24:27], v[172:175], a[0:7], v141
    v_smfmac_f32_16x16x64_bf16 v[28:31], v[172:175], a[32:39], v141
    s_waitcnt lgkmcnt(2)
    v_smfmac_f32_16x16x64_bf16 v[24:27], v[176:179], a[8:15], v141
    v_smfmac_f32_16x16x64_bf16 v[28:31], v[176:179], a[40:47], v141
    s_waitcnt lgkmcnt(1)
    v_smfmac_f32_16x16x64_bf16 v[24:27], v[180:183], a[16:23], v141
    v_smfmac_f32_16x16x64_bf16 v[28:31], v[180:183], a[48:55], v141
    s_waitcnt lgkmcnt(0)
    v_smfmac_f32_16x16x64_bf16 v[24:27], v[184:187], a[24:31], v141
    v_smfmac_f32_16x16x64_bf16 v[28:31], v[184:187], a[56:63], v141
    s_mov_b64 exec, 0xffff
    s_nop 5
    v_add_f32 v24, v24, v25
    v_add_f32 v25, v28, v29
    s_cmp_eq_u32 s59, 0
    s_cbranch_scc1 L_slow_14
    buffer_store_dwordx2 v[24:25], v142, s[44:47], s72 offen
L_join_15:
    s_mov_b64 exec, -1
    s_cmp_eq_u32 s3, 0
    s_cbranch_scc0 L_act
    buffer_load_dwordx2 v[48:49], v142, s[44:47], s73 offen offset:0 sc1
    buffer_load_dwordx2 v[50:51], v142, s[44:47], s73 offen offset:512 sc1
    buffer_load_dwordx2 v[52:53], v142, s[44:47], s73 offen offset:1024 sc1
    buffer_load_dwordx2 v[54:55], v142, s[44:47], s73 offen offset:1536 sc1
    ds_read_b64_tr_b16 a[64:65], v152 offset:0
    ds_read_b64_tr_b16 a[66:67], v152 offset:2048
    ds_read_b64_tr_b16 a[68:69], v152 offset:16384
    ds_read_b64_tr_b16 a[70:71], v152 offset:18432
    ds_read_b64_tr_b16 a[72:73], v153 offset:0
    ds_read_b64_tr_b16 a[74:75], v153 offset:2048
    ds_read_b64_tr_b16 a[76:77], v153 offset:16384
    ds_read_b64_tr_b16 a[78:79], v153 offset:18432
    ds_read_b64_tr_b16 a[80:81], v154 offset:0
    ds_read_b64_tr_b16 a[82:83], v154 offset:2048
    ds_read_b64_tr_b16 a[84:85], v154 offset:16384
    ds_read_b64_tr_b16 a[86:87], v154 offset:18432
    ds_read_b64_tr_b16 a[88:89], v155 offset:0
    ds_read_b64_tr_b16 a[90:91], v155 offset:2048
    ds_read_b64_tr_b16 a[92:93], v155 offset:16384
    ds_read_b64_tr_b16 a[94:95], v155 offset:18432
    buffer_load_dwordx2 v[56:57], v142, s[44:47], s73 offen offset:0 sc1
    buffer_load_dwordx2 v[58:59], v142, s[44:47], s73 offen offset:512 sc1
    buffer_load_dwordx2 v[60:61], v142, s[44:47], s73 offen offset:1024 sc1
    buffer_load_dwordx2 v[62:63], v142, s[44:47], s73 offen offset:1536 sc1
    s_mov_b32 s61, 400000
L_ua:
    s_waitcnt vmcnt(4)
    v_pk_add_f32 v[40:41], v[48:49], v[50:51]
    v_pk_add_f32 v[44:45], v[52:53], v[54:55]
    v_pk_add_f32 v[40:41], v[40:41], v[44:45]
    v_cmp_u_f32 vcc, v40, v41
    s_nop 0
    s_cbranch_vccnz L_ub
L_ud:
    v_mul_f32 v4, 0xbfb8aa3b, v40
    v_exp_f32 v4, v4
    v_mul_f32 v40, v40, v41
    v_add_f32 v4, 1.0, v4
    v_rcp_f32 v4, v4
    s_nop 0
    v_mul_f32 v40, v40, v4
    v_cvt_pk_bf16_f32 v40, v40, v40
    ds_write_b16 v146, v40 offset:23040
    s_waitcnt lgkmcnt(0)
L_act:
    s_barrier
    ds_read_b128 v[172:175], v136 offset:23040
    ds_read_b128 v[176:179], v137 offset:23040
    ds_read_b128 v[180:183], v138 offset:23040
    ds_read_b128 v[184:187], v139 offset:23040
    s_waitcnt lgkmcnt(3)
    v_smfmac_f32_16x16x64_bf16 v[32:35], v[172:175], a[64:71], v141
    s_waitcnt lgkmcnt(2)
    v_smfmac_f32_16x16x64_bf16 v[32:35], v[176:179], a[72:79], v141
    s_waitcnt lgkmcnt(1)
    v_smfmac_f32_16x16x64_bf16 v[32:35], v[180:183], a[80:87], v141
    s_waitcnt lgkmcnt(0)
    v_smfmac_f32_16x16x64_bf16 v[32:35], v[184:187], a[88:95], v141
    s_nop 7
    v_add_f32 v32, v32, v33
    buffer_store_dword v32, v143, s[44:47], s74 offen sc1
    s_endpgm
L_ub:
    buffer_load_dwordx2 v[48:49], v142, s[44:47], s73 offen offset:0 sc1
    buffer_load_dwordx2 v[50:51], v142, s[44:47], s73 offen offset:512 sc1
    buffer_load_dwordx2 v[52:53], v142, s[44:47], s73 offen offset:1024 sc1
    buffer_load_dwordx2 v[54:55], v142, s[44:47], s73 offen offset:1536 sc1
    s_waitcnt vmcnt(4)
    v_max3_u32 v4, v56, v57, v58
    v_max3_u32 v4, v4, v59, v60
    v_max3_u32 v4, v4, v61, v62
    v_max_u32 v4, v4, v63
    v_cmp_eq_u32 vcc, -1, v4
    v_pk_add_f32 v[40:41], v[56:57], v[58:59]
    v_pk_add_f32 v[44:45], v[60:61], v[62:63]
    v_pk_add_f32 v[40:41], v[40:41], v[44:45]
    s_cbranch_vccz L_ud
    buffer_load_dwordx2 v[56:57], v142, s[44:47], s73 offen offset:0 sc1
    buffer_load_dwordx2 v[58:59], v142, s[44:47], s73 offen offset:512 sc1
    buffer_load_dwordx2 v[60:61], v142, s[44:47], s73 offen offset:1024 sc1
    buffer_load_dwordx2 v[62:63], v142, s[44:47], s73 offen offset:1536 sc1
    s_sub_u32 s61, s61, 1
    s_cbranch_scc0 L_ua
    s_branch L_ud
L_g4:
    buffer_load_dwordx2 v[90:91], v100, s[44:47], s64 offen sc1
    s_waitcnt vmcnt(1)
    v_mov_b64 v[98:99], v[92:93]
    s_nop 0
    v_writelane_b32 v98, s79, m0
    v_writelane_b32 v99, s66, m0
    v_cmp_lt_f32 vcc, s86, v98
    v_cmp_eq_f32 s[96:97], s86, v98
    v_max_u32 v3, v98, v99
    s_cbranch_vccnz L_g0
    v_cmp_eq_u32 vcc, -1, v3
    s_ff1_i32_b32 s69, s96
    s_cmp_lg_u32 s68, s69
    s_cbranch_scc1 L_g0
    s_cmp_lg_u32 vcc_lo, 0
    s_cbranch_scc0 L_g3
    buffer_load_dwordx2 v[92:93], v100, s[44:47], s64 offen sc1
    s_sub_u32 s61, s61, 1
    s_cbranch_scc0 L_g2
    s_branch L_g3
L_g5:
    s_waitcnt vmcnt(1)
    v_mov_b32 v98, v90
    s_nop 0
    v_writelane_b32 v98, s79, m0
    s_nop 0
    s_branch L_g0
L_sb:
    buffer_load_dwordx4 v[172:175], v6, s[44:47], s65 offen offset:0 sc1
    buffer_load_dwordx4 v[176:179], v6, s[44:47], s65 offen offset:1024 sc1
    buffer_load_dwordx4 v[180:183], v6, s[44:47], s65 offen offset:2048 sc1
    buffer_load_dwordx4 v[184:187], v6, s[44:47], s65 offen offset:3072 sc1
    buffer_load_dwordx4 v[188:191], v6, s[44:47], s66 offen offset:0 sc1
    buffer_load_dwordx4 v[192:195], v6, s[44:47], s66 offen offset:1024 sc1
    buffer_load_dwordx4 v[196:199], v6, s[44:47], s66 offen offset:2048 sc1
    buffer_load_dwordx4 v[200:203], v6, s[44:47], s66 offen offset:3072 sc1
    s_waitcnt vmcnt(13)
    v_max3_u32 v2, v204, v205, v204
    v_max3_u32 v2, v206, v207, v2
    v_max3_u32 v2, v208, v209, v2
    v_max3_u32 v2, v210, v211, v2
    v_max3_u32 v2, v212, v213, v2
    v_max3_u32 v2, v214, v215, v2
    v_max3_u32 v2, v216, v217, v2
    v_max3_u32 v2, v218, v219, v2
    v_pk_add_f32 v[40:41], v[204:205], v[208:209]
    v_pk_add_f32 v[44:45], v[212:213], v[216:217]
    v_pk_add_f32 v[42:43], v[206:207], v[210:211]
    v_pk_add_f32 v[46:47], v[214:215], v[218:219]
    v_pk_add_f32 v[40:41], v[40:41], v[44:45]
    v_pk_add_f32 v[42:43], v[42:43], v[46:47]
    s_waitcnt vmcnt(9)
    v_max3_u32 v2, v220, v221, v2
    v_max3_u32 v2, v222, v223, v2
    v_max3_u32 v2, v224, v225, v2
    v_max3_u32 v2, v226, v227, v2
    v_max3_u32 v2, v228, v229, v2
    v_max3_u32 v2, v230, v231, v2
    v_max3_u32 v2, v232, v233, v2
    v_max3_u32 v2, v234, v235, v2
    v_cmp_eq_u32 vcc, -1, v2
    v_pk_add_f32 v[40:41], v[40:41], v[220:221]
    v_pk_add_f32 v[42:43], v[42:43], v[222:223]
    v_pk_add_f32 v[40:41], v[40:41], v[224:225]
    v_pk_add_f32 v[42:43], v[42:43], v[226:227]
    v_pk_add_f32 v[40:41], v[40:41], v[228:229]
    v_pk_add_f32 v[42:43], v[42:43], v[230:231]
    v_pk_add_f32 v[40:41], v[40:41], v[232:233]
    v_pk_add_f32 v[42:43], v[42:43], v[234:235]
    s_cbranch_vccz L_sd
    buffer_load_dwordx4 v[204:207], v6, s[44:47], s65 offen offset:0 sc1
    buffer_load_dwordx4 v[208:211], v6, s[44:47], s65 offen offset:1024 sc1
    buffer_load_dwordx4 v[212:215], v6, s[44:47], s65 offen offset:2048 sc1
    buffer_load_dwordx4 v[216:219], v6, s[44:47], s65 offen offset:3072 sc1
    buffer_load_dwordx4 v[220:223], v6, s[44:47], s66 offen offset:0 sc1
    buffer_load_dwordx4 v[224:227], v6, s[44:47], s66 offen offset:1024 sc1
    buffer_load_dwordx4 v[228:231], v6, s[44:47], s66 offen offset:2048 sc1
    buffer_load_dwordx4 v[232:235], v6, s[44:47], s66 offen offset:3072 sc1
    buffer_load_dwordx2 v[98:99], v100, s[44:47], s64 offen sc1
    s_sub_u32 s61, s61, 1
    s_cbranch_scc0 L_sa
    s_branch L_sd
L_bulk:
    v_cvt_pk_bf16_f32 v16, v120, v121
    v_cvt_pk_bf16_f32 v17, v122, v123
    v_cvt_pk_bf16_f32 v18, v124, v125
    v_cvt_pk_bf16_f32 v19, v126, v127
    v_cvt_pk_bf16_f32 v20, v128, v129
    v_cvt_pk_bf16_f32 v21, v130, v131
    v_cvt_pk_bf16_f32 v22, v132, v133
    v_cvt_pk_bf16_f32 v23, v134, v135
    ds_write_b128 v96, v[16:19] offset:8704
    ds_write_b128 v96, v[20:23] offset:13056
    v_bfe_u32 v3, v1, 4, 1
    v_and_b32 v4, 0xf0, v6
    v_lshl_add_u32 v101, v3, 9, v4
    v_lshlrev_b32 v144, 2, v1
    v_lshlrev_b32 v142, 3, v1
    v_and_b32 v3, 56, v142
    v_and_b32 v4, 0x180, v6
    v_add_u32 v3, 22528, v3
    v_add_u32 v145, v3, v4
    v_and_b32 v3, 1, v1
    v_and_b32 v4, 48, v1
    v_lshl_add_u32 v140, v3, 6, v4
    v_mul_u32_u24 v141, 0xaaaa, v3
    v_add_u32 v141, 0x4444, v141
    v_and_b32 v4, 60, v1
    v_lshl_add_u32 v4, v3, 1, v4
    v_and_b32 v3, 2, v1
    v_lshl_add_u32 v146, v3, 5, v4
    s_lshl_b32 s71, s58, 10
    s_add_u32 s71, s71, 1179648
    v_and_b32 v3, 14, v1
    v_mov_b32 v5, 128
    v_cmp_eq_u32 vcc, 0, v3
    v_cmp_eq_u32 s[84:85], 4, v3
    v_and_b32 v4, 124, v144
    v_cndmask_b32 v136, v5, v140, vcc
    v_cmp_eq_u32 vcc, 8, v3
    v_cndmask_b32 v137, v5, v140, s[84:85]
    v_cmp_eq_u32 s[84:85], 12, v3
    v_lshrrev_b32 v3, 5, v1
    v_cndmask_b32 v138, v5, v140, vcc
    v_lshl_add_u32 v143, v3, 13, v4
    v_cndmask_b32 v139, v5, v140, s[84:85]
    v_mov_b64 v[24:25], 0
    v_mov_b64 v[28:29], 0
    v_mov_b64 v[32:33], 0
    s_lshl2_add_u32 s72, s54, s3
    s_lshl_b32 s72, s72, 7
    s_add_u32 s72, s72, 1048576
    s_andn2_b32 s73, s72, 0x7ff
    s_lshl2_add_u32 s74, s58, s3
    s_lshl_b32 s74, s74, 7
    s_add_u32 s74, s74, s56
    s_lshl_b32 s74, s74, 7
    s_add_u32 s74, s74, 786432
    s_lshl_b32 s75, s53, 8
    s_add_u32 s75, s75, s88
    s_sub_u32 s64, s3, 1
    s_lshl_b32 s64, s64, 2
    v_lshrrev_b32 v88, 4, v1
    v_add_u32 v88, s64, v88
    v_and_b32 v2, 0xf0, v6
    v_lshl_add_u32 v91, v88, 11, v2
    v_mul_u32_u24 v89, 272, v88
    v_add_u32 v89, v89, v2
    v_lshlrev_b32 v90, 3, v88
    v_mov_b32 v3, 0
    s_lshl_b32 s67, s54, 9
    s_add_u32 s67, s67, 1179648
    s_waitcnt lgkmcnt(0)
    s_barrier
    ds_read_b128 v[40:43], v89 offset:0
    ds_read_b128 v[44:47], v89 offset:3264
    ds_read_b128 v[48:51], v89 offset:6528
    ds_read_b128 v[52:55], v89 offset:9792
    ds_read_b128 v[56:59], v89 offset:13056
    ds_read_b128 v[60:63], v89 offset:16320
    ds_read_b64_tr_b16 a[64:65], v152 offset:0
    ds_read_b64_tr_b16 a[66:67], v152 offset:2048
    ds_read_b64_tr_b16 a[68:69], v152 offset:16384
    ds_read_b64_tr_b16 a[70:71], v152 offset:18432
    ds_read_b64_tr_b16 a[72:73], v153 offset:0
    ds_read_b64_tr_b16 a[74:75], v153 offset:2048
    ds_read_b64_tr_b16 a[76:77], v153 offset:16384
    ds_read_b64_tr_b16 a[78:79], v153 offset:18432
    ds_read_b64_tr_b16 a[80:81], v154 offset:0
    ds_read_b64_tr_b16 a[82:83], v154 offset:2048
    ds_read_b64_tr_b16 a[84:85], v154 offset:16384
    ds_read_b64_tr_b16 a[86:87], v154 offset:18432
    ds_read_b64_tr_b16 a[88:89], v155 offset:0
    ds_read_b64_tr_b16 a[90:91], v155 offset:2048
    ds_read_b64_tr_b16 a[92:93], v155 offset:16384
    ds_read_b64_tr_b16 a[94:95], v155 offset:18432
    s_barrier
    ds_read_b32 v92, v3 offset:22016
    ds_read_b64 v[64:65], v90 offset:21504
    ds_read_b64 v[66:67], v90 offset:21600
    ds_read_b64 v[68:69], v90 offset:21696
    ds_read_b64 v[70:71], v90 offset:21792
    ds_read_b64 v[72:73], v90 offset:21888
    ds_read_b64 v[74:75], v90 offset:21984
    s_waitcnt lgkmcnt(0)
    v_readfirstlane_b32 s65, v92
    s_nop 0
    s_and_b32 s65, s65, 63
    v_subrev_u32 v88, s65, v88
    s_cmp_eq_u32 s3, 3
    s_cbranch_scc0 L_nocr
    s_mul_i32 s66, s65, 272
    v_add_u32 v4, s66, v144
    v_lshlrev_b32 v5, 3, s65
    ds_read_b32 v93, v4 offset:0
    ds_read_b64 v[4:5], v5 offset:21504
    s_lshl_b32 s66, s65, 11
    s_add_u32 s66, s66, s75
    s_waitcnt lgkmcnt(0)
    v_lshlrev_b32 v80, 16, v93
    v_and_b32 v81, 0xffff0000, v93
    v_pk_fma_f32 v[80:81], v[80:81], v[4:5], v[4:5] op_sel:[0,0,1] op_sel_hi:[1,0,1]
    v_min_u32 v93, -2, v93
    v_cvt_pk_bf16_f32 v4, v80, v81
    buffer_store_dword v4, v144, s[36:39], s66 offen sc1
L_nocr:
    v_lshlrev_b32 v80, 16, v40
    v_and_b32 v81, 0xffff0000, v40
    v_lshlrev_b32 v82, 16, v41
    v_and_b32 v83, 0xffff0000, v41
    v_lshlrev_b32 v84, 16, v42
    v_and_b32 v85, 0xffff0000, v42
    v_lshlrev_b32 v86, 16, v43
    v_and_b32 v87, 0xffff0000, v43
    v_pk_fma_f32 v[80:81], v[80:81], v[64:65], v[64:65] op_sel:[0,0,1] op_sel_hi:[1,0,1]
    v_pk_fma_f32 v[82:83], v[82:83], v[64:65], v[64:65] op_sel:[0,0,1] op_sel_hi:[1,0,1]
    v_pk_fma_f32 v[84:85], v[84:85], v[64:65], v[64:65] op_sel:[0,0,1] op_sel_hi:[1,0,1]
    v_pk_fma_f32 v[86:87], v[86:87], v[64:65], v[64:65] op_sel:[0,0,1] op_sel_hi:[1,0,1]
    v_cvt_pk_bf16_f32 v40, v80, v81
    v_cvt_pk_bf16_f32 v41, v82, v83
    v_cvt_pk_bf16_f32 v42, v84, v85
    v_cvt_pk_bf16_f32 v43, v86, v87
    v_lshlrev_b32 v80, 16, v44
    v_and_b32 v81, 0xffff0000, v44
    v_lshlrev_b32 v82, 16, v45
    v_and_b32 v83, 0xffff0000, v45
    v_lshlrev_b32 v84, 16, v46
    v_and_b32 v85, 0xffff0000, v46
    v_lshlrev_b32 v86, 16, v47
    v_and_b32 v87, 0xffff0000, v47
    v_pk_fma_f32 v[80:81], v[80:81], v[66:67], v[66:67] op_sel:[0,0,1] op_sel_hi:[1,0,1]
    v_pk_fma_f32 v[82:83], v[82:83], v[66:67], v[66:67] op_sel:[0,0,1] op_sel_hi:[1,0,1]
    v_pk_fma_f32 v[84:85], v[84:85], v[66:67], v[66:67] op_sel:[0,0,1] op_sel_hi:[1,0,1]
    v_pk_fma_f32 v[86:87], v[86:87], v[66:67], v[66:67] op_sel:[0,0,1] op_sel_hi:[1,0,1]
    v_cvt_pk_bf16_f32 v44, v80, v81
    v_cvt_pk_bf16_f32 v45, v82, v83
    v_cvt_pk_bf16_f32 v46, v84, v85
    v_cvt_pk_bf16_f32 v47, v86, v87
    v_lshlrev_b32 v80, 16, v48
    v_and_b32 v81, 0xffff0000, v48
    v_lshlrev_b32 v82, 16, v49
    v_and_b32 v83, 0xffff0000, v49
    v_lshlrev_b32 v84, 16, v50
    v_and_b32 v85, 0xffff0000, v50
    v_lshlrev_b32 v86, 16, v51
    v_and_b32 v87, 0xffff0000, v51
    v_pk_fma_f32 v[80:81], v[80:81], v[68:69], v[68:69] op_sel:[0,0,1] op_sel_hi:[1,0,1]
    v_pk_fma_f32 v[82:83], v[82:83], v[68:69], v[68:69] op_sel:[0,0,1] op_sel_hi:[1,0,1]
    v_pk_fma_f32 v[84:85], v[84:85], v[68:69], v[68:69] op_sel:[0,0,1] op_sel_hi:[1,0,1]
    v_pk_fma_f32 v[86:87], v[86:87], v[68:69], v[68:69] op_sel:[0,0,1] op_sel_hi:[1,0,1]
    v_cvt_pk_bf16_f32 v48, v80, v81
    v_cvt_pk_bf16_f32 v49, v82, v83
    v_cvt_pk_bf16_f32 v50, v84, v85
    v_cvt_pk_bf16_f32 v51, v86, v87
    v_lshlrev_b32 v80, 16, v52
    v_and_b32 v81, 0xffff0000, v52
    v_lshlrev_b32 v82, 16, v53
    v_and_b32 v83, 0xffff0000, v53
    v_lshlrev_b32 v84, 16, v54
    v_and_b32 v85, 0xffff0000, v54
    v_lshlrev_b32 v86, 16, v55
    v_and_b32 v87, 0xffff0000, v55
    v_pk_fma_f32 v[80:81], v[80:81], v[70:71], v[70:71] op_sel:[0,0,1] op_sel_hi:[1,0,1]
    v_pk_fma_f32 v[82:83], v[82:83], v[70:71], v[70:71] op_sel:[0,0,1] op_sel_hi:[1,0,1]
    v_pk_fma_f32 v[84:85], v[84:85], v[70:71], v[70:71] op_sel:[0,0,1] op_sel_hi:[1,0,1]
    v_pk_fma_f32 v[86:87], v[86:87], v[70:71], v[70:71] op_sel:[0,0,1] op_sel_hi:[1,0,1]
    v_cvt_pk_bf16_f32 v52, v80, v81
    v_cvt_pk_bf16_f32 v53, v82, v83
    v_cvt_pk_bf16_f32 v54, v84, v85
    v_cvt_pk_bf16_f32 v55, v86, v87
    v_lshlrev_b32 v80, 16, v56
    v_and_b32 v81, 0xffff0000, v56
    v_lshlrev_b32 v82, 16, v57
    v_and_b32 v83, 0xffff0000, v57
    v_lshlrev_b32 v84, 16, v58
    v_and_b32 v85, 0xffff0000, v58
    v_lshlrev_b32 v86, 16, v59
    v_and_b32 v87, 0xffff0000, v59
    v_pk_fma_f32 v[80:81], v[80:81], v[72:73], v[72:73] op_sel:[0,0,1] op_sel_hi:[1,0,1]
    v_pk_fma_f32 v[82:83], v[82:83], v[72:73], v[72:73] op_sel:[0,0,1] op_sel_hi:[1,0,1]
    v_pk_fma_f32 v[84:85], v[84:85], v[72:73], v[72:73] op_sel:[0,0,1] op_sel_hi:[1,0,1]
    v_pk_fma_f32 v[86:87], v[86:87], v[72:73], v[72:73] op_sel:[0,0,1] op_sel_hi:[1,0,1]
    v_cvt_pk_bf16_f32 v56, v80, v81
    v_cvt_pk_bf16_f32 v57, v82, v83
    v_cvt_pk_bf16_f32 v58, v84, v85
    v_cvt_pk_bf16_f32 v59, v86, v87
    s_cmp_eq_u32 s3, 1
    s_cbranch_scc0 L_bulkd
    v_lshlrev_b32 v80, 16, v60
    v_and_b32 v81, 0xffff0000, v60
    v_lshlrev_b32 v82, 16, v61
    v_and_b32 v83, 0xffff0000, v61
    v_lshlrev_b32 v84, 16, v62
    v_and_b32 v85, 0xffff0000, v62
    v_lshlrev_b32 v86, 16, v63
    v_and_b32 v87, 0xffff0000, v63
    v_pk_fma_f32 v[80:81], v[80:81], v[74:75], v[74:75] op_sel:[0,0,1] op_sel_hi:[1,0,1]
    v_pk_fma_f32 v[82:83], v[82:83], v[74:75], v[74:75] op_sel:[0,0,1] op_sel_hi:[1,0,1]
    v_pk_fma_f32 v[84:85], v[84:85], v[74:75], v[74:75] op_sel:[0,0,1] op_sel_hi:[1,0,1]
    v_pk_fma_f32 v[86:87], v[86:87], v[74:75], v[74:75] op_sel:[0,0,1] op_sel_hi:[1,0,1]
    v_cvt_pk_bf16_f32 v60, v80, v81
    v_cvt_pk_bf16_f32 v61, v82, v83
    v_cvt_pk_bf16_f32 v62, v84, v85
    v_cvt_pk_bf16_f32 v63, v86, v87
L_bulkd:
    s_cmp_eq_u32 s3, 3
    s_cbranch_scc0 L_nohp
    s_waitcnt vmcnt(0)
    buffer_store_dword v93, v144, s[44:47], s67 offen offset:256 sc1
L_nohp:
    v_cmp_ne_u32 vcc, 0, v88
    s_nop 0
    s_mov_b64 exec, vcc
    buffer_store_dwordx4 v[40:43], v91, s[36:39], s75 offen sc1
    s_mov_b64 exec, -1
    s_add_u32 s75, s75, 24576
    v_cmp_ne_u32 vcc, -12, v88
    s_nop 0
    s_mov_b64 exec, vcc
    buffer_store_dwordx4 v[44:47], v91, s[36:39], s75 offen sc1
    s_mov_b64 exec, -1
    s_add_u32 s75, s75, 24576
    v_cmp_ne_u32 vcc, -24, v88
    s_nop 0
    s_mov_b64 exec, vcc
    buffer_store_dwordx4 v[48:51], v91, s[36:39], s75 offen sc1
    s_mov_b64 exec, -1
    s_add_u32 s75, s75, 24576
    v_cmp_ne_u32 vcc, -36, v88
    s_nop 0
    s_mov_b64 exec, vcc
    buffer_store_dwordx4 v[52:55], v91, s[36:39], s75 offen sc1
    s_mov_b64 exec, -1
    s_add_u32 s75, s75, 24576
    v_cmp_ne_u32 vcc, -48, v88
    s_nop 0
    s_mov_b64 exec, vcc
    buffer_store_dwordx4 v[56:59], v91, s[36:39], s75 offen sc1
    s_mov_b64 exec, -1
    s_add_u32 s75, s75, 24576
    s_cmp_eq_u32 s3, 1
    s_cbranch_scc0 L_bst2
    v_cmp_ne_u32 vcc, -60, v88
    s_nop 0
    s_mov_b64 exec, vcc
    buffer_store_dwordx4 v[60:63], v91, s[36:39], s75 offen sc1
    s_mov_b64 exec, -1
    s_add_u32 s75, s75, 24576
L_bst2:
    s_cmp_eq_u32 s57, 1
    s_cbranch_scc0 L_moe
    s_branch L_fin2
L_red:
    s_lshl_b32 s78, s56, 6
    s_and_b32 s77, s78, 0xff
    s_andn2_b32 s76, s78, 0xff
    s_lshl1_add_u32 s76, s76, s77
    s_add_u32 s76, s76, s70
    s_add_u32 s76, s76, 1179648
    v_readlane_b32 s70, v99, s68
    v_and_b32 v3, 7, v1
    v_lshlrev_b32 v3, 3, v3
    v_cvt_pk_bf16_f32 v88, v2, v2
    v_and_b32 v88, 0xffff0000, v88
    v_mul_f32 v88, 0xbfb8aa3b, v88
    v_exp_f32 v88, v88
    s_lshl_b32 s64, s56, 13
    s_add_u32 s64, s64, 786432
    v_add_f32 v88, 1.0, v88
    v_rcp_f32 v88, v88
    s_add_u32 s65, s64, 4096
    s_and_b32 s70, s70, 2047
    s_lshl_b32 s70, s70, 11
    s_add_u32 s70, s70, s78
    v_cvt_pk_bf16_f32 v88, v88, v88
    v_and_b32 v88, 0xffff0000, v88
    s_mov_b32 s61, 400000
L_poll_16:
    s_sub_u32 s61, s61, 1
    s_cbranch_scc1 L_poll_16_out
    buffer_load_dwordx2 v[84:85], v3, s[44:47], s76 offen sc1
    buffer_load_dwordx2 v[86:87], v3, s[44:47], s76 offen offset:256 sc1
    s_waitcnt vmcnt(0)
    v_max3_u32 v2, v84, v85, v86
    v_max_u32 v2, v2, v87
    v_cmp_eq_u32 vcc, -1, v2
    s_nop 0
    s_cbranch_vccnz L_poll_16
L_poll_16_out:
    v_lshlrev_b32 v104, 16, v84
    v_and_b32 v105, 0xffff0000, v84
    v_lshlrev_b32 v106, 16, v85
    v_and_b32 v107, 0xffff0000, v85
    v_lshlrev_b32 v108, 16, v86
    v_and_b32 v109, 0xffff0000, v86
    v_lshlrev_b32 v110, 16, v87
    v_and_b32 v111, 0xffff0000, v87
    v_pk_add_f32 v[104:105], v[104:105], v[108:109]
    v_pk_add_f32 v[106:107], v[106:107], v[110:111]
    buffer_load_dwordx4 v[172:175], v6, s[44:47], s64 offen offset:0 sc1
    buffer_load_dwordx4 v[176:179], v6, s[44:47], s64 offen offset:1024 sc1
    buffer_load_dwordx4 v[180:183], v6, s[44:47], s64 offen offset:2048 sc1
    buffer_load_dwordx4 v[184:187], v6, s[44:47], s64 offen offset:3072 sc1
    buffer_load_dwordx4 v[188:191], v6, s[44:47], s65 offen offset:0 sc1
    buffer_load_dwordx4 v[192:195], v6, s[44:47], s65 offen offset:1024 sc1
    buffer_load_dwordx4 v[196:199], v6, s[44:47], s65 offen offset:2048 sc1
    buffer_load_dwordx4 v[204:207], v6, s[44:47], s64 offen offset:0 sc1
    buffer_load_dwordx4 v[208:211], v6, s[44:47], s64 offen offset:1024 sc1
    buffer_load_dwordx4 v[212:215], v6, s[44:47], s64 offen offset:2048 sc1
    buffer_load_dwordx4 v[216:219], v6, s[44:47], s64 offen offset:3072 sc1
    buffer_load_dwordx4 v[220:223], v6, s[44:47], s65 offen offset:0 sc1
    buffer_load_dwordx4 v[224:227], v6, s[44:47], s65 offen offset:1024 sc1
    buffer_load_dwordx4 v[228:231], v6, s[44:47], s65 offen offset:2048 sc1
    s_mov_b32 s61, 400000
L_ya:
    s_waitcnt vmcnt(10)
    v_pk_add_f32 v[40:41], v[172:173], v[176:177]
    v_pk_add_f32 v[44:45], v[180:181], v[184:185]
    v_pk_add_f32 v[42:43], v[174:175], v[178:179]
    v_pk_add_f32 v[46:47], v[182:183], v[186:187]
    v_pk_add_f32 v[40:41], v[40:41], v[44:45]
    v_pk_add_f32 v[42:43], v[42:43], v[46:47]
    s_waitcnt vmcnt(9)
    v_pk_add_f32 v[40:41], v[40:41], v[188:189]
    v_pk_add_f32 v[42:43], v[42:43], v[190:191]
    s_waitcnt vmcnt(8)
    v_pk_add_f32 v[40:41], v[40:41], v[192:193]
    v_pk_add_f32 v[42:43], v[42:43], v[194:195]
    s_waitcnt vmcnt(7)
    v_pk_add_f32 v[40:41], v[40:41], v[196:197]
    v_pk_add_f32 v[42:43], v[42:43], v[198:199]
    v_pk_add_f32 v[44:45], v[40:41], v[42:43]
    v_cmp_u_f32 vcc, v44, v45
    s_nop 0
    s_cbranch_vccnz L_yb
L_yd:
    v_add_f32_dpp v40, v40, v40 row_ror:8 row_mask:0xf bank_mask:0xf
    v_add_f32_dpp v41, v41, v41 row_ror:8 row_mask:0xf bank_mask:0xf
    v_add_f32_dpp v42, v42, v42 row_ror:8 row_mask:0xf bank_mask:0xf
    v_add_f32_dpp v43, v43, v43 row_ror:8 row_mask:0xf bank_mask:0xf
    v_mov_b64 v[44:45], v[40:41]
    v_mov_b64 v[46:47], v[42:43]
    s_nop 0
    v_permlane16_swap_b32 v40, v44
    v_permlane16_swap_b32 v41, v45
    v_permlane16_swap_b32 v42, v46
    v_permlane16_swap_b32 v43, v47
    v_pk_add_f32 v[40:41], v[40:41], v[44:45]
    v_pk_add_f32 v[42:43], v[42:43], v[46:47]
    v_mov_b64 v[44:45], v[40:41]
    v_mov_b64 v[46:47], v[42:43]
    s_nop 0
    v_permlane32_swap_b32 v40, v44
    v_permlane32_swap_b32 v41, v45
    v_permlane32_swap_b32 v42, v46
    v_permlane32_swap_b32 v43, v47
    v_pk_add_f32 v[40:41], v[40:41], v[44:45]
    v_pk_add_f32 v[42:43], v[42:43], v[46:47]
    v_pk_fma_f32 v[40:41], v[40:41], v[88:89], v[104:105] op_sel_hi:[1,0,1]
    v_pk_fma_f32 v[42:43], v[42:43], v[88:89], v[106:107] op_sel_hi:[1,0,1]
    s_mov_b64 exec, 0xff
    v_cvt_pk_bf16_f32 v44, v40, v41
    v_cvt_pk_bf16_f32 v45, v42, v43
    buffer_store_dwordx2 v[44:45], v3, s[36:39], s70 offen
    s_mov_b64 exec, -1
L_fin2:
    s_endpgm
L_yb:
    buffer_load_dwordx4 v[172:175], v6, s[44:47], s64 offen offset:0 sc1
    buffer_load_dwordx4 v[176:179], v6, s[44:47], s64 offen offset:1024 sc1
    buffer_load_dwordx4 v[180:183], v6, s[44:47], s64 offen offset:2048 sc1
    buffer_load_dwordx4 v[184:187], v6, s[44:47], s64 offen offset:3072 sc1
    buffer_load_dwordx4 v[188:191], v6, s[44:47], s65 offen offset:0 sc1
    buffer_load_dwordx4 v[192:195], v6, s[44:47], s65 offen offset:1024 sc1
    buffer_load_dwordx4 v[196:199], v6, s[44:47], s65 offen offset:2048 sc1
    s_waitcnt vmcnt(10)
    v_max3_u32 v2, v204, v205, v204
    v_max3_u32 v2, v206, v207, v2
    v_max3_u32 v2, v208, v209, v2
    v_max3_u32 v2, v210, v211, v2
    v_max3_u32 v2, v212, v213, v2
    v_max3_u32 v2, v214, v215, v2
    v_max3_u32 v2, v216, v217, v2
    v_max3_u32 v2, v218, v219, v2
    v_pk_add_f32 v[40:41], v[204:205], v[208:209]
    v_pk_add_f32 v[44:45], v[212:213], v[216:217]
    v_pk_add_f32 v[42:43], v[206:207], v[210:211]
    v_pk_add_f32 v[46:47], v[214:215], v[218:219]
    v_pk_add_f32 v[40:41], v[40:41], v[44:45]
    v_pk_add_f32 v[42:43], v[42:43], v[46:47]
    s_waitcnt vmcnt(7)
    v_max3_u32 v2, v220, v221, v2
    v_max3_u32 v2, v222, v223, v2
    v_max3_u32 v2, v224, v225, v2
    v_max3_u32 v2, v226, v227, v2
    v_max3_u32 v2, v228, v229, v2
    v_max3_u32 v2, v230, v231, v2
    v_cmp_eq_u32 vcc, -1, v2
    v_pk_add_f32 v[40:41], v[40:41], v[220:221]
    v_pk_add_f32 v[42:43], v[42:43], v[222:223]
    v_pk_add_f32 v[40:41], v[40:41], v[224:225]
    v_pk_add_f32 v[42:43], v[42:43], v[226:227]
    v_pk_add_f32 v[40:41], v[40:41], v[228:229]
    v_pk_add_f32 v[42:43], v[42:43], v[230:231]
    s_cbranch_vccz L_yd
    buffer_load_dwordx4 v[204:207], v6, s[44:47], s64 offen offset:0 sc1
    buffer_load_dwordx4 v[208:211], v6, s[44:47], s64 offen offset:1024 sc1
    buffer_load_dwordx4 v[212:215], v6, s[44:47], s64 offen offset:2048 sc1
    buffer_load_dwordx4 v[216:219], v6, s[44:47], s64 offen offset:3072 sc1
    buffer_load_dwordx4 v[220:223], v6, s[44:47], s65 offen offset:0 sc1
    buffer_load_dwordx4 v[224:227], v6, s[44:47], s65 offen offset:1024 sc1
    buffer_load_dwordx4 v[228:231], v6, s[44:47], s65 offen offset:2048 sc1
    s_sub_u32 s61, s61, 1
    s_cbranch_scc0 L_ya
    s_branch L_yd
L_spin_1:
    s_mov_b32 s61, 0
L_spin_1_l:
    buffer_load_dword v191, v192, s[40:43], 0 offen sc1
    s_waitcnt vmcnt(0)
    v_cmp_eq_u32 vcc, 0, v191
    s_nop 0
    s_cbranch_vccz L_spin_1_ok
    s_add_u32 s61, s61, 1
    s_cmp_lt_u32 s61, 400000
    s_cbranch_scc1 L_spin_1_l
    s_branch L_spin_1_ok
L_spin_2:
    s_mov_b32 s61, 0
L_spin_2_l:
    buffer_load_dwordx2 v[228:229], v193, s[44:47], s92 offen offset:0 sc1
    buffer_load_dwordx2 v[230:231], v193, s[44:47], s92 offen offset:256 sc1
    buffer_load_dword v232, v194, s[44:47], s93 offen sc1
    buffer_load_dword v233, v195, s[44:47], s93 offen sc1
    s_waitcnt vmcnt(0)
    v_max3_u32 v2, v228, v229, v230
    v_max3_u32 v2, v2, v231, v232
    v_max_u32 v2, v2, v233
    v_cmp_eq_u32 vcc, -1, v2
    s_nop 0
    s_cbranch_vccz L_spin_2_ok
    s_add_u32 s61, s61, 1
    s_cmp_lt_u32 s61, 400000
    s_cbranch_scc1 L_spin_2_l
    s_branch L_spin_2_ok
L_spin_3:
    s_mov_b32 s61, 0
L_spin_3_l:
    buffer_load_dword v158, v6, s[44:47], s94 offen sc1
    s_waitcnt vmcnt(0)
    v_cmp_eq_u32 vcc, -1, v158
    s_nop 0
    s_lshl_b64 vcc, vcc, 32
    s_cbranch_vccz L_spin_3_ok
    s_add_u32 s61, s61, 1
    s_cmp_lt_u32 s61, 400000
    s_cbranch_scc1 L_spin_3_l
    s_branch L_spin_3_ok
L_slow_4:
    buffer_store_dword v6, v6, s[44:47], s13 offen offset:0 sc1
    s_nop 1
    s_branch L_join_5
L_spin_6:
    s_mov_b32 s61, 0
L_spin_6_l:
    buffer_load_dword v171, v6, s[44:47], s14 offen sc1
    s_waitcnt vmcnt(0)
    v_cmp_eq_u32 vcc, -1, v171
    s_nop 0
    s_lshl_b64 vcc, vcc, 32
    s_cbranch_vccz L_spin_6_ok
    s_add_u32 s61, s61, 1
    s_cmp_lt_u32 s61, 400000
    s_cbranch_scc1 L_spin_6_l
    s_branch L_spin_6_ok
L_slow_7:
    buffer_store_dword v6, v6, s[44:47], s13 offen offset:0 sc1
    s_nop 1
    s_branch L_join_8
L_slow_9:
    buffer_store_dword v6, v6, s[44:47], s13 offen offset:512 sc1
    s_nop 1
    s_branch L_join_10
L_spin_11:
    s_mov_b32 s61, 0
L_spin_11_l:
    buffer_load_dword v171, v6, s[44:47], s14 offen sc1
    s_waitcnt vmcnt(0)
    v_cmp_eq_u32 vcc, -1, v171
    s_nop 0
    s_lshr_b64 vcc, vcc, 32
    s_cbranch_vccz L_spin_11_ok
    s_add_u32 s61, s61, 1
    s_cmp_lt_u32 s61, 400000
    s_cbranch_scc1 L_spin_11_l
    s_branch L_spin_11_ok
L_slow_12:
    buffer_store_dwordx4 v[40:43], v6, s[44:47], s67 offen sc1
    s_nop 1
    s_branch L_join_13
L_slow_14:
    buffer_store_dwordx2 v[24:25], v142, s[44:47], s72 offen sc1
    s_nop 1
    s_branch L_join_15
L_exact0:
    s_waitcnt vmcnt(0) lgkmcnt(0)
    v_mov_b32 v2, 0xff800000
    s_mov_b32 s62, 0
L_exact0a:
    buffer_load_dwordx4 v[172:175], v6, s[44:47], s62 offen
    buffer_load_dwordx4 v[176:179], v6, s[44:47], s62 offen offset:1024
    s_waitcnt vmcnt(0)
    v_mfma_f32_32x32x16_bf16 v[40:55], v[172:175], v[8:11], 0
    v_mfma_f32_32x32x16_bf16 v[40:55], v[176:179], v[12:15], v[40:55]
    s_nop 11
    v_max3_f32 v2, v2, v40, v41
    v_max3_f32 v2, v2, v42, v43
    v_max3_f32 v2, v2, v44, v45
    v_max3_f32 v2, v2, v46, v47
    v_max3_f32 v2, v2, v48, v49
    v_max3_f32 v2, v2, v50, v51
    v_max3_f32 v2, v2, v52, v53
    v_max3_f32 v2, v2, v54, v55
    s_add_u32 s62, s62, 4096
    s_cmp_lt_u32 s62, 0x40000
    s_cbranch_scc1 L_exact0a
    v_mov_b32 v3, v2
    s_nop 1
    v_permlane32_swap_b32 v2, v3
    v_max_f32 v2, v2, v3
    v_sub_f32 v56, 0, v2
    v_sub_f32 v57, 0, v2
    v_sub_f32 v58, 0, v2
    v_sub_f32 v59, 0, v2
    v_sub_f32 v60, 0, v2
    v_sub_f32 v61, 0, v2
    v_sub_f32 v62, 0, v2
    v_sub_f32 v63, 0, v2
    v_sub_f32 v64, 0, v2
    v_sub_f32 v65, 0, v2
    v_sub_f32 v66, 0, v2
    v_sub_f32 v67, 0, v2
    v_sub_f32 v68, 0, v2
    v_sub_f32 v69, 0, v2
    v_sub_f32 v70, 0, v2
    v_sub_f32 v71, 0, v2
    v_mov_b64 v[104:105], 0
    v_mov_b64 v[106:107], 0
    v_mov_b64 v[108:109], 0
    v_mov_b64 v[110:111], 0
    v_mov_b64 v[112:113], 0
    v_mov_b64 v[114:115], 0
    v_mov_b64 v[116:117], 0
    v_mov_b64 v[118:119], 0
    v_mov_b64 v[136:137], 0
    v_mov_b64 v[138:139], 0
    s_mov_b32 s62, 0
L_exact0b:
    buffer_load_dwordx4 v[172:175], v6, s[44:47], s62 offen offset:0
    buffer_load_dwordx4 v[176:179], v6, s[44:47], s62 offen offset:1024
    buffer_load_dwordx4 v[180:183], v6, s[44:47], s62 offen offset:2048
    buffer_load_dwordx4 v[184:187], v6, s[44:47], s62 offen offset:3072
    s_waitcnt vmcnt(0)
    v_mfma_f32_32x32x16_bf16 v[40:55], v[172:175], v[8:11], v[56:71]
    v_mfma_f32_32x32x16_bf16 v[40:55], v[176:179], v[12:15], v[40:55]
    s_nop 11
    v_exp_f32 v40, v40
    v_exp_f32 v41, v41
    v_exp_f32 v42, v42
    v_exp_f32 v43, v43
    v_exp_f32 v44, v44
    v_exp_f32 v45, v45
    v_exp_f32 v46, v46
    v_exp_f32 v47, v47
    v_exp_f32 v48, v48
    v_exp_f32 v49, v49
    v_exp_f32 v50, v50
    v_exp_f32 v51, v51
    v_exp_f32 v52, v52
    v_exp_f32 v53, v53
    v_exp_f32 v54, v54
    v_exp_f32 v55, v55
    v_smfmac_f32_32x32x32_bf16 v[104:119], v[180:183], v[40:47], v7
    v_smfmac_f32_16x16x64_bf16 v[136:139], v[152:155], v[40:47], v7
    v_smfmac_f32_32x32x32_bf16 v[104:119], v[184:187], v[48:55], v7
    v_smfmac_f32_16x16x64_bf16 v[136:139], v[152:155], v[48:55], v7
    s_nop 7
    s_add_u32 s62, s62, 4096
    s_cmp_lt_u32 s62, 0x40000
    s_cbranch_scc1 L_exact0b
    s_nop 7
    v_mov_b32 v2, v136
    v_mov_b32 v3, v136
    s_nop 1
    v_permlane32_swap_b32 v2, v3
    s_nop 1
    v_rcp_f32 v2, v2
    s_nop 0
    v_pk_mul_f32 v[104:105], v[104:105], v[2:3] op_sel_hi:[1,0]
    v_pk_mul_f32 v[106:107], v[106:107], v[2:3] op_sel_hi:[1,0]
    v_pk_mul_f32 v[108:109], v[108:109], v[2:3] op_sel_hi:[1,0]
    v_pk_mul_f32 v[110:111], v[110:111], v[2:3] op_sel_hi:[1,0]
    v_pk_mul_f32 v[112:113], v[112:113], v[2:3] op_sel_hi:[1,0]
    v_pk_mul_f32 v[114:115], v[114:115], v[2:3] op_sel_hi:[1,0]
    v_pk_mul_f32 v[116:117], v[116:117], v[2:3] op_sel_hi:[1,0]
    v_pk_mul_f32 v[118:119], v[118:119], v[2:3] op_sel_hi:[1,0]
    v_cvt_pk_bf16_f32 v24, v104, v105
    v_cvt_pk_bf16_f32 v25, v106, v107
    v_cvt_pk_bf16_f32 v26, v108, v109
    v_cvt_pk_bf16_f32 v27, v110, v111
    v_cvt_pk_bf16_f32 v28, v112, v113
    v_cvt_pk_bf16_f32 v29, v114, v115
    v_cvt_pk_bf16_f32 v30, v116, v117
    v_cvt_pk_bf16_f32 v31, v118, v119
    buffer_store_dwordx4 v[24:27], v6, s[44:47], s12 offen offset:0 sc1
    buffer_store_dwordx4 v[28:31], v6, s[44:47], s12 offen offset:1024 sc1
    ds_write_b128 v252, v[24:27] offset:0
    ds_write_b128 v252, v[28:31] offset:1024
    s_waitcnt vmcnt(0) lgkmcnt(0)
    s_mov_b64 exec, 1
    s_cmp_eq_u32 s59, 0
    s_cbranch_scc1 L_slow_7
    buffer_store_dword v6, v6, s[44:47], s13 offen offset:0
L_join_8:
    s_mov_b64 exec, -1
    s_mov_b32 s61, 400000
L_ex0p:
    s_sub_u32 s61, s61, 1
    s_cbranch_scc1 L_ex0q
    buffer_load_dword v171, v6, s[44:47], s14 offen sc1
    s_waitcnt vmcnt(0)
    v_cmp_eq_u32 vcc, -1, v171
    s_nop 0
    s_lshl_b64 vcc, vcc, 32
    s_cbranch_vccnz L_ex0p
L_ex0q:
    s_add_u32 m0, s89, 2048
    s_nop 0
    buffer_load_dwordx4 v6, s[44:47], s40 offen offset:0 sc1 lds
    buffer_load_dwordx4 v6, s[44:47], s40 offen offset:1024 sc1 lds
    s_add_u32 m0, s89, 4096
    s_nop 0
    buffer_load_dwordx4 v6, s[44:47], s41 offen offset:0 sc1 lds
    buffer_load_dwordx4 v6, s[44:47], s41 offen offset:1024 sc1 lds
    s_branch L_back0
L_exact1:
    s_waitcnt vmcnt(0) lgkmcnt(0)
    v_mov_b32 v2, 0xff800000
    s_mov_b32 s62, 0
L_exact1a:
    buffer_load_dwordx4 v[204:207], v6, s[44:47], s62 offen
    buffer_load_dwordx4 v[208:211], v6, s[44:47], s62 offen offset:1024
    s_waitcnt vmcnt(0)
    v_mfma_f32_32x32x16_bf16 v[40:55], v[204:207], v[16:19], 0
    v_mfma_f32_32x32x16_bf16 v[40:55], v[208:211], v[20:23], v[40:55]
    s_nop 11
    v_max3_f32 v2, v2, v40, v41
    v_max3_f32 v2, v2, v42, v43
    v_max3_f32 v2, v2, v44, v45
    v_max3_f32 v2, v2, v46, v47
    v_max3_f32 v2, v2, v48, v49
    v_max3_f32 v2, v2, v50, v51
    v_max3_f32 v2, v2, v52, v53
    v_max3_f32 v2, v2, v54, v55
    s_add_u32 s62, s62, 4096
    s_cmp_lt_u32 s62, 0x40000
    s_cbranch_scc1 L_exact1a
    v_mov_b32 v3, v2
    s_nop 1
    v_permlane32_swap_b32 v2, v3
    v_max_f32 v2, v2, v3
    v_sub_f32 v56, 0, v2
    v_sub_f32 v57, 0, v2
    v_sub_f32 v58, 0, v2
    v_sub_f32 v59, 0, v2
    v_sub_f32 v60, 0, v2
    v_sub_f32 v61, 0, v2
    v_sub_f32 v62, 0, v2
    v_sub_f32 v63, 0, v2
    v_sub_f32 v64, 0, v2
    v_sub_f32 v65, 0, v2
    v_sub_f32 v66, 0, v2
    v_sub_f32 v67, 0, v2
    v_sub_f32 v68, 0, v2
    v_sub_f32 v69, 0, v2
    v_sub_f32 v70, 0, v2
    v_sub_f32 v71, 0, v2
    v_mov_b64 v[88:89], 0
    v_mov_b64 v[90:91], 0
    v_mov_b64 v[92:93], 0
    v_mov_b64 v[94:95], 0
    v_mov_b64 v[96:97], 0
    v_mov_b64 v[98:99], 0
    v_mov_b64 v[100:101], 0
    v_mov_b64 v[102:103], 0
    v_mov_b64 v[140:141], 0
    v_mov_b64 v[142:143], 0
    s_mov_b32 s62, 0
L_exact1b:
    buffer_load_dwordx4 v[204:207], v6, s[44:47], s62 offen offset:0
    buffer_load_dwordx4 v[208:211], v6, s[44:47], s62 offen offset:1024
    buffer_load_dwordx4 v[212:215], v6, s[44:47], s62 offen offset:2048
    buffer_load_dwordx4 v[216:219], v6, s[44:47], s62 offen offset:3072
    s_waitcnt vmcnt(0)
    v_mfma_f32_32x32x16_bf16 v[40:55], v[204:207], v[16:19], v[56:71]
    v_mfma_f32_32x32x16_bf16 v[40:55], v[208:211], v[20:23], v[40:55]
    s_nop 11
    v_exp_f32 v40, v40
    v_exp_f32 v41, v41
    v_exp_f32 v42, v42
    v_exp_f32 v43, v43
    v_exp_f32 v44, v44
    v_exp_f32 v45, v45
    v_exp_f32 v46, v46
    v_exp_f32 v47, v47
    v_exp_f32 v48, v48
    v_exp_f32 v49, v49
    v_exp_f32 v50, v50
    v_exp_f32 v51, v51
    v_exp_f32 v52, v52
    v_exp_f32 v53, v53
    v_exp_f32 v54, v54
    v_exp_f32 v55, v55
    v_smfmac_f32_32x32x32_bf16 v[88:103], v[212:215], v[40:47], v7
    v_smfmac_f32_16x16x64_bf16 v[140:143], v[152:155], v[40:47], v7
    v_smfmac_f32_32x32x32_bf16 v[88:103], v[216:219], v[48:55], v7
    v_smfmac_f32_16x16x64_bf16 v[140:143], v[152:155], v[48:55], v7
    s_nop 7
    s_add_u32 s62, s62, 4096
    s_cmp_lt_u32 s62, 0x40000
    s_cbranch_scc1 L_exact1b
    s_nop 7
    v_mov_b32 v2, v140
    v_mov_b32 v3, v140
    s_nop 1
    v_permlane32_swap_b32 v2, v3
    s_nop 1
    s_branch L_back1
L_end:
    s_endpgm
.section .rodata,"a"
.p2align 6
.amdhsa_kernel sequential_preLN__grouped_kv_mqa__moe_arch_mod__prompt_kernel
  .amdhsa_next_free_vgpr 512
  .amdhsa_next_free_sgpr 102
  .amdhsa_accum_offset 256
  .amdhsa_group_segment_fixed_size 0
  .amdhsa_kernarg_size 104
  .amdhsa_user_sgpr_count 2
  .amdhsa_user_sgpr_kernarg_segment_ptr 1
  .amdhsa_system_sgpr_workgroup_id_x 1
.end_amdhsa_kernel
```
